```python
import torch

def _softmax(x, axis=-1):
    return torch.softmax(x, dim=axis)
def _gelu(x):
    return torch.nn.functional.gelu(x, approximate="tanh")
def _silu(x):
    return torch.nn.functional.silu(x)
def _sigmoid(x):
    return torch.sigmoid(x)
def _layernorm(x, axis=-1, eps=1e-5):
    m = x.mean(dim=axis, keepdim=True)
    v = x.var(dim=axis, keepdim=True, unbiased=False)
    return (x - m) / torch.sqrt(v + eps)
def _scatter_add(tgt, idx, src, axis=0):
    return tgt.clone().index_add_(axis, idx, src)
def _segment_sum(src, seg, n):
    out = torch.zeros((n,) + src.shape[1:], dtype=src.dtype)
    return out.index_add_(0, seg, src)
def _pad(x, pw):
    flat = tuple(v for pair in reversed(pw) for v in pair)
    return torch.nn.functional.pad(x, flat)

kernel_name = 'interleave_layers__spectral_fnet__glu_gated_glu__prompt'

def setup_inputs():

    _w = (lambda a: (lambda t: t.to(torch.bfloat16) if t.is_floating_point() else t)(torch.as_tensor(a)))
    def _A_setup():
        B, S, D = 1, 2048, 640
        ns = torch.arange(S)[:, None] * torch.arange(S)[None, :]
        nd = torch.arange(D)[:, None] * torch.arange(D)[None, :]
        Ws_re = torch.cos(-2.0 * torch.pi * ns / S).to(float)
        Ws_im = torch.sin(-2.0 * torch.pi * ns / S).to(float)
        Wd_re = torch.cos(-2.0 * torch.pi * nd / D).to(float)
        Wd_im = torch.sin(-2.0 * torch.pi * nd / D).to(float)
        return {
            "x": _w((lambda *s: torch.randn(*s, dtype=torch.bfloat16) * 0.05)(B, S, D)),
            "dft_seq_re": _w(Ws_re),
            "dft_seq_im": _w(Ws_im),
            "dft_hid_re": _w(Wd_re),
            "dft_hid_im": _w(Wd_im),
        }
    _A_in = _A_setup()

    def _B_setup():
        B, S, D, F = 1, 2048, 640, 1536
        return {
            "x": _w((lambda *s: torch.randn(*s, dtype=torch.bfloat16) * 0.05)(B, S, D)),
            "w_gate": _w((lambda *s: torch.randn(*s, dtype=torch.bfloat16) * 1.6)(D, F)),
            "w_up": _w((lambda *s: torch.randn(*s, dtype=torch.bfloat16) * 0.8)(D, F)),
            "w_down": _w((lambda *s: torch.randn(*s, dtype=torch.bfloat16) * 0.8)(F, D)),
        }
    _B_in = _B_setup()

    return {
        "A_x": _A_in["x"],
        "A_dft_seq_re": _A_in["dft_seq_re"],
        "A_dft_seq_im": _A_in["dft_seq_im"],
        "A_dft_hid_re": _A_in["dft_hid_re"],
        "A_dft_hid_im": _A_in["dft_hid_im"],
        "B_x": _B_in["x"],
        "B_w_gate": _B_in["w_gate"],
        "B_w_up": _B_in["w_up"],
        "B_w_down": _B_in["w_down"],
    }

def reference(A_x, A_dft_seq_re, A_dft_seq_im, A_dft_hid_re, A_dft_hid_im, B_x, B_w_gate, B_w_up, B_w_down):
    def _A_ref(x, dft_seq_re, dft_seq_im, dft_hid_re, dft_hid_im):
        a = torch.einsum("bsd,ed->bse", x, dft_hid_re)
        b = torch.einsum("bsd,ed->bse", x, dft_hid_im)
        y = torch.einsum("ts,bse->bte", dft_seq_re, a) - torch.einsum("ts,bse->bte", dft_seq_im, b)
        return y

    def _B_ref(x, w_gate, w_up, w_down):
        g = torch.einsum("bsd,df->bsf", x, w_gate)
        u = torch.einsum("bsd,df->bsf", x, w_up)
        h = _sigmoid(g) * u
        return torch.einsum("bsf,fd->bsd", h, w_down)

    x = A_x
    x = x + _A_ref(_layernorm(x, axis=-1), A_dft_seq_re, A_dft_seq_im, A_dft_hid_re, A_dft_hid_im)
    x = x + _B_ref(_layernorm(x, axis=-1), B_w_gate, B_w_up, B_w_down)
    x = x + _A_ref(_layernorm(x, axis=-1), A_dft_seq_re, A_dft_seq_im, A_dft_hid_re, A_dft_hid_im)
    x = x + _B_ref(_layernorm(x, axis=-1), B_w_gate, B_w_up, B_w_down)
    return x
```

```asm
; @launch grid=(256,1,1) block=(256,1,1) lds=163840
.amdgcn_target "amdgcn-amd-amdhsa--gfx950"
.text
.globl interleave_layers__spectral_fnet__glu_gated_glu__prompt_kernel
.p2align 8
.type interleave_layers__spectral_fnet__glu_gated_glu__prompt_kernel,@function
interleave_layers__spectral_fnet__glu_gated_glu__prompt_kernel:
    s_cmp_ge_u32 s2, 256
    s_cbranch_scc1 L_end
    s_load_dwordx2 s[32:33], s[0:1], 0
    s_load_dwordx4 s[44:47], s[0:1], 48
    s_load_dwordx8 s[48:55], s[0:1], 64
    v_lshrrev_b32 v1, 6, v0
    v_and_b32 v2, 31, v0
    v_readfirstlane_b32 s3, v1
    v_and_b32 v1, 63, v0
    v_bfe_u32 v3, v0, 5, 1
    v_lshlrev_b32 v4, 4, v1
    v_mov_b32 v30, 0
    v_mov_b32 v31, 1
    v_mov_b32 v7, 0
    v_mov_b32 v6, 0
    v_mov_b32 v10, 0
    s_bfe_u32 s16, s2, 0x20001
    s_lshl_b32 s16, s16, 2
    s_lshr_b32 s17, s2, 6
    s_add_u32 s16, s16, s17
    s_bfe_u32 s17, s2, 0x30003
    s_lshl_b32 s17, s17, 1
    s_and_b32 s18, s2, 1
    s_add_u32 s17, s17, s18
    s_mov_b32 s18, s16
    s_sub_u32 s19, 32, s16
    s_cmp_eq_u32 s16, 0
    s_cselect_b32 s19, 16, s19
    s_bitcmp1_b32 s3, 1
    s_cselect_b32 s20, s19, s18
    s_and_b32 s21, s3, 1
    s_lshl_b32 s21, s21, 5
    s_add_u32 s20, s20, s21
    s_lshl_b32 s22, s17, 5
    v_add_u32 v28, s22, v2
    v_cmp_eq_u32 vcc, 0, v28
    v_mov_b32 v29, 320
    s_nop 0
    v_cndmask_b32 v28, v28, v29, vcc
    v_cvt_f32_u32 v28, v28
    v_mul_f32 v28, 0x3acccccd, v28
    s_mul_i32 s22, s3, 80
    v_lshl_add_u32 v29, v3, 3, s22
    v_cvt_f32_u32 v29, v29
    v_mul_f32 v29, v29, v28
    v_lshrrev_b32 v20, 3, v1
    v_and_b32 v21, 7, v1
    v_add_u32 v22, 0, v20
    v_bfe_u32 v23, v22, 1, 3
    v_xor_b32 v23, v23, v21
    v_lshl_add_u32 v22, v22, 6, s20
    v_mul_u32_u24 v22, 1280, v22
    v_lshl_add_u32 v16, v23, 4, v22
    v_add_u32 v22, 8, v20
    v_bfe_u32 v23, v22, 1, 3
    v_xor_b32 v23, v23, v21
    v_lshl_add_u32 v22, v22, 6, s20
    v_mul_u32_u24 v22, 1280, v22
    v_lshl_add_u32 v17, v23, 4, v22
    v_add_u32 v22, 16, v20
    v_bfe_u32 v23, v22, 1, 3
    v_xor_b32 v23, v23, v21
    v_lshl_add_u32 v22, v22, 6, s20
    v_mul_u32_u24 v22, 1280, v22
    v_lshl_add_u32 v18, v23, 4, v22
    v_add_u32 v22, 24, v20
    v_bfe_u32 v23, v22, 1, 3
    v_xor_b32 v23, v23, v21
    v_lshl_add_u32 v22, v22, 6, s20
    v_mul_u32_u24 v22, 1280, v22
    v_lshl_add_u32 v19, v23, 4, v22
    v_mul_f32 v22, 0x3f800000, v28
    v_cos_f32 v210, v22
    v_sin_f32 v211, -v22
    v_mul_f32 v22, 0x40000000, v28
    v_cos_f32 v212, v22
    v_sin_f32 v213, -v22
    v_mul_f32 v22, 0x40400000, v28
    v_cos_f32 v214, v22
    v_sin_f32 v215, -v22
    v_mul_f32 v22, 0x40800000, v28
    v_cos_f32 v216, v22
    v_sin_f32 v217, -v22
    v_mul_f32 v22, 0x40a00000, v28
    v_cos_f32 v218, v22
    v_sin_f32 v219, -v22
    v_mul_f32 v22, 0x40c00000, v28
    v_cos_f32 v220, v22
    v_sin_f32 v221, -v22
    v_mul_f32 v22, 0x40e00000, v28
    v_cos_f32 v222, v22
    v_sin_f32 v223, -v22
    s_waitcnt lgkmcnt(0)
    s_mov_b32 s4, s54
    s_mov_b32 s5, s55
    s_mov_b32 s6, 39845888
    s_mov_b32 s7, 0x20000
    s_lshl_b32 s64, s16, 12
    s_cmp_ge_u32 s17, 10
    s_cbranch_scc1 L_prep
    s_mul_i32 s56, s17, 258048
    s_lshl_b32 s57, s3, 12
    s_add_u32 s58, s56, s57
    s_lshr_b32 s23, s17, 1
    s_mul_i32 s59, s23, 245760
    s_mul_i32 s24, s3, 61440
    s_add_u32 s59, s59, s24
    s_add_u32 s59, s59, 4194304
    s_lshl_b32 s64, s16, 12
    s_mul_i32 s21, s23, 0
    s_add_u32 s21, s21, s16
    s_add_u32 s21, s21, 0
    s_and_b32 s21, s21, 3
    s_mul_i32 s36, s21, 15360
    s_add_u32 s36, s36, s59
    s_mul_i32 s40, s21, 3072
    s_mul_i32 s21, s23, 0
    s_add_u32 s21, s21, s16
    s_add_u32 s21, s21, 1
    s_and_b32 s21, s21, 3
    s_mul_i32 s37, s21, 15360
    s_add_u32 s37, s37, s59
    s_mul_i32 s41, s21, 3072
    s_mul_i32 s21, s23, 0
    s_add_u32 s21, s21, s16
    s_add_u32 s21, s21, 2
    s_and_b32 s21, s21, 3
    s_mul_i32 s38, s21, 15360
    s_add_u32 s38, s38, s59
    s_mul_i32 s42, s21, 3072
    s_mul_i32 s21, s23, 0
    s_add_u32 s21, s21, s16
    s_add_u32 s21, s21, 3
    s_and_b32 s21, s21, 3
    s_mul_i32 s39, s21, 15360
    s_add_u32 s39, s39, s59
    s_mul_i32 s43, s21, 3072
    s_mov_b32 s12, s32
    s_mov_b32 s13, s33
    s_mov_b32 s14, 2621440
    s_mov_b32 s15, 0x20000
    s_mul_i32 s25, s3, 30720
    s_add_u32 s25, s25, 40960
    s_lshr_b32 s30, s17, 1
    s_lshl_b32 s30, s30, 7
    s_add_u32 s31, s30, 640
    s_add_u32 m0, s25, 0
    s_nop 0
    buffer_load_dwordx4 v16, s[12:15], s30 offen  lds
    s_add_u32 m0, s25, 1024
    s_nop 0
    buffer_load_dwordx4 v17, s[12:15], s30 offen  lds
    s_add_u32 m0, s25, 2048
    s_nop 0
    buffer_load_dwordx4 v18, s[12:15], s30 offen  lds
    s_add_u32 m0, s25, 3072
    s_nop 0
    buffer_load_dwordx4 v19, s[12:15], s30 offen  lds
    s_add_u32 m0, s25, 4096
    s_nop 0
    buffer_load_dwordx4 v16, s[12:15], s31 offen  lds
    s_add_u32 m0, s25, 5120
    s_nop 0
    buffer_load_dwordx4 v17, s[12:15], s31 offen  lds
    s_add_u32 m0, s25, 6144
    s_nop 0
    buffer_load_dwordx4 v18, s[12:15], s31 offen  lds
    s_add_u32 m0, s25, 7168
    s_nop 0
    buffer_load_dwordx4 v19, s[12:15], s31 offen  lds
    s_add_u32 s30, s30, 128
    s_cmp_eq_u32 s30, 640
    s_cselect_b32 s30, 0, s30
    s_add_u32 s31, s30, 640
    s_mov_b32 s8, s52
    s_mov_b32 s9, s53
    s_mov_b32 s10, 256
    s_mov_b32 s11, 0x20000
    s_mul_i32 s22, s3, 10240
    v_add_u32 v5, s22, v4
    s_mul_i32 s23, s17, 40960
    s_add_u32 s23, s23, s22
    s_add_u32 s23, s23, 35733504
    s_mul_i32 s24, s3, 5
    s_sub_u32 s24, s24, s16
    v_fmamk_f32 v22, v28, 0x0, v29
    v_fract_f32 v22, v22
    v_cos_f32 v224, v22
    v_sin_f32 v225, -v22
    s_nop 0
    v_pk_mul_f32 v[226:227], v[224:225], v[210:211] op_sel_hi:[1,0]
    v_pk_mul_f32 v[228:229], v[224:225], v[212:213] op_sel_hi:[1,0]
    v_pk_mul_f32 v[230:231], v[224:225], v[214:215] op_sel_hi:[1,0]
    v_pk_mul_f32 v[232:233], v[224:225], v[216:217] op_sel_hi:[1,0]
    v_pk_mul_f32 v[234:235], v[224:225], v[218:219] op_sel_hi:[1,0]
    v_pk_mul_f32 v[236:237], v[224:225], v[220:221] op_sel_hi:[1,0]
    v_pk_mul_f32 v[238:239], v[224:225], v[222:223] op_sel_hi:[1,0]
    v_pk_fma_f32 v[226:227], v[224:225], v[210:211], v[226:227] op_sel:[1,1,0] op_sel_hi:[0,1,1] neg_lo:[1,0,0]
    v_pk_fma_f32 v[228:229], v[224:225], v[212:213], v[228:229] op_sel:[1,1,0] op_sel_hi:[0,1,1] neg_lo:[1,0,0]
    v_pk_fma_f32 v[230:231], v[224:225], v[214:215], v[230:231] op_sel:[1,1,0] op_sel_hi:[0,1,1] neg_lo:[1,0,0]
    v_pk_fma_f32 v[232:233], v[224:225], v[216:217], v[232:233] op_sel:[1,1,0] op_sel_hi:[0,1,1] neg_lo:[1,0,0]
    v_pk_fma_f32 v[234:235], v[224:225], v[218:219], v[234:235] op_sel:[1,1,0] op_sel_hi:[0,1,1] neg_lo:[1,0,0]
    v_pk_fma_f32 v[236:237], v[224:225], v[220:221], v[236:237] op_sel:[1,1,0] op_sel_hi:[0,1,1] neg_lo:[1,0,0]
    v_pk_fma_f32 v[238:239], v[224:225], v[222:223], v[238:239] op_sel:[1,1,0] op_sel_hi:[0,1,1] neg_lo:[1,0,0]
    v_cvt_pk_bf16_f32 v240, v224, v226
    v_cvt_pk_bf16_f32 v244, v225, v227
    v_cvt_pk_bf16_f32 v241, v228, v230
    v_cvt_pk_bf16_f32 v245, v229, v231
    v_cvt_pk_bf16_f32 v242, v232, v234
    v_cvt_pk_bf16_f32 v246, v233, v235
    v_cvt_pk_bf16_f32 v243, v236, v238
    v_cvt_pk_bf16_f32 v247, v237, v239
    ds_write_b128 v5, v[240:243] offset:0
    ds_write_b128 v5, v[244:247] offset:1024
    s_add_u32 s27, s24, 0
    s_and_b32 s27, s27, 15
    s_cbranch_scc1 Lns_prompt_1
    s_add_u32 s27, s23, 0
    buffer_store_dwordx4 v[240:243], v4, s[4:7], s27 offen sc1
    buffer_store_dwordx4 v[244:247], v4, s[4:7], s27 offen offset:1024 sc1
Lns_prompt_1:
    v_fmamk_f32 v22, v28, 0x41800000, v29
    v_fract_f32 v22, v22
    v_cos_f32 v224, v22
    v_sin_f32 v225, -v22
    s_nop 0
    v_pk_mul_f32 v[226:227], v[224:225], v[210:211] op_sel_hi:[1,0]
    v_pk_mul_f32 v[228:229], v[224:225], v[212:213] op_sel_hi:[1,0]
    v_pk_mul_f32 v[230:231], v[224:225], v[214:215] op_sel_hi:[1,0]
    v_pk_mul_f32 v[232:233], v[224:225], v[216:217] op_sel_hi:[1,0]
    v_pk_mul_f32 v[234:235], v[224:225], v[218:219] op_sel_hi:[1,0]
    v_pk_mul_f32 v[236:237], v[224:225], v[220:221] op_sel_hi:[1,0]
    v_pk_mul_f32 v[238:239], v[224:225], v[222:223] op_sel_hi:[1,0]
    v_pk_fma_f32 v[226:227], v[224:225], v[210:211], v[226:227] op_sel:[1,1,0] op_sel_hi:[0,1,1] neg_lo:[1,0,0]
    v_pk_fma_f32 v[228:229], v[224:225], v[212:213], v[228:229] op_sel:[1,1,0] op_sel_hi:[0,1,1] neg_lo:[1,0,0]
    v_pk_fma_f32 v[230:231], v[224:225], v[214:215], v[230:231] op_sel:[1,1,0] op_sel_hi:[0,1,1] neg_lo:[1,0,0]
    v_pk_fma_f32 v[232:233], v[224:225], v[216:217], v[232:233] op_sel:[1,1,0] op_sel_hi:[0,1,1] neg_lo:[1,0,0]
    v_pk_fma_f32 v[234:235], v[224:225], v[218:219], v[234:235] op_sel:[1,1,0] op_sel_hi:[0,1,1] neg_lo:[1,0,0]
    v_pk_fma_f32 v[236:237], v[224:225], v[220:221], v[236:237] op_sel:[1,1,0] op_sel_hi:[0,1,1] neg_lo:[1,0,0]
    v_pk_fma_f32 v[238:239], v[224:225], v[222:223], v[238:239] op_sel:[1,1,0] op_sel_hi:[0,1,1] neg_lo:[1,0,0]
    v_cvt_pk_bf16_f32 v248, v224, v226
    v_cvt_pk_bf16_f32 v252, v225, v227
    v_cvt_pk_bf16_f32 v249, v228, v230
    v_cvt_pk_bf16_f32 v253, v229, v231
    v_cvt_pk_bf16_f32 v250, v232, v234
    v_cvt_pk_bf16_f32 v254, v233, v235
    v_cvt_pk_bf16_f32 v251, v236, v238
    v_cvt_pk_bf16_f32 v255, v237, v239
    ds_write_b128 v5, v[248:251] offset:2048
    ds_write_b128 v5, v[252:255] offset:3072
    s_add_u32 s27, s24, 1
    s_and_b32 s27, s27, 15
    s_cbranch_scc1 Lns_prompt_2
    s_add_u32 s27, s23, 2048
    buffer_store_dwordx4 v[248:251], v4, s[4:7], s27 offen sc1
    buffer_store_dwordx4 v[252:255], v4, s[4:7], s27 offen offset:1024 sc1
Lns_prompt_2:
    s_add_u32 m0, s25, 8192
    s_nop 0
    buffer_load_dwordx4 v16, s[12:15], s30 offen  lds
    s_add_u32 m0, s25, 9216
    s_nop 0
    buffer_load_dwordx4 v17, s[12:15], s30 offen  lds
    v_fmamk_f32 v22, v28, 0x42000000, v29
    v_fract_f32 v22, v22
    v_cos_f32 v224, v22
    v_sin_f32 v225, -v22
    s_nop 0
    v_pk_mul_f32 v[226:227], v[224:225], v[210:211] op_sel_hi:[1,0]
    v_pk_mul_f32 v[228:229], v[224:225], v[212:213] op_sel_hi:[1,0]
    v_pk_mul_f32 v[230:231], v[224:225], v[214:215] op_sel_hi:[1,0]
    v_pk_mul_f32 v[232:233], v[224:225], v[216:217] op_sel_hi:[1,0]
    v_pk_mul_f32 v[234:235], v[224:225], v[218:219] op_sel_hi:[1,0]
    v_pk_mul_f32 v[236:237], v[224:225], v[220:221] op_sel_hi:[1,0]
    v_pk_mul_f32 v[238:239], v[224:225], v[222:223] op_sel_hi:[1,0]
    v_pk_fma_f32 v[226:227], v[224:225], v[210:211], v[226:227] op_sel:[1,1,0] op_sel_hi:[0,1,1] neg_lo:[1,0,0]
    v_pk_fma_f32 v[228:229], v[224:225], v[212:213], v[228:229] op_sel:[1,1,0] op_sel_hi:[0,1,1] neg_lo:[1,0,0]
    v_pk_fma_f32 v[230:231], v[224:225], v[214:215], v[230:231] op_sel:[1,1,0] op_sel_hi:[0,1,1] neg_lo:[1,0,0]
    v_pk_fma_f32 v[232:233], v[224:225], v[216:217], v[232:233] op_sel:[1,1,0] op_sel_hi:[0,1,1] neg_lo:[1,0,0]
    v_pk_fma_f32 v[234:235], v[224:225], v[218:219], v[234:235] op_sel:[1,1,0] op_sel_hi:[0,1,1] neg_lo:[1,0,0]
    v_pk_fma_f32 v[236:237], v[224:225], v[220:221], v[236:237] op_sel:[1,1,0] op_sel_hi:[0,1,1] neg_lo:[1,0,0]
    v_pk_fma_f32 v[238:239], v[224:225], v[222:223], v[238:239] op_sel:[1,1,0] op_sel_hi:[0,1,1] neg_lo:[1,0,0]
    v_cvt_pk_bf16_f32 v240, v224, v226
    v_cvt_pk_bf16_f32 v244, v225, v227
    v_cvt_pk_bf16_f32 v241, v228, v230
    v_cvt_pk_bf16_f32 v245, v229, v231
    v_cvt_pk_bf16_f32 v242, v232, v234
    v_cvt_pk_bf16_f32 v246, v233, v235
    v_cvt_pk_bf16_f32 v243, v236, v238
    v_cvt_pk_bf16_f32 v247, v237, v239
    ds_write_b128 v5, v[240:243] offset:4096
    ds_write_b128 v5, v[244:247] offset:5120
    s_add_u32 s27, s24, 2
    s_and_b32 s27, s27, 15
    s_cbranch_scc1 Lns_prompt_3
    s_add_u32 s27, s23, 4096
    buffer_store_dwordx4 v[240:243], v4, s[4:7], s27 offen sc1
    buffer_store_dwordx4 v[244:247], v4, s[4:7], s27 offen offset:1024 sc1
Lns_prompt_3:
    s_add_u32 m0, s25, 10240
    s_nop 0
    buffer_load_dwordx4 v18, s[12:15], s30 offen  lds
    s_add_u32 m0, s25, 11264
    s_nop 0
    buffer_load_dwordx4 v19, s[12:15], s30 offen  lds
    v_fmamk_f32 v22, v28, 0x42400000, v29
    v_fract_f32 v22, v22
    v_cos_f32 v224, v22
    v_sin_f32 v225, -v22
    s_nop 0
    v_pk_mul_f32 v[226:227], v[224:225], v[210:211] op_sel_hi:[1,0]
    v_pk_mul_f32 v[228:229], v[224:225], v[212:213] op_sel_hi:[1,0]
    v_pk_mul_f32 v[230:231], v[224:225], v[214:215] op_sel_hi:[1,0]
    v_pk_mul_f32 v[232:233], v[224:225], v[216:217] op_sel_hi:[1,0]
    v_pk_mul_f32 v[234:235], v[224:225], v[218:219] op_sel_hi:[1,0]
    v_pk_mul_f32 v[236:237], v[224:225], v[220:221] op_sel_hi:[1,0]
    v_pk_mul_f32 v[238:239], v[224:225], v[222:223] op_sel_hi:[1,0]
    v_pk_fma_f32 v[226:227], v[224:225], v[210:211], v[226:227] op_sel:[1,1,0] op_sel_hi:[0,1,1] neg_lo:[1,0,0]
    v_pk_fma_f32 v[228:229], v[224:225], v[212:213], v[228:229] op_sel:[1,1,0] op_sel_hi:[0,1,1] neg_lo:[1,0,0]
    v_pk_fma_f32 v[230:231], v[224:225], v[214:215], v[230:231] op_sel:[1,1,0] op_sel_hi:[0,1,1] neg_lo:[1,0,0]
    v_pk_fma_f32 v[232:233], v[224:225], v[216:217], v[232:233] op_sel:[1,1,0] op_sel_hi:[0,1,1] neg_lo:[1,0,0]
    v_pk_fma_f32 v[234:235], v[224:225], v[218:219], v[234:235] op_sel:[1,1,0] op_sel_hi:[0,1,1] neg_lo:[1,0,0]
    v_pk_fma_f32 v[236:237], v[224:225], v[220:221], v[236:237] op_sel:[1,1,0] op_sel_hi:[0,1,1] neg_lo:[1,0,0]
    v_pk_fma_f32 v[238:239], v[224:225], v[222:223], v[238:239] op_sel:[1,1,0] op_sel_hi:[0,1,1] neg_lo:[1,0,0]
    v_cvt_pk_bf16_f32 v248, v224, v226
    v_cvt_pk_bf16_f32 v252, v225, v227
    v_cvt_pk_bf16_f32 v249, v228, v230
    v_cvt_pk_bf16_f32 v253, v229, v231
    v_cvt_pk_bf16_f32 v250, v232, v234
    v_cvt_pk_bf16_f32 v254, v233, v235
    v_cvt_pk_bf16_f32 v251, v236, v238
    v_cvt_pk_bf16_f32 v255, v237, v239
    ds_write_b128 v5, v[248:251] offset:6144
    ds_write_b128 v5, v[252:255] offset:7168
    s_add_u32 s27, s24, 3
    s_and_b32 s27, s27, 15
    s_cbranch_scc1 Lns_prompt_4
    s_add_u32 s27, s23, 6144
    buffer_store_dwordx4 v[248:251], v4, s[4:7], s27 offen sc1
    buffer_store_dwordx4 v[252:255], v4, s[4:7], s27 offen offset:1024 sc1
Lns_prompt_4:
    s_add_u32 m0, s25, 12288
    s_nop 0
    buffer_load_dwordx4 v16, s[12:15], s31 offen  lds
    s_add_u32 m0, s25, 13312
    s_nop 0
    buffer_load_dwordx4 v17, s[12:15], s31 offen  lds
    v_fmamk_f32 v22, v28, 0x42800000, v29
    v_fract_f32 v22, v22
    v_cos_f32 v224, v22
    v_sin_f32 v225, -v22
    s_nop 0
    v_pk_mul_f32 v[226:227], v[224:225], v[210:211] op_sel_hi:[1,0]
    v_pk_mul_f32 v[228:229], v[224:225], v[212:213] op_sel_hi:[1,0]
    v_pk_mul_f32 v[230:231], v[224:225], v[214:215] op_sel_hi:[1,0]
    v_pk_mul_f32 v[232:233], v[224:225], v[216:217] op_sel_hi:[1,0]
    v_pk_mul_f32 v[234:235], v[224:225], v[218:219] op_sel_hi:[1,0]
    v_pk_mul_f32 v[236:237], v[224:225], v[220:221] op_sel_hi:[1,0]
    v_pk_mul_f32 v[238:239], v[224:225], v[222:223] op_sel_hi:[1,0]
    v_pk_fma_f32 v[226:227], v[224:225], v[210:211], v[226:227] op_sel:[1,1,0] op_sel_hi:[0,1,1] neg_lo:[1,0,0]
    v_pk_fma_f32 v[228:229], v[224:225], v[212:213], v[228:229] op_sel:[1,1,0] op_sel_hi:[0,1,1] neg_lo:[1,0,0]
    v_pk_fma_f32 v[230:231], v[224:225], v[214:215], v[230:231] op_sel:[1,1,0] op_sel_hi:[0,1,1] neg_lo:[1,0,0]
    v_pk_fma_f32 v[232:233], v[224:225], v[216:217], v[232:233] op_sel:[1,1,0] op_sel_hi:[0,1,1] neg_lo:[1,0,0]
    v_pk_fma_f32 v[234:235], v[224:225], v[218:219], v[234:235] op_sel:[1,1,0] op_sel_hi:[0,1,1] neg_lo:[1,0,0]
    v_pk_fma_f32 v[236:237], v[224:225], v[220:221], v[236:237] op_sel:[1,1,0] op_sel_hi:[0,1,1] neg_lo:[1,0,0]
    v_pk_fma_f32 v[238:239], v[224:225], v[222:223], v[238:239] op_sel:[1,1,0] op_sel_hi:[0,1,1] neg_lo:[1,0,0]
    v_cvt_pk_bf16_f32 v240, v224, v226
    v_cvt_pk_bf16_f32 v244, v225, v227
    v_cvt_pk_bf16_f32 v241, v228, v230
    v_cvt_pk_bf16_f32 v245, v229, v231
    v_cvt_pk_bf16_f32 v242, v232, v234
    v_cvt_pk_bf16_f32 v246, v233, v235
    v_cvt_pk_bf16_f32 v243, v236, v238
    v_cvt_pk_bf16_f32 v247, v237, v239
    ds_write_b128 v5, v[240:243] offset:8192
    ds_write_b128 v5, v[244:247] offset:9216
    s_add_u32 s27, s24, 4
    s_and_b32 s27, s27, 15
    s_cbranch_scc1 Lns_prompt_5
    s_add_u32 s27, s23, 8192
    buffer_store_dwordx4 v[240:243], v4, s[4:7], s27 offen sc1
    buffer_store_dwordx4 v[244:247], v4, s[4:7], s27 offen offset:1024 sc1
Lns_prompt_5:
    v_cvt_f32_u32 v56, v2
    v_mul_f32 v56, 0x3d000000, v56
    v_cvt_f32_u32 v57, v3
    v_mul_f32 v57, 4.0, v57
    v_mul_f32 v57, v57, v56
    v_fmamk_f32 v58, v56, 0x0, v57
    v_fmamk_f32 v59, v56, 0x3f800000, v57
    v_cos_f32 v60, v58
    v_cos_f32 v61, v59
    v_sin_f32 v62, v58
    v_sin_f32 v63, v59
    v_cvt_pk_bf16_f32 v32, v60, v61
    v_cvt_pk_bf16_f32 v40, v62, v63
    v_xor_b32 v48, 0x80008000, v32
    v_fmamk_f32 v58, v56, 0x40000000, v57
    v_fmamk_f32 v59, v56, 0x40400000, v57
    v_cos_f32 v60, v58
    v_cos_f32 v61, v59
    v_sin_f32 v62, v58
    v_sin_f32 v63, v59
    v_cvt_pk_bf16_f32 v33, v60, v61
    v_cvt_pk_bf16_f32 v41, v62, v63
    v_xor_b32 v49, 0x80008000, v33
    v_fmamk_f32 v58, v56, 0x41000000, v57
    v_fmamk_f32 v59, v56, 0x41100000, v57
    v_cos_f32 v60, v58
    v_cos_f32 v61, v59
    v_sin_f32 v62, v58
    v_sin_f32 v63, v59
    v_cvt_pk_bf16_f32 v34, v60, v61
    v_cvt_pk_bf16_f32 v42, v62, v63
    v_xor_b32 v50, 0x80008000, v34
    v_fmamk_f32 v58, v56, 0x41200000, v57
    v_fmamk_f32 v59, v56, 0x41300000, v57
    v_cos_f32 v60, v58
    v_cos_f32 v61, v59
    v_sin_f32 v62, v58
    v_sin_f32 v63, v59
    v_cvt_pk_bf16_f32 v35, v60, v61
    v_cvt_pk_bf16_f32 v43, v62, v63
    v_xor_b32 v51, 0x80008000, v35
    v_fmamk_f32 v58, v56, 0x41800000, v57
    v_fmamk_f32 v59, v56, 0x41880000, v57
    v_cos_f32 v60, v58
    v_cos_f32 v61, v59
    v_sin_f32 v62, v58
    v_sin_f32 v63, v59
    v_cvt_pk_bf16_f32 v36, v60, v61
    v_cvt_pk_bf16_f32 v44, v62, v63
    v_xor_b32 v52, 0x80008000, v36
    v_fmamk_f32 v58, v56, 0x41900000, v57
    v_fmamk_f32 v59, v56, 0x41980000, v57
    v_cos_f32 v60, v58
    v_cos_f32 v61, v59
    v_sin_f32 v62, v58
    v_sin_f32 v63, v59
    v_cvt_pk_bf16_f32 v37, v60, v61
    v_cvt_pk_bf16_f32 v45, v62, v63
    v_xor_b32 v53, 0x80008000, v37
    v_fmamk_f32 v58, v56, 0x41c00000, v57
    v_fmamk_f32 v59, v56, 0x41c80000, v57
    v_cos_f32 v60, v58
    v_cos_f32 v61, v59
    v_sin_f32 v62, v58
    v_sin_f32 v63, v59
    v_cvt_pk_bf16_f32 v38, v60, v61
    v_cvt_pk_bf16_f32 v46, v62, v63
    v_xor_b32 v54, 0x80008000, v38
    v_fmamk_f32 v58, v56, 0x41d00000, v57
    v_fmamk_f32 v59, v56, 0x41d80000, v57
    v_cos_f32 v60, v58
    v_cos_f32 v61, v59
    v_sin_f32 v62, v58
    v_sin_f32 v63, v59
    v_cvt_pk_bf16_f32 v39, v60, v61
    v_cvt_pk_bf16_f32 v47, v62, v63
    v_xor_b32 v55, 0x80008000, v39
    v_bfe_u32 v28, v2, 1, 3
    v_lshlrev_b32 v29, 7, v2
    v_add_u32 v29, s25, v29
    s_lshr_b32 s28, s17, 1
    s_lshl_b32 s28, s28, 13
    v_add_u32 v22, 0, v3
    v_xor_b32 v22, v22, v28
    v_lshl_add_u32 v12, v22, 4, v29
    v_add_u32 v22, 2, v3
    v_xor_b32 v22, v22, v28
    v_lshl_add_u32 v13, v22, 4, v29
    v_add_u32 v22, 4, v3
    v_xor_b32 v22, v22, v28
    v_lshl_add_u32 v14, v22, 4, v29
    v_add_u32 v22, 6, v3
    v_xor_b32 v22, v22, v28
    v_lshl_add_u32 v15, v22, 4, v29
    v_mov_b32 v24, 0
    v_mov_b32 v25, 0
    v_mov_b32 v26, 0
    v_mov_b32 v27, 0
    s_mov_b32 s26, 0x3f803f80
    s_waitcnt lgkmcnt(0)
    s_barrier
    s_add_u32 m0, s25, 14336
    s_nop 0
    buffer_load_dwordx4 v18, s[12:15], s31 offen  lds
    s_add_u32 m0, s25, 15360
    s_nop 0
    buffer_load_dwordx4 v19, s[12:15], s31 offen  lds
    s_add_u32 s30, s30, 128
    s_cmp_eq_u32 s30, 640
    s_cselect_b32 s30, 0, s30
    s_add_u32 s31, s30, 640
    s_add_u32 m0, s25, 16384
    s_nop 0
    buffer_load_dwordx4 v16, s[12:15], s30 offen  lds
    s_add_u32 m0, s25, 17408
    s_nop 0
    buffer_load_dwordx4 v17, s[12:15], s30 offen  lds
    s_add_u32 m0, s25, 18432
    s_nop 0
    buffer_load_dwordx4 v18, s[12:15], s30 offen  lds
    s_add_u32 m0, s25, 19456
    s_nop 0
    buffer_load_dwordx4 v19, s[12:15], s30 offen  lds
    s_waitcnt vmcnt(16)
    ds_read_b128 v[96:99], v12 offset:0
    ds_read_b128 v[100:103], v13 offset:0
    ds_read_b128 v[104:107], v14 offset:0
    ds_read_b128 v[108:111], v15 offset:0
    v_add_u32 v5, s28, v4
    s_add_u32 s28, s28, 8192
    s_cmp_eq_u32 s28, 40960
    s_cselect_b32 s28, 0, s28
    ds_read_b128 a[0:3], v5 offset:0
    ds_read_b128 a[4:7], v5 offset:1024
    ds_read_b128 a[8:11], v5 offset:2048
    ds_read_b128 a[12:15], v5 offset:3072
    ds_read_b128 a[16:19], v5 offset:4096
    ds_read_b128 a[20:23], v5 offset:5120
    ds_read_b128 a[24:27], v5 offset:6144
    ds_read_b128 a[28:31], v5 offset:7168
    s_waitcnt lgkmcnt(0)
    v_dot2c_f32_bf16 v24, s26, v96
    v_dot2c_f32_bf16 v26, v96, v96
    v_dot2c_f32_bf16 v25, s26, v97
    v_dot2c_f32_bf16 v27, v97, v97
    v_dot2c_f32_bf16 v24, s26, v98
    v_dot2c_f32_bf16 v26, v98, v98
    v_dot2c_f32_bf16 v25, s26, v99
    v_dot2c_f32_bf16 v27, v99, v99
    v_dot2c_f32_bf16 v24, s26, v100
    v_dot2c_f32_bf16 v26, v100, v100
    v_dot2c_f32_bf16 v25, s26, v101
    v_dot2c_f32_bf16 v27, v101, v101
    v_dot2c_f32_bf16 v24, s26, v102
    v_dot2c_f32_bf16 v26, v102, v102
    v_dot2c_f32_bf16 v25, s26, v103
    v_dot2c_f32_bf16 v27, v103, v103
    v_dot2c_f32_bf16 v24, s26, v104
    v_dot2c_f32_bf16 v26, v104, v104
    v_dot2c_f32_bf16 v25, s26, v105
    v_dot2c_f32_bf16 v27, v105, v105
    v_dot2c_f32_bf16 v24, s26, v106
    v_dot2c_f32_bf16 v26, v106, v106
    v_dot2c_f32_bf16 v25, s26, v107
    v_dot2c_f32_bf16 v27, v107, v107
    v_dot2c_f32_bf16 v24, s26, v108
    v_dot2c_f32_bf16 v26, v108, v108
    v_dot2c_f32_bf16 v25, s26, v109
    v_dot2c_f32_bf16 v27, v109, v109
    v_dot2c_f32_bf16 v24, s26, v110
    v_dot2c_f32_bf16 v26, v110, v110
    v_dot2c_f32_bf16 v25, s26, v111
    v_dot2c_f32_bf16 v27, v111, v111
    v_mfma_f32_32x32x16_bf16 v[64:79], v[96:99], a[0:3], 0
    s_waitcnt vmcnt(12)
    ds_read_b128 v[112:115], v12 offset:4096
    ds_read_b128 v[116:119], v13 offset:4096
    ds_read_b128 v[120:123], v14 offset:4096
    ds_read_b128 v[124:127], v15 offset:4096
    v_mfma_f32_32x32x16_bf16 v[80:95], v[96:99], a[4:7], 0
    s_add_u32 m0, s25, 20480
    s_nop 0
    buffer_load_dwordx4 v16, s[12:15], s31 offen  lds
    s_add_u32 m0, s25, 21504
    s_nop 0
    buffer_load_dwordx4 v17, s[12:15], s31 offen  lds
    v_mfma_f32_32x32x16_bf16 v[64:79], v[100:103], a[8:11], v[64:79]
    s_add_u32 m0, s25, 22528
    s_nop 0
    buffer_load_dwordx4 v18, s[12:15], s31 offen  lds
    s_add_u32 m0, s25, 23552
    s_nop 0
    buffer_load_dwordx4 v19, s[12:15], s31 offen  lds
    s_add_u32 s30, s30, 128
    s_cmp_eq_u32 s30, 640
    s_cselect_b32 s30, 0, s30
    s_add_u32 s31, s30, 640
    v_mfma_f32_32x32x16_bf16 v[80:95], v[100:103], a[12:15], v[80:95]
    s_add_u32 m0, s25, 24576
    s_nop 0
    buffer_load_dwordx4 v16, s[12:15], s30 offen  lds
    s_add_u32 m0, s25, 25600
    s_nop 0
    buffer_load_dwordx4 v17, s[12:15], s30 offen  lds
    v_mfma_f32_32x32x16_bf16 v[64:79], v[104:107], a[16:19], v[64:79]
    s_add_u32 m0, s25, 26624
    s_nop 0
    buffer_load_dwordx4 v18, s[12:15], s30 offen  lds
    s_add_u32 m0, s25, 27648
    s_nop 0
    buffer_load_dwordx4 v19, s[12:15], s30 offen  lds
    v_mfma_f32_32x32x16_bf16 v[80:95], v[104:107], a[20:23], v[80:95]
    v_mfma_f32_32x32x16_bf16 v[64:79], v[108:111], a[24:27], v[64:79]
    v_mfma_f32_32x32x16_bf16 v[80:95], v[108:111], a[28:31], v[80:95]
    s_waitcnt lgkmcnt(0)
    v_dot2c_f32_bf16 v24, s26, v112
    v_dot2c_f32_bf16 v26, v112, v112
    v_dot2c_f32_bf16 v25, s26, v113
    v_dot2c_f32_bf16 v27, v113, v113
    v_dot2c_f32_bf16 v24, s26, v114
    v_dot2c_f32_bf16 v26, v114, v114
    v_dot2c_f32_bf16 v25, s26, v115
    v_dot2c_f32_bf16 v27, v115, v115
    v_dot2c_f32_bf16 v24, s26, v116
    v_dot2c_f32_bf16 v26, v116, v116
    v_dot2c_f32_bf16 v25, s26, v117
    v_dot2c_f32_bf16 v27, v117, v117
    v_dot2c_f32_bf16 v24, s26, v118
    v_dot2c_f32_bf16 v26, v118, v118
    v_dot2c_f32_bf16 v25, s26, v119
    v_dot2c_f32_bf16 v27, v119, v119
    v_dot2c_f32_bf16 v24, s26, v120
    v_dot2c_f32_bf16 v26, v120, v120
    v_dot2c_f32_bf16 v25, s26, v121
    v_dot2c_f32_bf16 v27, v121, v121
    v_dot2c_f32_bf16 v24, s26, v122
    v_dot2c_f32_bf16 v26, v122, v122
    v_dot2c_f32_bf16 v25, s26, v123
    v_dot2c_f32_bf16 v27, v123, v123
    v_dot2c_f32_bf16 v24, s26, v124
    v_dot2c_f32_bf16 v26, v124, v124
    v_dot2c_f32_bf16 v25, s26, v125
    v_dot2c_f32_bf16 v27, v125, v125
    v_dot2c_f32_bf16 v24, s26, v126
    v_dot2c_f32_bf16 v26, v126, v126
    v_dot2c_f32_bf16 v25, s26, v127
    v_dot2c_f32_bf16 v27, v127, v127
    v_mfma_f32_32x32x16_bf16 v[192:207], v[112:115], a[0:3], 0
    s_waitcnt vmcnt(16)
    ds_read_b128 v[96:99], v12 offset:8192
    ds_read_b128 v[100:103], v13 offset:8192
    ds_read_b128 v[104:107], v14 offset:8192
    ds_read_b128 v[108:111], v15 offset:8192
    v_mfma_f32_32x32x16_bf16 v[208:223], v[112:115], a[4:7], 0
    v_add_u32 v5, s28, v4
    s_add_u32 s28, s28, 8192
    s_cmp_eq_u32 s28, 40960
    s_cselect_b32 s28, 0, s28
    ds_read_b128 a[32:35], v5 offset:0
    ds_read_b128 a[36:39], v5 offset:1024
    v_mfma_f32_32x32x16_bf16 v[192:207], v[116:119], a[8:11], v[192:207]
    ds_read_b128 a[40:43], v5 offset:2048
    ds_read_b128 a[44:47], v5 offset:3072
    ds_read_b128 a[48:51], v5 offset:4096
    ds_read_b128 a[52:55], v5 offset:5120
    ds_read_b128 a[56:59], v5 offset:6144
    ds_read_b128 a[60:63], v5 offset:7168
    v_mfma_f32_32x32x16_bf16 v[208:223], v[116:119], a[12:15], v[208:223]
    s_add_u32 m0, s25, 0
    s_nop 0
    buffer_load_dwordx4 v16, s[12:15], s31 offen  lds
    s_add_u32 m0, s25, 1024
    s_nop 0
    buffer_load_dwordx4 v17, s[12:15], s31 offen  lds
    v_mfma_f32_32x32x16_bf16 v[192:207], v[120:123], a[16:19], v[192:207]
    s_add_u32 m0, s25, 2048
    s_nop 0
    buffer_load_dwordx4 v18, s[12:15], s31 offen  lds
    s_add_u32 m0, s25, 3072
    s_nop 0
    buffer_load_dwordx4 v19, s[12:15], s31 offen  lds
    s_add_u32 s30, s30, 128
    s_cmp_eq_u32 s30, 640
    s_cselect_b32 s30, 0, s30
    s_add_u32 s31, s30, 640
    v_mfma_f32_32x32x16_bf16 v[208:223], v[120:123], a[20:23], v[208:223]
    s_add_u32 m0, s25, 4096
    s_nop 0
    buffer_load_dwordx4 v16, s[12:15], s30 offen  lds
    s_add_u32 m0, s25, 5120
    s_nop 0
    buffer_load_dwordx4 v17, s[12:15], s30 offen  lds
    v_mfma_f32_32x32x16_bf16 v[192:207], v[124:127], a[24:27], v[192:207]
    s_add_u32 m0, s25, 6144
    s_nop 0
    buffer_load_dwordx4 v18, s[12:15], s30 offen  lds
    s_add_u32 m0, s25, 7168
    s_nop 0
    buffer_load_dwordx4 v19, s[12:15], s30 offen  lds
    v_mfma_f32_32x32x16_bf16 v[208:223], v[124:127], a[28:31], v[208:223]
    s_waitcnt lgkmcnt(0)
    v_dot2c_f32_bf16 v24, s26, v96
    v_dot2c_f32_bf16 v26, v96, v96
    v_dot2c_f32_bf16 v25, s26, v97
    v_dot2c_f32_bf16 v27, v97, v97
    v_dot2c_f32_bf16 v24, s26, v98
    v_dot2c_f32_bf16 v26, v98, v98
    v_dot2c_f32_bf16 v25, s26, v99
    v_dot2c_f32_bf16 v27, v99, v99
    v_dot2c_f32_bf16 v24, s26, v100
    v_dot2c_f32_bf16 v26, v100, v100
    v_dot2c_f32_bf16 v25, s26, v101
    v_dot2c_f32_bf16 v27, v101, v101
    v_dot2c_f32_bf16 v24, s26, v102
    v_dot2c_f32_bf16 v26, v102, v102
    v_dot2c_f32_bf16 v25, s26, v103
    v_dot2c_f32_bf16 v27, v103, v103
    v_dot2c_f32_bf16 v24, s26, v104
    v_dot2c_f32_bf16 v26, v104, v104
    v_dot2c_f32_bf16 v25, s26, v105
    v_dot2c_f32_bf16 v27, v105, v105
    v_dot2c_f32_bf16 v24, s26, v106
    v_dot2c_f32_bf16 v26, v106, v106
    v_dot2c_f32_bf16 v25, s26, v107
    v_dot2c_f32_bf16 v27, v107, v107
    v_dot2c_f32_bf16 v24, s26, v108
    v_dot2c_f32_bf16 v26, v108, v108
    v_dot2c_f32_bf16 v25, s26, v109
    v_dot2c_f32_bf16 v27, v109, v109
    v_dot2c_f32_bf16 v24, s26, v110
    v_dot2c_f32_bf16 v26, v110, v110
    v_dot2c_f32_bf16 v25, s26, v111
    v_dot2c_f32_bf16 v27, v111, v111
    v_mfma_f32_32x32x16_bf16 v[64:79], v[96:99], a[32:35], v[64:79]
    s_waitcnt vmcnt(20)
    ds_read_b128 v[112:115], v12 offset:12288
    ds_read_b128 v[116:119], v13 offset:12288
    ds_read_b128 v[120:123], v14 offset:12288
    ds_read_b128 v[124:127], v15 offset:12288
    v_mfma_f32_32x32x16_bf16 v[80:95], v[96:99], a[36:39], v[80:95]
    s_add_u32 m0, s25, 8192
    s_nop 0
    buffer_load_dwordx4 v16, s[12:15], s31 offen  lds
    s_add_u32 m0, s25, 9216
    s_nop 0
    buffer_load_dwordx4 v17, s[12:15], s31 offen  lds
    v_mfma_f32_32x32x16_bf16 v[64:79], v[100:103], a[40:43], v[64:79]
    s_add_u32 m0, s25, 10240
    s_nop 0
    buffer_load_dwordx4 v18, s[12:15], s31 offen  lds
    s_add_u32 m0, s25, 11264
    s_nop 0
    buffer_load_dwordx4 v19, s[12:15], s31 offen  lds
    s_add_u32 s30, s30, 128
    s_cmp_eq_u32 s30, 640
    s_cselect_b32 s30, 0, s30
    s_add_u32 s31, s30, 640
    v_mfma_f32_32x32x16_bf16 v[80:95], v[100:103], a[44:47], v[80:95]
    v_mfma_f32_32x32x16_bf16 v[64:79], v[104:107], a[48:51], v[64:79]
    v_mfma_f32_32x32x16_bf16 v[80:95], v[104:107], a[52:55], v[80:95]
    v_mfma_f32_32x32x16_bf16 v[64:79], v[108:111], a[56:59], v[64:79]
    v_mfma_f32_32x32x16_bf16 v[80:95], v[108:111], a[60:63], v[80:95]
    s_waitcnt lgkmcnt(0)
    v_dot2c_f32_bf16 v24, s26, v112
    v_dot2c_f32_bf16 v26, v112, v112
    v_dot2c_f32_bf16 v25, s26, v113
    v_dot2c_f32_bf16 v27, v113, v113
    v_dot2c_f32_bf16 v24, s26, v114
    v_dot2c_f32_bf16 v26, v114, v114
    v_dot2c_f32_bf16 v25, s26, v115
    v_dot2c_f32_bf16 v27, v115, v115
    v_dot2c_f32_bf16 v24, s26, v116
    v_dot2c_f32_bf16 v26, v116, v116
    v_dot2c_f32_bf16 v25, s26, v117
    v_dot2c_f32_bf16 v27, v117, v117
    v_dot2c_f32_bf16 v24, s26, v118
    v_dot2c_f32_bf16 v26, v118, v118
    v_dot2c_f32_bf16 v25, s26, v119
    v_dot2c_f32_bf16 v27, v119, v119
    v_dot2c_f32_bf16 v24, s26, v120
    v_dot2c_f32_bf16 v26, v120, v120
    v_dot2c_f32_bf16 v25, s26, v121
    v_dot2c_f32_bf16 v27, v121, v121
    v_dot2c_f32_bf16 v24, s26, v122
    v_dot2c_f32_bf16 v26, v122, v122
    v_dot2c_f32_bf16 v25, s26, v123
    v_dot2c_f32_bf16 v27, v123, v123
    v_dot2c_f32_bf16 v24, s26, v124
    v_dot2c_f32_bf16 v26, v124, v124
    v_dot2c_f32_bf16 v25, s26, v125
    v_dot2c_f32_bf16 v27, v125, v125
    v_dot2c_f32_bf16 v24, s26, v126
    v_dot2c_f32_bf16 v26, v126, v126
    v_dot2c_f32_bf16 v25, s26, v127
    v_dot2c_f32_bf16 v27, v127, v127
    v_mfma_f32_32x32x16_bf16 v[192:207], v[112:115], a[32:35], v[192:207]
    s_waitcnt vmcnt(20)
    ds_read_b128 v[96:99], v12 offset:16384
    ds_read_b128 v[100:103], v13 offset:16384
    ds_read_b128 v[104:107], v14 offset:16384
    ds_read_b128 v[108:111], v15 offset:16384
    v_mfma_f32_32x32x16_bf16 v[208:223], v[112:115], a[36:39], v[208:223]
    v_add_u32 v5, s28, v4
    s_add_u32 s28, s28, 8192
    s_cmp_eq_u32 s28, 40960
    s_cselect_b32 s28, 0, s28
    ds_read_b128 a[0:3], v5 offset:0
    ds_read_b128 a[4:7], v5 offset:1024
    v_mfma_f32_32x32x16_bf16 v[192:207], v[116:119], a[40:43], v[192:207]
    ds_read_b128 a[8:11], v5 offset:2048
    ds_read_b128 a[12:15], v5 offset:3072
    ds_read_b128 a[16:19], v5 offset:4096
    ds_read_b128 a[20:23], v5 offset:5120
    ds_read_b128 a[24:27], v5 offset:6144
    ds_read_b128 a[28:31], v5 offset:7168
    v_mfma_f32_32x32x16_bf16 v[208:223], v[116:119], a[44:47], v[208:223]
    v_mfma_f32_32x32x16_bf16 v[192:207], v[120:123], a[48:51], v[192:207]
    v_mfma_f32_32x32x16_bf16 v[208:223], v[120:123], a[52:55], v[208:223]
    v_mfma_f32_32x32x16_bf16 v[192:207], v[124:127], a[56:59], v[192:207]
    v_mfma_f32_32x32x16_bf16 v[208:223], v[124:127], a[60:63], v[208:223]
    s_waitcnt lgkmcnt(0)
    s_cmp_lg_u32 s3, 3
    s_cbranch_scc1 Lw_prompt_6
    v_mov_b32 v0, 0
    s_mov_b32 s21, 0
    buffer_load_dword v0, v30, s[8:11], s21 offen sc1
Lw_prompt_6:
    v_dot2c_f32_bf16 v24, s26, v96
    v_dot2c_f32_bf16 v26, v96, v96
    v_dot2c_f32_bf16 v25, s26, v97
    v_dot2c_f32_bf16 v27, v97, v97
    v_dot2c_f32_bf16 v24, s26, v98
    v_dot2c_f32_bf16 v26, v98, v98
    v_dot2c_f32_bf16 v25, s26, v99
    v_dot2c_f32_bf16 v27, v99, v99
    v_dot2c_f32_bf16 v24, s26, v100
    v_dot2c_f32_bf16 v26, v100, v100
    v_dot2c_f32_bf16 v25, s26, v101
    v_dot2c_f32_bf16 v27, v101, v101
    v_dot2c_f32_bf16 v24, s26, v102
    v_dot2c_f32_bf16 v26, v102, v102
    v_dot2c_f32_bf16 v25, s26, v103
    v_dot2c_f32_bf16 v27, v103, v103
    v_dot2c_f32_bf16 v24, s26, v104
    v_dot2c_f32_bf16 v26, v104, v104
    v_dot2c_f32_bf16 v25, s26, v105
    v_dot2c_f32_bf16 v27, v105, v105
    v_dot2c_f32_bf16 v24, s26, v106
    v_dot2c_f32_bf16 v26, v106, v106
    v_dot2c_f32_bf16 v25, s26, v107
    v_dot2c_f32_bf16 v27, v107, v107
    v_dot2c_f32_bf16 v24, s26, v108
    v_dot2c_f32_bf16 v26, v108, v108
    v_dot2c_f32_bf16 v25, s26, v109
    v_dot2c_f32_bf16 v27, v109, v109
    v_dot2c_f32_bf16 v24, s26, v110
    v_dot2c_f32_bf16 v26, v110, v110
    v_dot2c_f32_bf16 v25, s26, v111
    v_dot2c_f32_bf16 v27, v111, v111
    v_mfma_f32_32x32x16_bf16 v[64:79], v[96:99], a[0:3], v[64:79]
    s_waitcnt vmcnt(16)
    ds_read_b128 v[112:115], v12 offset:20480
    ds_read_b128 v[116:119], v13 offset:20480
    ds_read_b128 v[120:123], v14 offset:20480
    ds_read_b128 v[124:127], v15 offset:20480
    v_mfma_f32_32x32x16_bf16 v[80:95], v[96:99], a[4:7], v[80:95]
    v_mfma_f32_32x32x16_bf16 v[64:79], v[100:103], a[8:11], v[64:79]
    v_mfma_f32_32x32x16_bf16 v[80:95], v[100:103], a[12:15], v[80:95]
    v_mfma_f32_32x32x16_bf16 v[64:79], v[104:107], a[16:19], v[64:79]
    v_mfma_f32_32x32x16_bf16 v[80:95], v[104:107], a[20:23], v[80:95]
    v_mfma_f32_32x32x16_bf16 v[64:79], v[108:111], a[24:27], v[64:79]
    v_mfma_f32_32x32x16_bf16 v[80:95], v[108:111], a[28:31], v[80:95]
    s_waitcnt lgkmcnt(0)
    v_dot2c_f32_bf16 v24, s26, v112
    v_dot2c_f32_bf16 v26, v112, v112
    v_dot2c_f32_bf16 v25, s26, v113
    v_dot2c_f32_bf16 v27, v113, v113
    v_dot2c_f32_bf16 v24, s26, v114
    v_dot2c_f32_bf16 v26, v114, v114
    v_dot2c_f32_bf16 v25, s26, v115
    v_dot2c_f32_bf16 v27, v115, v115
    v_dot2c_f32_bf16 v24, s26, v116
    v_dot2c_f32_bf16 v26, v116, v116
    v_dot2c_f32_bf16 v25, s26, v117
    v_dot2c_f32_bf16 v27, v117, v117
    v_dot2c_f32_bf16 v24, s26, v118
    v_dot2c_f32_bf16 v26, v118, v118
    v_dot2c_f32_bf16 v25, s26, v119
    v_dot2c_f32_bf16 v27, v119, v119
    v_dot2c_f32_bf16 v24, s26, v120
    v_dot2c_f32_bf16 v26, v120, v120
    v_dot2c_f32_bf16 v25, s26, v121
    v_dot2c_f32_bf16 v27, v121, v121
    v_dot2c_f32_bf16 v24, s26, v122
    v_dot2c_f32_bf16 v26, v122, v122
    v_dot2c_f32_bf16 v25, s26, v123
    v_dot2c_f32_bf16 v27, v123, v123
    v_dot2c_f32_bf16 v24, s26, v124
    v_dot2c_f32_bf16 v26, v124, v124
    v_dot2c_f32_bf16 v25, s26, v125
    v_dot2c_f32_bf16 v27, v125, v125
    v_dot2c_f32_bf16 v24, s26, v126
    v_dot2c_f32_bf16 v26, v126, v126
    v_dot2c_f32_bf16 v25, s26, v127
    v_dot2c_f32_bf16 v27, v127, v127
    v_mfma_f32_32x32x16_bf16 v[192:207], v[112:115], a[0:3], v[192:207]
    s_waitcnt vmcnt(12)
    ds_read_b128 v[96:99], v12 offset:24576
    ds_read_b128 v[100:103], v13 offset:24576
    ds_read_b128 v[104:107], v14 offset:24576
    ds_read_b128 v[108:111], v15 offset:24576
    v_mfma_f32_32x32x16_bf16 v[208:223], v[112:115], a[4:7], v[208:223]
    v_add_u32 v5, s28, v4
    s_add_u32 s28, s28, 8192
    s_cmp_eq_u32 s28, 40960
    s_cselect_b32 s28, 0, s28
    ds_read_b128 a[32:35], v5 offset:0
    ds_read_b128 a[36:39], v5 offset:1024
    v_mfma_f32_32x32x16_bf16 v[192:207], v[116:119], a[8:11], v[192:207]
    ds_read_b128 a[40:43], v5 offset:2048
    ds_read_b128 a[44:47], v5 offset:3072
    ds_read_b128 a[48:51], v5 offset:4096
    ds_read_b128 a[52:55], v5 offset:5120
    ds_read_b128 a[56:59], v5 offset:6144
    ds_read_b128 a[60:63], v5 offset:7168
    v_mfma_f32_32x32x16_bf16 v[208:223], v[116:119], a[12:15], v[208:223]
    v_mfma_f32_32x32x16_bf16 v[192:207], v[120:123], a[16:19], v[192:207]
    v_mfma_f32_32x32x16_bf16 v[208:223], v[120:123], a[20:23], v[208:223]
    v_mfma_f32_32x32x16_bf16 v[192:207], v[124:127], a[24:27], v[192:207]
    v_mfma_f32_32x32x16_bf16 v[208:223], v[124:127], a[28:31], v[208:223]
    s_waitcnt lgkmcnt(0)
    v_dot2c_f32_bf16 v24, s26, v96
    v_dot2c_f32_bf16 v26, v96, v96
    v_dot2c_f32_bf16 v25, s26, v97
    v_dot2c_f32_bf16 v27, v97, v97
    v_dot2c_f32_bf16 v24, s26, v98
    v_dot2c_f32_bf16 v26, v98, v98
    v_dot2c_f32_bf16 v25, s26, v99
    v_dot2c_f32_bf16 v27, v99, v99
    v_dot2c_f32_bf16 v24, s26, v100
    v_dot2c_f32_bf16 v26, v100, v100
    v_dot2c_f32_bf16 v25, s26, v101
    v_dot2c_f32_bf16 v27, v101, v101
    v_dot2c_f32_bf16 v24, s26, v102
    v_dot2c_f32_bf16 v26, v102, v102
    v_dot2c_f32_bf16 v25, s26, v103
    v_dot2c_f32_bf16 v27, v103, v103
    v_dot2c_f32_bf16 v24, s26, v104
    v_dot2c_f32_bf16 v26, v104, v104
    v_dot2c_f32_bf16 v25, s26, v105
    v_dot2c_f32_bf16 v27, v105, v105
    v_dot2c_f32_bf16 v24, s26, v106
    v_dot2c_f32_bf16 v26, v106, v106
    v_dot2c_f32_bf16 v25, s26, v107
    v_dot2c_f32_bf16 v27, v107, v107
    v_dot2c_f32_bf16 v24, s26, v108
    v_dot2c_f32_bf16 v26, v108, v108
    v_dot2c_f32_bf16 v25, s26, v109
    v_dot2c_f32_bf16 v27, v109, v109
    v_dot2c_f32_bf16 v24, s26, v110
    v_dot2c_f32_bf16 v26, v110, v110
    v_dot2c_f32_bf16 v25, s26, v111
    v_dot2c_f32_bf16 v27, v111, v111
    v_mfma_f32_32x32x16_bf16 v[64:79], v[96:99], a[32:35], v[64:79]
    s_waitcnt vmcnt(8)
    ds_read_b128 v[112:115], v12 offset:0
    ds_read_b128 v[116:119], v13 offset:0
    ds_read_b128 v[120:123], v14 offset:0
    ds_read_b128 v[124:127], v15 offset:0
    v_mfma_f32_32x32x16_bf16 v[80:95], v[96:99], a[36:39], v[80:95]
    v_mfma_f32_32x32x16_bf16 v[64:79], v[100:103], a[40:43], v[64:79]
    v_mfma_f32_32x32x16_bf16 v[80:95], v[100:103], a[44:47], v[80:95]
    v_mfma_f32_32x32x16_bf16 v[64:79], v[104:107], a[48:51], v[64:79]
    v_mfma_f32_32x32x16_bf16 v[80:95], v[104:107], a[52:55], v[80:95]
    v_mfma_f32_32x32x16_bf16 v[64:79], v[108:111], a[56:59], v[64:79]
    v_mfma_f32_32x32x16_bf16 v[80:95], v[108:111], a[60:63], v[80:95]
    s_waitcnt lgkmcnt(0)
    v_dot2c_f32_bf16 v24, s26, v112
    v_dot2c_f32_bf16 v26, v112, v112
    v_dot2c_f32_bf16 v25, s26, v113
    v_dot2c_f32_bf16 v27, v113, v113
    v_dot2c_f32_bf16 v24, s26, v114
    v_dot2c_f32_bf16 v26, v114, v114
    v_dot2c_f32_bf16 v25, s26, v115
    v_dot2c_f32_bf16 v27, v115, v115
    v_dot2c_f32_bf16 v24, s26, v116
    v_dot2c_f32_bf16 v26, v116, v116
    v_dot2c_f32_bf16 v25, s26, v117
    v_dot2c_f32_bf16 v27, v117, v117
    v_dot2c_f32_bf16 v24, s26, v118
    v_dot2c_f32_bf16 v26, v118, v118
    v_dot2c_f32_bf16 v25, s26, v119
    v_dot2c_f32_bf16 v27, v119, v119
    v_dot2c_f32_bf16 v24, s26, v120
    v_dot2c_f32_bf16 v26, v120, v120
    v_dot2c_f32_bf16 v25, s26, v121
    v_dot2c_f32_bf16 v27, v121, v121
    v_dot2c_f32_bf16 v24, s26, v122
    v_dot2c_f32_bf16 v26, v122, v122
    v_dot2c_f32_bf16 v25, s26, v123
    v_dot2c_f32_bf16 v27, v123, v123
    v_dot2c_f32_bf16 v24, s26, v124
    v_dot2c_f32_bf16 v26, v124, v124
    v_dot2c_f32_bf16 v25, s26, v125
    v_dot2c_f32_bf16 v27, v125, v125
    v_dot2c_f32_bf16 v24, s26, v126
    v_dot2c_f32_bf16 v26, v126, v126
    v_dot2c_f32_bf16 v25, s26, v127
    v_dot2c_f32_bf16 v27, v127, v127
    v_mfma_f32_32x32x16_bf16 v[192:207], v[112:115], a[32:35], v[192:207]
    s_waitcnt vmcnt(4)
    ds_read_b128 v[96:99], v12 offset:4096
    ds_read_b128 v[100:103], v13 offset:4096
    ds_read_b128 v[104:107], v14 offset:4096
    ds_read_b128 v[108:111], v15 offset:4096
    v_mfma_f32_32x32x16_bf16 v[208:223], v[112:115], a[36:39], v[208:223]
    v_add_u32 v5, s28, v4
    s_add_u32 s28, s28, 8192
    s_cmp_eq_u32 s28, 40960
    s_cselect_b32 s28, 0, s28
    ds_read_b128 a[0:3], v5 offset:0
    ds_read_b128 a[4:7], v5 offset:1024
    v_mfma_f32_32x32x16_bf16 v[192:207], v[116:119], a[40:43], v[192:207]
    ds_read_b128 a[8:11], v5 offset:2048
    ds_read_b128 a[12:15], v5 offset:3072
    ds_read_b128 a[16:19], v5 offset:4096
    ds_read_b128 a[20:23], v5 offset:5120
    ds_read_b128 a[24:27], v5 offset:6144
    ds_read_b128 a[28:31], v5 offset:7168
    v_mfma_f32_32x32x16_bf16 v[208:223], v[116:119], a[44:47], v[208:223]
    v_mfma_f32_32x32x16_bf16 v[192:207], v[120:123], a[48:51], v[192:207]
    v_mfma_f32_32x32x16_bf16 v[208:223], v[120:123], a[52:55], v[208:223]
    v_mfma_f32_32x32x16_bf16 v[192:207], v[124:127], a[56:59], v[192:207]
    v_mfma_f32_32x32x16_bf16 v[208:223], v[124:127], a[60:63], v[208:223]
    s_waitcnt lgkmcnt(0)
    v_dot2c_f32_bf16 v24, s26, v96
    v_dot2c_f32_bf16 v26, v96, v96
    v_dot2c_f32_bf16 v25, s26, v97
    v_dot2c_f32_bf16 v27, v97, v97
    v_dot2c_f32_bf16 v24, s26, v98
    v_dot2c_f32_bf16 v26, v98, v98
    v_dot2c_f32_bf16 v25, s26, v99
    v_dot2c_f32_bf16 v27, v99, v99
    v_dot2c_f32_bf16 v24, s26, v100
    v_dot2c_f32_bf16 v26, v100, v100
    v_dot2c_f32_bf16 v25, s26, v101
    v_dot2c_f32_bf16 v27, v101, v101
    v_dot2c_f32_bf16 v24, s26, v102
    v_dot2c_f32_bf16 v26, v102, v102
    v_dot2c_f32_bf16 v25, s26, v103
    v_dot2c_f32_bf16 v27, v103, v103
    v_dot2c_f32_bf16 v24, s26, v104
    v_dot2c_f32_bf16 v26, v104, v104
    v_dot2c_f32_bf16 v25, s26, v105
    v_dot2c_f32_bf16 v27, v105, v105
    v_dot2c_f32_bf16 v24, s26, v106
    v_dot2c_f32_bf16 v26, v106, v106
    v_dot2c_f32_bf16 v25, s26, v107
    v_dot2c_f32_bf16 v27, v107, v107
    v_dot2c_f32_bf16 v24, s26, v108
    v_dot2c_f32_bf16 v26, v108, v108
    v_dot2c_f32_bf16 v25, s26, v109
    v_dot2c_f32_bf16 v27, v109, v109
    v_dot2c_f32_bf16 v24, s26, v110
    v_dot2c_f32_bf16 v26, v110, v110
    v_dot2c_f32_bf16 v25, s26, v111
    v_dot2c_f32_bf16 v27, v111, v111
    v_mfma_f32_32x32x16_bf16 v[64:79], v[96:99], a[0:3], v[64:79]
    s_waitcnt vmcnt(0)
    ds_read_b128 v[112:115], v12 offset:8192
    ds_read_b128 v[116:119], v13 offset:8192
    ds_read_b128 v[120:123], v14 offset:8192
    ds_read_b128 v[124:127], v15 offset:8192
    v_mfma_f32_32x32x16_bf16 v[80:95], v[96:99], a[4:7], v[80:95]
    v_mfma_f32_32x32x16_bf16 v[64:79], v[100:103], a[8:11], v[64:79]
    v_mfma_f32_32x32x16_bf16 v[80:95], v[100:103], a[12:15], v[80:95]
    v_mfma_f32_32x32x16_bf16 v[64:79], v[104:107], a[16:19], v[64:79]
    v_mfma_f32_32x32x16_bf16 v[80:95], v[104:107], a[20:23], v[80:95]
    v_mfma_f32_32x32x16_bf16 v[64:79], v[108:111], a[24:27], v[64:79]
    v_mfma_f32_32x32x16_bf16 v[80:95], v[108:111], a[28:31], v[80:95]
    s_waitcnt lgkmcnt(0)
    v_dot2c_f32_bf16 v24, s26, v112
    v_dot2c_f32_bf16 v26, v112, v112
    v_dot2c_f32_bf16 v25, s26, v113
    v_dot2c_f32_bf16 v27, v113, v113
    v_dot2c_f32_bf16 v24, s26, v114
    v_dot2c_f32_bf16 v26, v114, v114
    v_dot2c_f32_bf16 v25, s26, v115
    v_dot2c_f32_bf16 v27, v115, v115
    v_dot2c_f32_bf16 v24, s26, v116
    v_dot2c_f32_bf16 v26, v116, v116
    v_dot2c_f32_bf16 v25, s26, v117
    v_dot2c_f32_bf16 v27, v117, v117
    v_dot2c_f32_bf16 v24, s26, v118
    v_dot2c_f32_bf16 v26, v118, v118
    v_dot2c_f32_bf16 v25, s26, v119
    v_dot2c_f32_bf16 v27, v119, v119
    v_dot2c_f32_bf16 v24, s26, v120
    v_dot2c_f32_bf16 v26, v120, v120
    v_dot2c_f32_bf16 v25, s26, v121
    v_dot2c_f32_bf16 v27, v121, v121
    v_dot2c_f32_bf16 v24, s26, v122
    v_dot2c_f32_bf16 v26, v122, v122
    v_dot2c_f32_bf16 v25, s26, v123
    v_dot2c_f32_bf16 v27, v123, v123
    v_dot2c_f32_bf16 v24, s26, v124
    v_dot2c_f32_bf16 v26, v124, v124
    v_dot2c_f32_bf16 v25, s26, v125
    v_dot2c_f32_bf16 v27, v125, v125
    v_dot2c_f32_bf16 v24, s26, v126
    v_dot2c_f32_bf16 v26, v126, v126
    v_dot2c_f32_bf16 v25, s26, v127
    v_dot2c_f32_bf16 v27, v127, v127
    v_mfma_f32_32x32x16_bf16 v[192:207], v[112:115], a[0:3], v[192:207]
    v_mfma_f32_32x32x16_bf16 v[208:223], v[112:115], a[4:7], v[208:223]
    v_mfma_f32_32x32x16_bf16 v[192:207], v[116:119], a[8:11], v[192:207]
    v_mfma_f32_32x32x16_bf16 v[208:223], v[116:119], a[12:15], v[208:223]
    v_mfma_f32_32x32x16_bf16 v[192:207], v[120:123], a[16:19], v[192:207]
    v_mfma_f32_32x32x16_bf16 v[208:223], v[120:123], a[20:23], v[208:223]
    v_mfma_f32_32x32x16_bf16 v[192:207], v[124:127], a[24:27], v[192:207]
    v_mfma_f32_32x32x16_bf16 v[208:223], v[124:127], a[28:31], v[208:223]
    v_add_f32 v24, v24, v25
    v_add_f32 v26, v26, v27
    v_mov_b32 v22, v24
    v_mov_b32 v23, v24
    s_nop 0
    s_nop 0
    v_permlane32_swap_b32 v22, v23
    v_add_f32 v24, v22, v23
    v_mov_b32 v22, v26
    v_mov_b32 v23, v26
    s_nop 0
    s_nop 0
    v_permlane32_swap_b32 v22, v23
    v_add_f32 v26, v22, v23
    v_mul_f32 v24, 0xbacccccd, v24
    v_mul_f32 v26, 0x3acccccd, v26
    v_fma_f32 v26, -v24, v24, v26
    v_max_f32 v26, 0, v26
    v_add_f32 v26, 0x3727c5ac, v26
    v_rsq_f32 v29, v26
    v_lshl_add_u32 v28, v2, 2, s25
    ds_write_b32 v28, v29
    v_lshl_add_u32 v28, v3, 4, s25
    s_waitcnt lgkmcnt(0)
    ds_read_b128 v[96:99], v28 offset:0
    ds_read_b128 v[100:103], v28 offset:32
    ds_read_b128 v[104:107], v28 offset:64
    ds_read_b128 v[108:111], v28 offset:96
    v_and_b32 v22, 1, v2
    v_lshlrev_b32 v22, 31, v22
    v_or_b32 v22, 1.0, v22
    s_lshl_b32 s24, s3, 12
    s_add_u32 s24, s24, 0
    v_lshl_add_u32 v26, v2, 2, s24
    v_lshl_add_u32 v26, v3, 9, v26
    s_lshl_b32 s24, s3, 10
    s_add_u32 s24, s24, 0
    v_lshl_add_u32 v27, v1, 2, s24
    s_mul_i32 s27, s16, 5120
    s_lshl_b32 s24, s17, 9
    s_add_u32 s27, s27, s24
    s_mul_i32 s24, s3, 655360
    s_add_u32 s27, s27, s24
    s_add_u32 s27, s27, 7340032
    v_mul_u32_u24 v29, 81920, v3
    v_lshl_add_u32 v29, v2, 4, v29
    s_lshl_b32 s29, s17, 4
    s_add_u32 s29, s29, s16
    s_lshl_b32 s29, s29, 7
    v_pk_fma_f32 v[64:65], v[192:193], v[22:23], v[64:65] op_sel_hi:[1,0,1]
    v_pk_fma_f32 v[66:67], v[194:195], v[22:23], v[66:67] op_sel_hi:[1,0,1]
    v_pk_fma_f32 v[68:69], v[196:197], v[22:23], v[68:69] op_sel_hi:[1,0,1]
    v_pk_fma_f32 v[70:71], v[198:199], v[22:23], v[70:71] op_sel_hi:[1,0,1]
    v_pk_fma_f32 v[72:73], v[200:201], v[22:23], v[72:73] op_sel_hi:[1,0,1]
    v_pk_fma_f32 v[74:75], v[202:203], v[22:23], v[74:75] op_sel_hi:[1,0,1]
    v_pk_fma_f32 v[76:77], v[204:205], v[22:23], v[76:77] op_sel_hi:[1,0,1]
    v_pk_fma_f32 v[78:79], v[206:207], v[22:23], v[78:79] op_sel_hi:[1,0,1]
    v_pk_fma_f32 v[80:81], v[208:209], v[22:23], v[80:81] op_sel_hi:[1,0,1]
    v_pk_fma_f32 v[82:83], v[210:211], v[22:23], v[82:83] op_sel_hi:[1,0,1]
    v_pk_fma_f32 v[84:85], v[212:213], v[22:23], v[84:85] op_sel_hi:[1,0,1]
    v_pk_fma_f32 v[86:87], v[214:215], v[22:23], v[86:87] op_sel_hi:[1,0,1]
    v_pk_fma_f32 v[88:89], v[216:217], v[22:23], v[88:89] op_sel_hi:[1,0,1]
    v_pk_fma_f32 v[90:91], v[218:219], v[22:23], v[90:91] op_sel_hi:[1,0,1]
    v_pk_fma_f32 v[92:93], v[220:221], v[22:23], v[92:93] op_sel_hi:[1,0,1]
    v_pk_fma_f32 v[94:95], v[222:223], v[22:23], v[94:95] op_sel_hi:[1,0,1]
    s_cmp_lg_u32 s3, 3
    s_cbranch_scc1 Lw_prompt_8
    s_waitcnt vmcnt(0)
    v_cmp_gt_u32 vcc, 16, v0
    s_cbranch_vccz Lq_prompt_7
    s_mov_b32 s21, 0
    s_mov_b32 s66, 0
Lp_prompt_9:
    buffer_load_dword v0, v30, s[8:11], s21 offen sc1
    s_add_u32 s66, s66, 1
    s_waitcnt vmcnt(0)
    v_cmp_gt_u32 vcc, 16, v0
    s_cbranch_vccz Lq_prompt_7
    s_cmp_lt_u32 s66, 0x40000
    s_cbranch_scc0 Lq_prompt_7
    s_sleep 4
    s_branch Lp_prompt_9
Lq_prompt_7:
Lw_prompt_8:
    s_cmp_lg_u32 s3, 3
    s_cbranch_scc1 Lw_prompt_10
    v_mov_b32 v0, 0
    s_add_u32 s21, s64, 35652736
    buffer_load_dword v0, v30, s[4:7], s21 offen sc1
Lw_prompt_10:
    s_mov_b32 s15, s29
    s_waitcnt lgkmcnt(0)
    v_pk_mul_f32 v[64:65], v[64:65], v[96:97]
    v_pk_mul_f32 v[66:67], v[66:67], v[98:99]
    v_pk_mul_f32 v[68:69], v[68:69], v[100:101]
    v_pk_mul_f32 v[70:71], v[70:71], v[102:103]
    v_pk_mul_f32 v[72:73], v[72:73], v[104:105]
    v_pk_mul_f32 v[74:75], v[74:75], v[106:107]
    v_pk_mul_f32 v[76:77], v[76:77], v[108:109]
    v_pk_mul_f32 v[78:79], v[78:79], v[110:111]
    v_pk_mul_f32 v[80:81], v[80:81], v[96:97]
    v_pk_mul_f32 v[82:83], v[82:83], v[98:99]
    v_pk_mul_f32 v[84:85], v[84:85], v[100:101]
    v_pk_mul_f32 v[86:87], v[86:87], v[102:103]
    v_pk_mul_f32 v[88:89], v[88:89], v[104:105]
    v_pk_mul_f32 v[90:91], v[90:91], v[106:107]
    v_pk_mul_f32 v[92:93], v[92:93], v[108:109]
    v_pk_mul_f32 v[94:95], v[94:95], v[110:111]
    v_cvt_pk_bf16_f32 v112, v64, v65
    v_cvt_pk_bf16_f32 v113, v66, v67
    v_cvt_pk_bf16_f32 v114, v68, v69
    v_cvt_pk_bf16_f32 v115, v70, v71
    v_cvt_pk_bf16_f32 v116, v72, v73
    v_cvt_pk_bf16_f32 v117, v74, v75
    v_cvt_pk_bf16_f32 v118, v76, v77
    v_cvt_pk_bf16_f32 v119, v78, v79
    v_mfma_f32_32x32x16_bf16 v[128:143], v[32:35], v[112:115], 0
    v_mfma_f32_32x32x16_bf16 v[144:159], v[40:43], v[112:115], 0
    v_mfma_f32_32x32x16_bf16 v[128:143], v[36:39], v[116:119], v[128:143]
    v_mfma_f32_32x32x16_bf16 v[144:159], v[44:47], v[116:119], v[144:159]
    v_cvt_pk_bf16_f32 v120, v80, v81
    v_cvt_pk_bf16_f32 v121, v82, v83
    v_cvt_pk_bf16_f32 v122, v84, v85
    v_cvt_pk_bf16_f32 v123, v86, v87
    v_cvt_pk_bf16_f32 v124, v88, v89
    v_cvt_pk_bf16_f32 v125, v90, v91
    v_cvt_pk_bf16_f32 v126, v92, v93
    v_cvt_pk_bf16_f32 v127, v94, v95
    v_mfma_f32_32x32x16_bf16 v[128:143], v[40:43], v[120:123], v[128:143]
    v_mfma_f32_32x32x16_bf16 v[144:159], v[48:51], v[120:123], v[144:159]
    v_mfma_f32_32x32x16_bf16 v[128:143], v[44:47], v[124:127], v[128:143]
    v_mfma_f32_32x32x16_bf16 v[144:159], v[52:55], v[124:127], v[144:159]
    s_barrier
    s_nop 10
    v_cvt_pk_bf16_f32 v160, v128, v144
    ds_write_b32 v26, v160 offset:0
    v_cvt_pk_bf16_f32 v161, v129, v145
    ds_write_b32 v26, v161 offset:128
    v_cvt_pk_bf16_f32 v162, v130, v146
    ds_write_b32 v26, v162 offset:256
    v_cvt_pk_bf16_f32 v163, v131, v147
    ds_write_b32 v26, v163 offset:384
    v_cvt_pk_bf16_f32 v164, v132, v148
    ds_write_b32 v26, v164 offset:1024
    v_cvt_pk_bf16_f32 v165, v133, v149
    ds_write_b32 v26, v165 offset:1152
    v_cvt_pk_bf16_f32 v166, v134, v150
    ds_write_b32 v26, v166 offset:1280
    v_cvt_pk_bf16_f32 v167, v135, v151
    ds_write_b32 v26, v167 offset:1408
    v_cvt_pk_bf16_f32 v168, v136, v152
    ds_write_b32 v26, v168 offset:2048
    v_cvt_pk_bf16_f32 v169, v137, v153
    ds_write_b32 v26, v169 offset:2176
    v_cvt_pk_bf16_f32 v170, v138, v154
    ds_write_b32 v26, v170 offset:2304
    v_cvt_pk_bf16_f32 v171, v139, v155
    ds_write_b32 v26, v171 offset:2432
    v_cvt_pk_bf16_f32 v172, v140, v156
    ds_write_b32 v26, v172 offset:3072
    v_cvt_pk_bf16_f32 v173, v141, v157
    ds_write_b32 v26, v173 offset:3200
    v_cvt_pk_bf16_f32 v174, v142, v158
    ds_write_b32 v26, v174 offset:3328
    v_cvt_pk_bf16_f32 v175, v143, v159
    ds_write_b32 v26, v175 offset:3456
    s_cmp_lg_u32 s3, 3
    s_cbranch_scc1 Lw_prompt_12
    s_waitcnt vmcnt(0)
    v_cmp_gt_u32 vcc, 12, v0
    s_cbranch_vccz Lq_prompt_11
    s_add_u32 s21, s64, 35652736
    s_mov_b32 s66, 0
Lp_prompt_13:
    buffer_load_dword v0, v30, s[4:7], s21 offen sc1
    s_add_u32 s66, s66, 1
    s_waitcnt vmcnt(0)
    v_cmp_gt_u32 vcc, 12, v0
    s_cbranch_vccz Lq_prompt_11
    s_cmp_lt_u32 s66, 0x40000
    s_cbranch_scc0 Lq_prompt_11
    s_sleep 4
    s_branch Lp_prompt_13
Lq_prompt_11:
Lw_prompt_12:
    s_waitcnt lgkmcnt(0)
    s_barrier
    ds_read2st64_b32 v[176:177], v27 offset0:0 offset1:16
    ds_read2st64_b32 v[178:179], v27 offset0:32 offset1:48
    ds_read2st64_b32 v[180:181], v27 offset0:1 offset1:17
    ds_read2st64_b32 v[182:183], v27 offset0:33 offset1:49
    ds_read2st64_b32 v[184:185], v27 offset0:2 offset1:18
    ds_read2st64_b32 v[186:187], v27 offset0:34 offset1:50
    ds_read2st64_b32 v[188:189], v27 offset0:3 offset1:19
    ds_read2st64_b32 v[190:191], v27 offset0:35 offset1:51
    s_waitcnt lgkmcnt(6)
    s_add_u32 s21, s27, 0
    buffer_store_dwordx4 v[176:179], v29, s[4:7], s21 offen sc1
    s_waitcnt lgkmcnt(4)
    s_add_u32 s21, s27, 163840
    buffer_store_dwordx4 v[180:183], v29, s[4:7], s21 offen sc1
    s_waitcnt lgkmcnt(2)
    s_add_u32 s21, s27, 327680
    buffer_store_dwordx4 v[184:187], v29, s[4:7], s21 offen sc1
    s_waitcnt lgkmcnt(0)
    s_add_u32 s21, s27, 491520
    buffer_store_dwordx4 v[188:191], v29, s[4:7], s21 offen sc1
    s_sub_u32 s23, s17, 10
    s_lshl_b32 s23, s23, 1
    s_add_u32 s23, s23, s3
    s_sub_u32 s23, 39, s23
    s_cmp_ge_u32 s3, 2
    s_cselect_b32 s23, 40, s23
    s_cmp_eq_u32 s17, 15
    s_cselect_b32 s23, 40, s23
    s_sub_u32 s24, 19, s17
    s_cmp_eq_u32 s3, 1
    s_cselect_b32 s22, s24, s17
    s_add_u32 s24, s17, 20
    s_cmp_eq_u32 s3, 2
    s_cselect_b32 s22, s24, s22
    s_cmp_eq_u32 s3, 3
    s_cselect_b32 s22, 40, s22
    s_cmp_ge_u32 s17, 10
    s_cselect_b32 s22, s23, s22
    s_cmp_ge_u32 s22, 40
    s_cbranch_scc1 Lp2l_prompt_14
    s_cmp_ge_u32 s22, 20
    s_cselect_b32 s23, s19, s18
    s_cselect_b32 s24, 20, 0
    s_sub_u32 s24, s22, s24
    s_lshl_b32 s27, s23, 13
    s_add_u32 s27, s27, 6291456
    s_add_u32 s28, s27, 262144
    buffer_load_dwordx4 v[64:67], v4, s[4:7], s27 offen sc1
    buffer_load_dwordx4 v[96:99], v4, s[4:7], s28 offen sc1
    buffer_load_dwordx4 v[68:71], v4, s[4:7], s27 offen offset:1024 sc1
    buffer_load_dwordx4 v[100:103], v4, s[4:7], s28 offen offset:1024 sc1
    buffer_load_dwordx4 v[72:75], v4, s[4:7], s27 offen offset:2048 sc1
    buffer_load_dwordx4 v[104:107], v4, s[4:7], s28 offen offset:2048 sc1
    buffer_load_dwordx4 v[76:79], v4, s[4:7], s27 offen offset:3072 sc1
    buffer_load_dwordx4 v[108:111], v4, s[4:7], s28 offen offset:3072 sc1
    s_add_u32 s21, s27, 4096
    buffer_load_dwordx4 v[80:83], v4, s[4:7], s21 offen sc1
    s_add_u32 s29, s28, 4096
    buffer_load_dwordx4 v[112:115], v4, s[4:7], s29 offen sc1
    buffer_load_dwordx4 v[84:87], v4, s[4:7], s21 offen offset:1024 sc1
    buffer_load_dwordx4 v[116:119], v4, s[4:7], s29 offen offset:1024 sc1
    buffer_load_dwordx4 v[88:91], v4, s[4:7], s21 offen offset:2048 sc1
    buffer_load_dwordx4 v[120:123], v4, s[4:7], s29 offen offset:2048 sc1
    buffer_load_dwordx4 v[92:95], v4, s[4:7], s21 offen offset:3072 sc1
    buffer_load_dwordx4 v[124:127], v4, s[4:7], s29 offen offset:3072 sc1
    s_mov_b32 s8, s32
    s_mov_b32 s9, s33
    s_mov_b32 s10, 2621440
    s_mov_b32 s11, 0x20000
    v_lshl_add_u32 v7, v2, 6, s23
    v_mul_u32_u24 v7, 1280, v7
    v_lshl_add_u32 v7, v3, 4, v7
    s_lshl_b32 s30, s24, 6
    s_add_u32 s31, s30, 40960
    buffer_load_dwordx4 v[128:131], v7, s[8:11], s30 offen offset:0
    buffer_load_dwordx4 v[132:135], v7, s[8:11], s30 offen offset:32
    buffer_load_dwordx4 v[136:139], v7, s[8:11], s31 offen offset:0
    buffer_load_dwordx4 v[140:143], v7, s[8:11], s31 offen offset:32
    s_sub_u32 s25, 32, s23
    s_and_b32 s25, s25, 31
    s_cmp_ge_u32 s24, 10
    s_cselect_b32 s25, s25, s23
    s_cselect_b32 s26, 0x80000000, 0
    s_cselect_b64 s[60:61], -1, 0
    s_lshl_b32 s30, s24, 5
    v_add_u32 v5, s30, v2
    v_sub_u32 v6, 640, v5
    v_cmp_eq_u32 vcc, 320, v6
    s_nop 1
    v_cndmask_b32 v6, v6, 0, vcc
    v_cndmask_b32 v6, v5, v6, s[60:61]
    v_lshlrev_b32 v6, 4, v6
    v_mul_u32_u24 v7, 5120, v3
    v_add_u32 v6, v6, v7
    v_cmp_eq_u32 vcc, 0, v5
    v_mov_b32 v7, 0x7ff00000
    s_nop 0
    v_cndmask_b32 v6, v6, v7, vcc
    s_mul_i32 s25, s25, 81920
    s_add_u32 s25, s25, 7340032
    s_mul_i32 s62, s23, 40960
    s_lshl_b32 s31, s24, 10
    s_add_u32 s62, s62, s31
    v_bfe_u32 v10, v1, 4, 1
    v_mul_u32_u24 v10, 20480, v10
    v_and_b32 v11, 15, v1
    v_lshl_add_u32 v10, v11, 4, v10
    v_lshl_add_u32 v10, v3, 8, v10
    s_add_u32 s62, s62, 13631488
    s_add_u32 s63, s62, 1310720
    s_mul_i32 s28, s23, 5120
    s_lshl_b32 s27, s24, 8
    s_add_u32 s28, s28, s27
    s_add_u32 s28, s28, 36569088
    v_mul_u32_u24 v7, 163840, v3
    v_lshl_add_u32 v7, v2, 3, v7
    s_mov_b32 s27, 0x3f803f80
    s_waitcnt vmcnt(20)
    s_branch Lp2e_prompt_15
Lp2l_prompt_14:
    s_waitcnt vmcnt(0)
Lp2e_prompt_15:
    s_barrier
    s_cmp_lg_u32 s3, 0
    s_cbranch_scc1 Lw_prompt_16
    s_add_u32 s21, s15, 37748736
    s_mov_b64 exec, 1
    buffer_store_dword v31, v30, s[4:7], s21 offen sc1
    s_mov_b64 exec, -1
Lw_prompt_16:
    s_branch L_p1_done
L_prep:
    s_mov_b32 s8, s52
    s_mov_b32 s9, s53
    s_mov_b32 s10, 256
    s_mov_b32 s11, 0x20000
    s_cmp_lg_u32 s17, 15
    s_cbranch_scc1 Lz_prompt_17
    s_cmp_lg_u32 s3, 3
    s_cbranch_scc1 Lz_prompt_17
    v_mov_b32 v8, 0
    v_mov_b32 v9, 0
    v_mov_b32 v10, 0
    v_mov_b32 v11, 0
    s_add_u32 s27, s64, 35651584
    buffer_store_dwordx4 v[8:11], v4, s[4:7], s27 offen offset:0 sc1
    buffer_store_dwordx4 v[8:11], v4, s[4:7], s27 offen offset:1024 sc1
    s_mul_i32 s27, s16, 128
    s_add_u32 s27, s27, 37748736
    v_mul_u32_u24 v9, 2048, v1
    s_mov_b64 exec, 0xfffff
    buffer_store_dword v8, v9, s[4:7], s27 offen sc1
    s_waitcnt vmcnt(0)
    s_mov_b64 exec, 1
    buffer_atomic_add v31, v30, s[8:11], 0 offen sc1
    s_mov_b64 exec, -1
Lz_prompt_17:
    s_mul_i32 s22, s16, 6
    s_add_u32 s22, s22, s17
    s_sub_u32 s22, s22, 10
    s_cmp_ge_u32 s22, 48
    s_cselect_b32 s12, s46, s44
    s_cselect_b32 s13, s47, s45
    s_cselect_b32 s23, 1, 0
    s_cselect_b32 s24, 48, 0
    s_sub_u32 s24, s22, s24
    s_and_b32 s31, s24, 1
    s_lshr_b32 s24, s24, 1
    s_mov_b32 s14, 1966080
    s_mov_b32 s15, 0x20000
    v_lshrrev_b32 v5, 3, v1
    v_mul_u32_u24 v5, 3072, v5
    v_and_b32 v6, 7, v1
    v_lshl_add_u32 v5, v6, 4, v5
    s_lshl_b32 s25, s31, 1
    s_add_u32 s25, s25, s3
    s_mul_i32 s25, s25, 491520
    s_lshl_b32 s26, s24, 7
    s_add_u32 s25, s25, s26
    s_mul_i32 s26, s3, 20480
    s_lshr_b32 s44, s22, 1
    s_and_b32 s45, s22, 1
    s_lshl_b32 s45, s45, 1
    s_and_b32 s28, s3, 1
    s_add_u32 s46, s45, s28
    s_mul_i32 s47, s28, 10240
    s_add_u32 s47, s47, 40960
    s_mov_b32 s36, s48
    s_mov_b32 s37, s49
    s_mov_b32 s38, 1966080
    s_mov_b32 s39, 0x20000
    v_lshrrev_b32 v20, 2, v1
    v_mul_u32_u24 v20, 1280, v20
    v_and_b32 v21, 3, v1
    v_lshl_add_u32 v20, v21, 4, v20
    s_cmp_ge_u32 s3, 2
    s_cbranch_scc1 Lm_prompt_18
    s_mul_i32 s27, s44, 40960
    s_mul_i32 s28, s46, 320
    s_add_u32 s27, s27, s28
    s_add_u32 m0, s26, 0
    s_add_u32 s21, s25, 0
    buffer_load_dwordx4 v5, s[12:15], s21 offen nt lds
    s_add_u32 m0, s26, 1024
    s_add_u32 s21, s25, 24576
    buffer_load_dwordx4 v5, s[12:15], s21 offen nt lds
    s_add_u32 m0, s26, 2048
    s_add_u32 s21, s25, 49152
    buffer_load_dwordx4 v5, s[12:15], s21 offen nt lds
    s_add_u32 m0, s26, 3072
    s_add_u32 s21, s25, 73728
    buffer_load_dwordx4 v5, s[12:15], s21 offen nt lds
    s_add_u32 m0, s26, 4096
    s_add_u32 s21, s25, 98304
    buffer_load_dwordx4 v5, s[12:15], s21 offen nt lds
    s_add_u32 m0, s26, 5120
    s_add_u32 s21, s25, 122880
    buffer_load_dwordx4 v5, s[12:15], s21 offen nt lds
    s_add_u32 m0, s26, 6144
    s_add_u32 s21, s25, 147456
    buffer_load_dwordx4 v5, s[12:15], s21 offen nt lds
    s_add_u32 m0, s26, 7168
    s_add_u32 s21, s25, 172032
    buffer_load_dwordx4 v5, s[12:15], s21 offen nt lds
    s_add_u32 m0, s26, 8192
    s_add_u32 s21, s25, 196608
    buffer_load_dwordx4 v5, s[12:15], s21 offen nt lds
    s_add_u32 m0, s26, 9216
    s_add_u32 s21, s25, 221184
    buffer_load_dwordx4 v5, s[12:15], s21 offen nt lds
    s_add_u32 m0, s26, 10240
    s_add_u32 s21, s25, 245760
    buffer_load_dwordx4 v5, s[12:15], s21 offen nt lds
    s_add_u32 m0, s26, 11264
    s_add_u32 s21, s25, 270336
    buffer_load_dwordx4 v5, s[12:15], s21 offen nt lds
    s_add_u32 m0, s26, 12288
    s_add_u32 s21, s25, 294912
    buffer_load_dwordx4 v5, s[12:15], s21 offen nt lds
    s_add_u32 m0, s26, 13312
    s_add_u32 s21, s25, 319488
    buffer_load_dwordx4 v5, s[12:15], s21 offen nt lds
    s_add_u32 m0, s26, 14336
    s_add_u32 s21, s25, 344064
    buffer_load_dwordx4 v5, s[12:15], s21 offen nt lds
    s_add_u32 m0, s26, 15360
    s_add_u32 s21, s25, 368640
    buffer_load_dwordx4 v5, s[12:15], s21 offen nt lds
    s_add_u32 m0, s26, 16384
    s_add_u32 s21, s25, 393216
    buffer_load_dwordx4 v5, s[12:15], s21 offen nt lds
    s_add_u32 m0, s26, 17408
    s_add_u32 s21, s25, 417792
    buffer_load_dwordx4 v5, s[12:15], s21 offen nt lds
    s_add_u32 m0, s26, 18432
    s_add_u32 s21, s25, 442368
    buffer_load_dwordx4 v5, s[12:15], s21 offen nt lds
    s_add_u32 m0, s26, 19456
    s_add_u32 s21, s25, 466944
    buffer_load_dwordx4 v5, s[12:15], s21 offen nt lds
    s_add_u32 m0, s47, 0
    s_add_u32 s21, s27, 0
    buffer_load_dwordx4 v20, s[36:39], s21 offen lds
    s_add_u32 m0, s47, 1024
    s_add_u32 s21, s27, 20480
    buffer_load_dwordx4 v20, s[36:39], s21 offen lds
    s_add_u32 m0, s47, 2048
    s_add_u32 s21, s27, 64
    buffer_load_dwordx4 v20, s[36:39], s21 offen lds
    s_add_u32 m0, s47, 3072
    s_add_u32 s21, s27, 20544
    buffer_load_dwordx4 v20, s[36:39], s21 offen lds
    s_add_u32 m0, s47, 4096
    s_add_u32 s21, s27, 128
    buffer_load_dwordx4 v20, s[36:39], s21 offen lds
    s_add_u32 m0, s47, 5120
    s_add_u32 s21, s27, 20608
    buffer_load_dwordx4 v20, s[36:39], s21 offen lds
    s_add_u32 m0, s47, 6144
    s_add_u32 s21, s27, 192
    buffer_load_dwordx4 v20, s[36:39], s21 offen lds
    s_add_u32 m0, s47, 7168
    s_add_u32 s21, s27, 20672
    buffer_load_dwordx4 v20, s[36:39], s21 offen lds
    s_add_u32 m0, s47, 8192
    s_add_u32 s21, s27, 256
    buffer_load_dwordx4 v20, s[36:39], s21 offen lds
    s_add_u32 m0, s47, 9216
    s_add_u32 s21, s27, 20736
    buffer_load_dwordx4 v20, s[36:39], s21 offen lds
    s_waitcnt vmcnt(10)
    s_branch Lj_prompt_19
Lm_prompt_18:
    s_sub_u32 s27, s17, 10
    s_lshl_b32 s27, s27, 1
    s_add_u32 s27, s27, s28
    s_mul_i32 s27, s27, 3
    s_add_u32 s28, s27, 0
    s_cmp_ge_u32 s28, 32
    s_cbranch_scc1 Lm2_prompt_20
    s_bitcmp1_b32 s28, 4
    s_cselect_b32 s29, s19, s18
    s_and_b32 s30, s28, 8
    s_lshl_b32 s30, s30, 2
    s_add_u32 s29, s29, s30
    s_and_b32 s28, s28, 7
    s_lshl_b32 s30, s28, 1
    v_lshl_add_u32 v8, v2, 6, s29
    v_add_u32 v9, s30, v3
    v_sub_u32 v10, 32, v9
    v_cmp_eq_u32 vcc, 0, v9
    v_mov_b32 v11, 16
    s_nop 0
    v_cndmask_b32 v10, v10, v11, vcc
    v_mul_u32_u24 v12, v8, v9
    v_mul_u32_u24 v14, v8, v10
    v_lshl_add_u32 v13, v8, 5, v12
    v_lshl_add_u32 v15, v8, 5, v14
    v_and_b32 v12, 2047, v12
    v_cvt_f32_u32 v12, v12
    v_mul_f32 v12, 0x3a000000, v12
    v_cos_f32 v22, v12
    v_sin_f32 v23, -v12
    s_nop 0
    v_cvt_pk_bf16_f32 v96, v22, v23
    v_and_b32 v13, 2047, v13
    v_cvt_f32_u32 v13, v13
    v_mul_f32 v13, 0x3a000000, v13
    v_cos_f32 v22, v13
    v_sin_f32 v23, -v13
    s_nop 0
    v_cvt_pk_bf16_f32 v97, v22, v23
    v_and_b32 v14, 2047, v14
    v_cvt_f32_u32 v14, v14
    v_mul_f32 v14, 0x3a000000, v14
    v_cos_f32 v22, v14
    v_sin_f32 v23, -v14
    s_nop 0
    v_cvt_pk_bf16_f32 v98, v22, v23
    v_and_b32 v15, 2047, v15
    v_cvt_f32_u32 v15, v15
    v_mul_f32 v15, 0x3a000000, v15
    v_cos_f32 v22, v15
    v_sin_f32 v23, -v15
    s_nop 0
    v_cvt_pk_bf16_f32 v99, v22, v23
    s_lshl_b32 s29, s29, 3
    s_add_u32 s28, s28, s29
    s_lshl_b32 s28, s28, 10
    s_add_u32 s28, s28, 6291456
    buffer_store_dwordx4 v[96:99], v4, s[4:7], s28 offen sc1
Lm2_prompt_20:
    s_add_u32 s28, s27, 1
    s_cmp_ge_u32 s28, 32
    s_cbranch_scc1 Lm2_prompt_21
    s_bitcmp1_b32 s28, 4
    s_cselect_b32 s29, s19, s18
    s_and_b32 s30, s28, 8
    s_lshl_b32 s30, s30, 2
    s_add_u32 s29, s29, s30
    s_and_b32 s28, s28, 7
    s_lshl_b32 s30, s28, 1
    v_lshl_add_u32 v8, v2, 6, s29
    v_add_u32 v9, s30, v3
    v_sub_u32 v10, 32, v9
    v_cmp_eq_u32 vcc, 0, v9
    v_mov_b32 v11, 16
    s_nop 0
    v_cndmask_b32 v10, v10, v11, vcc
    v_mul_u32_u24 v12, v8, v9
    v_mul_u32_u24 v14, v8, v10
    v_lshl_add_u32 v13, v8, 5, v12
    v_lshl_add_u32 v15, v8, 5, v14
    v_and_b32 v12, 2047, v12
    v_cvt_f32_u32 v12, v12
    v_mul_f32 v12, 0x3a000000, v12
    v_cos_f32 v22, v12
    v_sin_f32 v23, -v12
    s_nop 0
    v_cvt_pk_bf16_f32 v100, v22, v23
    v_and_b32 v13, 2047, v13
    v_cvt_f32_u32 v13, v13
    v_mul_f32 v13, 0x3a000000, v13
    v_cos_f32 v22, v13
    v_sin_f32 v23, -v13
    s_nop 0
    v_cvt_pk_bf16_f32 v101, v22, v23
    v_and_b32 v14, 2047, v14
    v_cvt_f32_u32 v14, v14
    v_mul_f32 v14, 0x3a000000, v14
    v_cos_f32 v22, v14
    v_sin_f32 v23, -v14
    s_nop 0
    v_cvt_pk_bf16_f32 v102, v22, v23
    v_and_b32 v15, 2047, v15
    v_cvt_f32_u32 v15, v15
    v_mul_f32 v15, 0x3a000000, v15
    v_cos_f32 v22, v15
    v_sin_f32 v23, -v15
    s_nop 0
    v_cvt_pk_bf16_f32 v103, v22, v23
    s_lshl_b32 s29, s29, 3
    s_add_u32 s28, s28, s29
    s_lshl_b32 s28, s28, 10
    s_add_u32 s28, s28, 6291456
    buffer_store_dwordx4 v[100:103], v4, s[4:7], s28 offen sc1
Lm2_prompt_21:
    s_add_u32 s28, s27, 2
    s_cmp_ge_u32 s28, 32
    s_cbranch_scc1 Lm2_prompt_22
    s_bitcmp1_b32 s28, 4
    s_cselect_b32 s29, s19, s18
    s_and_b32 s30, s28, 8
    s_lshl_b32 s30, s30, 2
    s_add_u32 s29, s29, s30
    s_and_b32 s28, s28, 7
    s_lshl_b32 s30, s28, 1
    v_lshl_add_u32 v8, v2, 6, s29
    v_add_u32 v9, s30, v3
    v_sub_u32 v10, 32, v9
    v_cmp_eq_u32 vcc, 0, v9
    v_mov_b32 v11, 16
    s_nop 0
    v_cndmask_b32 v10, v10, v11, vcc
    v_mul_u32_u24 v12, v8, v9
    v_mul_u32_u24 v14, v8, v10
    v_lshl_add_u32 v13, v8, 5, v12
    v_lshl_add_u32 v15, v8, 5, v14
    v_and_b32 v12, 2047, v12
    v_cvt_f32_u32 v12, v12
    v_mul_f32 v12, 0x3a000000, v12
    v_cos_f32 v22, v12
    v_sin_f32 v23, -v12
    s_nop 0
    v_cvt_pk_bf16_f32 v104, v22, v23
    v_and_b32 v13, 2047, v13
    v_cvt_f32_u32 v13, v13
    v_mul_f32 v13, 0x3a000000, v13
    v_cos_f32 v22, v13
    v_sin_f32 v23, -v13
    s_nop 0
    v_cvt_pk_bf16_f32 v105, v22, v23
    v_and_b32 v14, 2047, v14
    v_cvt_f32_u32 v14, v14
    v_mul_f32 v14, 0x3a000000, v14
    v_cos_f32 v22, v14
    v_sin_f32 v23, -v14
    s_nop 0
    v_cvt_pk_bf16_f32 v106, v22, v23
    v_and_b32 v15, 2047, v15
    v_cvt_f32_u32 v15, v15
    v_mul_f32 v15, 0x3a000000, v15
    v_cos_f32 v22, v15
    v_sin_f32 v23, -v15
    s_nop 0
    v_cvt_pk_bf16_f32 v107, v22, v23
    s_lshl_b32 s29, s29, 3
    s_add_u32 s28, s28, s29
    s_lshl_b32 s28, s28, 10
    s_add_u32 s28, s28, 6291456
    buffer_store_dwordx4 v[104:107], v4, s[4:7], s28 offen sc1
Lm2_prompt_22:
    s_mov_b32 s21, 0
    s_mov_b32 s66, 0
Lp_prompt_24:
    buffer_load_dword v0, v30, s[8:11], s21 offen sc1
    s_add_u32 s66, s66, 1
    s_waitcnt vmcnt(0)
    v_cmp_gt_u32 vcc, 16, v0
    s_cbranch_vccz Lq_prompt_23
    s_cmp_lt_u32 s66, 0x40000
    s_cbranch_scc0 Lq_prompt_23
    s_sleep 4
    s_branch Lp_prompt_24
Lq_prompt_23:
    s_add_u32 s21, s64, 35652736
    s_mov_b64 exec, 1
    buffer_atomic_add v31, v30, s[4:7], s21 offen sc1
    s_mov_b64 exec, -1
    s_and_b32 s28, s3, 1
    s_getpc_b64 s[60:61]
L_pc:
    s_sub_u32 s60, s60, L_pc-interleave_layers__spectral_fnet__glu_gated_glu__prompt_kernel
    s_subb_u32 s61, s61, 0
    s_and_b32 s62, s16, 3
    s_mul_i32 s62, s62, 3
    s_lshr_b32 s63, s17, 1
    s_add_u32 s62, s62, s63
    s_sub_u32 s62, s62, 5
    s_lshl_b32 s62, s62, 1
    s_add_u32 s62, s62, s28
    s_mul_i32 s62, s62, 3072
    v_add_u32 v8, s62, v4
    s_mov_b32 s62, L_codeend-interleave_layers__spectral_fnet__glu_gated_glu__prompt_kernel
    s_mov_b32 s63, 0x20000
    buffer_load_dwordx4 v[200:203], v8, s[60:63], 0 offen offset:0
    buffer_load_dwordx4 v[204:207], v8, s[60:63], 0 offen offset:1024
    buffer_load_dwordx4 v[208:211], v8, s[60:63], 0 offen offset:2048
Lj_prompt_19:
    v_bfe_u32 v6, v1, 2, 2
    v_bfe_u32 v7, v1, 4, 1
    v_lshl_add_u32 v6, v7, 2, v6
    v_lshl_add_u32 v6, v3, 4, v6
    v_lshlrev_b32 v6, 7, v6
    v_and_b32 v7, 3, v1
    v_lshl_add_u32 v6, v7, 3, v6
    s_lshl_b32 s27, s3, 5
    v_add_u32 v6, s27, v6
    s_mov_b32 s29, 0x3f803f80
    v_mov_b32 v8, 0
    s_lshl_b32 s30, s24, 1
    s_lshr_b32 s27, s3, 1
    s_add_u32 s30, s30, s27
    s_mul_i32 s27, s30, 43
    s_lshr_b32 s27, s27, 7
    s_mul_i32 s28, s27, 3
    s_sub_u32 s28, s30, s28
    s_mul_i32 s27, s27, 252
    s_lshl_b32 s30, s23, 1
    s_add_u32 s27, s27, s30
    s_and_b32 s30, s3, 1
    s_add_u32 s27, s27, s30
    s_mul_i32 s30, s28, 44
    s_add_u32 s30, s30, 40
    s_cmp_eq_u32 s28, 2
    s_cselect_b32 s30, 168, s30
    s_cselect_b32 s60, 1, s31
    s_add_u32 s62, s30, 80
    s_add_u32 s62, s62, s27
    s_lshl_b32 s62, s62, 10
    s_lshl_b32 s28, s28, 2
    s_cmp_eq_u32 s60, 0
    s_cselect_b32 s30, s28, s30
    s_cselect_b32 s61, 8, 4
    s_mul_i32 s28, s31, 10
    s_mul_i32 s28, s28, s61
    s_add_u32 s30, s30, s28
    s_add_u32 s30, s30, s27
    s_lshl_b32 s60, s30, 10
    s_lshl_b32 s61, s61, 10
    s_barrier
    ds_read_b64_tr_b16 v[32:33], v6 offset:0
    ds_read_b64_tr_b16 v[34:35], v6 offset:1024
    ds_read_b64_tr_b16 v[36:37], v6 offset:4096
    ds_read_b64_tr_b16 v[38:39], v6 offset:5120
    ds_read_b64_tr_b16 v[40:41], v6 offset:8192
    ds_read_b64_tr_b16 v[42:43], v6 offset:9216
    ds_read_b64_tr_b16 v[44:45], v6 offset:12288
    ds_read_b64_tr_b16 v[46:47], v6 offset:13312
    ds_read_b64_tr_b16 v[48:49], v6 offset:16384
    ds_read_b64_tr_b16 v[50:51], v6 offset:17408
    ds_read_b64_tr_b16 v[52:53], v6 offset:20480
    ds_read_b64_tr_b16 v[54:55], v6 offset:21504
    s_waitcnt lgkmcnt(10)
    buffer_store_dwordx4 v[32:35], v4, s[4:7], s60 offen sc1
    s_add_u32 s60, s60, s61
    v_dot2c_f32_bf16 v8, s29, v32
    v_dot2c_f32_bf16 v8, s29, v33
    v_dot2c_f32_bf16 v8, s29, v34
    v_dot2c_f32_bf16 v8, s29, v35
    s_waitcnt lgkmcnt(8)
    buffer_store_dwordx4 v[36:39], v4, s[4:7], s60 offen sc1
    s_add_u32 s60, s60, s61
    v_dot2c_f32_bf16 v8, s29, v36
    v_dot2c_f32_bf16 v8, s29, v37
    v_dot2c_f32_bf16 v8, s29, v38
    v_dot2c_f32_bf16 v8, s29, v39
    s_waitcnt lgkmcnt(6)
    buffer_store_dwordx4 v[40:43], v4, s[4:7], s60 offen sc1
    s_add_u32 s60, s60, s61
    v_dot2c_f32_bf16 v8, s29, v40
    v_dot2c_f32_bf16 v8, s29, v41
    v_dot2c_f32_bf16 v8, s29, v42
    v_dot2c_f32_bf16 v8, s29, v43
    s_waitcnt lgkmcnt(4)
    buffer_store_dwordx4 v[44:47], v4, s[4:7], s60 offen sc1
    s_add_u32 s60, s60, s61
    v_dot2c_f32_bf16 v8, s29, v44
    v_dot2c_f32_bf16 v8, s29, v45
    v_dot2c_f32_bf16 v8, s29, v46
    v_dot2c_f32_bf16 v8, s29, v47
    s_waitcnt lgkmcnt(2)
    buffer_store_dwordx4 v[48:51], v4, s[4:7], s60 offen sc1
    s_add_u32 s60, s60, s61
    v_dot2c_f32_bf16 v8, s29, v48
    v_dot2c_f32_bf16 v8, s29, v49
    v_dot2c_f32_bf16 v8, s29, v50
    v_dot2c_f32_bf16 v8, s29, v51
    ds_read_b64_tr_b16 v[56:57], v6 offset:24576
    ds_read_b64_tr_b16 v[58:59], v6 offset:25600
    ds_read_b64_tr_b16 v[60:61], v6 offset:28672
    ds_read_b64_tr_b16 v[62:63], v6 offset:29696
    ds_read_b64_tr_b16 v[64:65], v6 offset:32768
    ds_read_b64_tr_b16 v[66:67], v6 offset:33792
    ds_read_b64_tr_b16 v[68:69], v6 offset:36864
    ds_read_b64_tr_b16 v[70:71], v6 offset:37888
    s_waitcnt lgkmcnt(8)
    buffer_store_dwordx4 v[52:55], v4, s[4:7], s60 offen sc1
    s_add_u32 s60, s60, s61
    v_dot2c_f32_bf16 v8, s29, v52
    v_dot2c_f32_bf16 v8, s29, v53
    v_dot2c_f32_bf16 v8, s29, v54
    v_dot2c_f32_bf16 v8, s29, v55
    s_waitcnt lgkmcnt(6)
    buffer_store_dwordx4 v[56:59], v4, s[4:7], s60 offen sc1
    s_add_u32 s60, s60, s61
    v_dot2c_f32_bf16 v8, s29, v56
    v_dot2c_f32_bf16 v8, s29, v57
    v_dot2c_f32_bf16 v8, s29, v58
    v_dot2c_f32_bf16 v8, s29, v59
    s_waitcnt lgkmcnt(4)
    buffer_store_dwordx4 v[60:63], v4, s[4:7], s60 offen sc1
    s_add_u32 s60, s60, s61
    v_dot2c_f32_bf16 v8, s29, v60
    v_dot2c_f32_bf16 v8, s29, v61
    v_dot2c_f32_bf16 v8, s29, v62
    v_dot2c_f32_bf16 v8, s29, v63
    s_waitcnt lgkmcnt(2)
    buffer_store_dwordx4 v[64:67], v4, s[4:7], s60 offen sc1
    s_add_u32 s60, s60, s61
    v_dot2c_f32_bf16 v8, s29, v64
    v_dot2c_f32_bf16 v8, s29, v65
    v_dot2c_f32_bf16 v8, s29, v66
    v_dot2c_f32_bf16 v8, s29, v67
    s_waitcnt lgkmcnt(0)
    buffer_store_dwordx4 v[68:71], v4, s[4:7], s60 offen sc1
    s_add_u32 s60, s60, s61
    v_dot2c_f32_bf16 v8, s29, v68
    v_dot2c_f32_bf16 v8, s29, v69
    v_dot2c_f32_bf16 v8, s29, v70
    v_dot2c_f32_bf16 v8, s29, v71
    s_nop 2
    v_mov_b32 v12, v8
    v_mov_b32 v13, v8
    s_nop 0
    s_nop 0
    v_permlane16_swap_b32 v12, v13
    v_add_f32 v8, v12, v13
    v_mov_b32 v12, v8
    v_mov_b32 v13, v8
    s_nop 0
    s_nop 0
    v_permlane32_swap_b32 v12, v13
    v_add_f32 v8, v12, v13
    v_cvt_pk_bf16_f32 v16, v8, v8
    v_and_b32 v13, 0xffff0000, v16
    v_sub_f32 v13, v8, v13
    v_cvt_pk_bf16_f32 v17, v13, v30
    v_cmp_eq_u32 vcc, 0, v3
    v_mov_b32 v18, 0
    v_mov_b32 v19, 0
    v_cndmask_b32 v16, v18, v16, vcc
    v_cndmask_b32 v17, v18, v17, vcc
    v_bfe_u32 v14, v1, 4, 1
    v_cmp_eq_u32 vcc, s31, v14
    s_nop 0
    s_and_saveexec_b64 s[60:61], vcc
    buffer_store_dwordx4 v[16:19], v4, s[4:7], s62 offen sc1
    s_mov_b64 exec, -1
    s_cmp_ge_u32 s3, 2
    s_cbranch_scc1 Ld_prompt_25
    v_lshrrev_b32 v6, 2, v1
    v_lshlrev_b32 v6, 6, v6
    v_and_b32 v7, 3, v1
    v_lshl_add_u32 v6, v7, 3, v6
    v_add_u32 v6, s47, v6
    s_mul_i32 s27, s46, 491520
    s_mul_i32 s28, s44, 5120
    s_add_u32 s27, s27, s28
    s_add_u32 s27, s27, 4194304
    s_waitcnt vmcnt(11)
    ds_read_b64_tr_b16 v[112:113], v6 offset:0
    ds_read_b64_tr_b16 v[114:115], v6 offset:1024
    ds_read_b64_tr_b16 v[116:117], v6 offset:32
    ds_read_b64_tr_b16 v[118:119], v6 offset:1056
    ds_read_b64_tr_b16 v[120:121], v6 offset:2048
    ds_read_b64_tr_b16 v[122:123], v6 offset:3072
    ds_read_b64_tr_b16 v[124:125], v6 offset:2080
    ds_read_b64_tr_b16 v[126:127], v6 offset:3104
    ds_read_b64_tr_b16 v[128:129], v6 offset:4096
    ds_read_b64_tr_b16 v[130:131], v6 offset:5120
    ds_read_b64_tr_b16 v[132:133], v6 offset:4128
    ds_read_b64_tr_b16 v[134:135], v6 offset:5152
    s_waitcnt lgkmcnt(10)
    s_add_u32 s21, s27, 0
    buffer_store_dwordx4 v[112:115], v4, s[4:7], s21 offen sc1
    s_waitcnt lgkmcnt(8)
    s_add_u32 s21, s27, 1024
    buffer_store_dwordx4 v[116:119], v4, s[4:7], s21 offen sc1
    s_waitcnt lgkmcnt(6)
    s_add_u32 s21, s27, 2048
    buffer_store_dwordx4 v[120:123], v4, s[4:7], s21 offen sc1
    s_waitcnt lgkmcnt(4)
    s_add_u32 s21, s27, 3072
    buffer_store_dwordx4 v[124:127], v4, s[4:7], s21 offen sc1
    s_waitcnt lgkmcnt(2)
    s_add_u32 s21, s27, 4096
    buffer_store_dwordx4 v[128:131], v4, s[4:7], s21 offen sc1
    ds_read_b64_tr_b16 v[136:137], v6 offset:6144
    ds_read_b64_tr_b16 v[138:139], v6 offset:7168
    ds_read_b64_tr_b16 v[140:141], v6 offset:6176
    ds_read_b64_tr_b16 v[142:143], v6 offset:7200
    ds_read_b64_tr_b16 v[144:145], v6 offset:8192
    ds_read_b64_tr_b16 v[146:147], v6 offset:9216
    ds_read_b64_tr_b16 v[148:149], v6 offset:8224
    ds_read_b64_tr_b16 v[150:151], v6 offset:9248
    s_waitcnt lgkmcnt(8)
    s_add_u32 s21, s27, 245760
    buffer_store_dwordx4 v[132:135], v4, s[4:7], s21 offen sc1
    s_waitcnt lgkmcnt(6)
    s_add_u32 s21, s27, 246784
    buffer_store_dwordx4 v[136:139], v4, s[4:7], s21 offen sc1
    s_waitcnt lgkmcnt(4)
    s_add_u32 s21, s27, 247808
    buffer_store_dwordx4 v[140:143], v4, s[4:7], s21 offen sc1
    s_waitcnt lgkmcnt(2)
    s_add_u32 s21, s27, 248832
    buffer_store_dwordx4 v[144:147], v4, s[4:7], s21 offen sc1
    s_waitcnt lgkmcnt(0)
    s_add_u32 s21, s27, 249856
    buffer_store_dwordx4 v[148:151], v4, s[4:7], s21 offen sc1
Ld_prompt_25:
    v_mov_b32 v29, 148480
    ds_write_b32 v29, v30
    s_waitcnt vmcnt(0) lgkmcnt(0)
    s_barrier
    s_cmp_lg_u32 s3, 0
    s_cbranch_scc1 Lw_prompt_26
    s_lshl_b32 s21, s45, 2
    v_add_u32 v29, s21, v1
    v_lshlrev_b32 v29, 12, v29
    v_add_u32 v29, 35652992, v29
    s_mul_i32 s27, s24, 86
    s_add_u32 s28, s27, 43
    s_lshr_b32 s27, s27, 7
    s_lshr_b32 s28, s28, 7
    s_lshl_b32 s21, s27, 12
    s_add_u32 s21, s21, 35652864
    v_writelane_b32 v29, s21, 9
    s_lshl_b32 s21, s28, 12
    s_add_u32 s21, s21, 35652864
    v_writelane_b32 v29, s21, 10
    s_cmp_eq_u32 s27, s28
    s_cselect_b32 s21, 0, 0x400
    s_or_b32 s21, s21, 0x2ff
    s_mov_b32 exec_lo, s21
    s_mov_b32 exec_hi, 0
    buffer_atomic_add v31, v29, s[4:7], 0 offen sc1
    s_mov_b64 exec, -1
Lw_prompt_26:
    s_mul_i32 s56, s17, 258048
    s_lshl_b32 s57, s3, 12
    s_add_u32 s58, s56, s57
    s_lshr_b32 s23, s17, 1
    s_mul_i32 s59, s23, 245760
    s_mul_i32 s24, s3, 61440
    s_add_u32 s59, s59, s24
    s_add_u32 s59, s59, 4194304
    s_lshl_b32 s64, s16, 12
    s_mul_i32 s21, s23, 0
    s_add_u32 s21, s21, s16
    s_add_u32 s21, s21, 0
    s_and_b32 s21, s21, 3
    s_mul_i32 s36, s21, 15360
    s_add_u32 s36, s36, s59
    s_mul_i32 s40, s21, 3072
    s_mul_i32 s21, s23, 0
    s_add_u32 s21, s21, s16
    s_add_u32 s21, s21, 1
    s_and_b32 s21, s21, 3
    s_mul_i32 s37, s21, 15360
    s_add_u32 s37, s37, s59
    s_mul_i32 s41, s21, 3072
    s_mul_i32 s21, s23, 0
    s_add_u32 s21, s21, s16
    s_add_u32 s21, s21, 2
    s_and_b32 s21, s21, 3
    s_mul_i32 s38, s21, 15360
    s_add_u32 s38, s38, s59
    s_mul_i32 s42, s21, 3072
    s_mul_i32 s21, s23, 0
    s_add_u32 s21, s21, s16
    s_add_u32 s21, s21, 3
    s_and_b32 s21, s21, 3
    s_mul_i32 s39, s21, 15360
    s_add_u32 s39, s39, s59
    s_mul_i32 s43, s21, 3072
    s_cmp_lg_u32 s3, 3
    s_cbranch_scc1 Lw_prompt_28
    s_add_u32 s21, s64, 35652736
    v_lshlrev_b32 v29, 7, v1
    s_mov_b64 exec, 1
    s_mov_b32 s66, 0
Lp_prompt_29:
    buffer_load_dword v0, v29, s[4:7], s21 offen sc1
    s_add_u32 s66, s66, 1
    s_waitcnt vmcnt(0)
    v_cmp_gt_u32 vcc, 12, v0
    s_cbranch_vccz Lq_prompt_27
    s_cmp_lt_u32 s66, 0x40000
    s_cbranch_scc0 Lq_prompt_27
    s_sleep 4
    s_branch Lp_prompt_29
Lq_prompt_27:
    s_mov_b64 exec, -1
Lw_prompt_28:
    s_barrier
    s_sub_u32 s23, s17, 10
    s_lshl_b32 s23, s23, 1
    s_add_u32 s23, s23, s3
    s_sub_u32 s23, 39, s23
    s_cmp_ge_u32 s3, 2
    s_cselect_b32 s23, 40, s23
    s_cmp_eq_u32 s17, 15
    s_cselect_b32 s23, 40, s23
    s_sub_u32 s24, 19, s17
    s_cmp_eq_u32 s3, 1
    s_cselect_b32 s22, s24, s17
    s_add_u32 s24, s17, 20
    s_cmp_eq_u32 s3, 2
    s_cselect_b32 s22, s24, s22
    s_cmp_eq_u32 s3, 3
    s_cselect_b32 s22, 40, s22
    s_cmp_ge_u32 s17, 10
    s_cselect_b32 s22, s23, s22
    s_cmp_ge_u32 s22, 40
    s_cbranch_scc1 Lp2l_prompt_30
    s_cmp_ge_u32 s22, 20
    s_cselect_b32 s23, s19, s18
    s_cselect_b32 s24, 20, 0
    s_sub_u32 s24, s22, s24
    s_lshl_b32 s27, s23, 13
    s_add_u32 s27, s27, 6291456
    s_add_u32 s28, s27, 262144
    buffer_load_dwordx4 v[64:67], v4, s[4:7], s27 offen sc1
    buffer_load_dwordx4 v[96:99], v4, s[4:7], s28 offen sc1
    buffer_load_dwordx4 v[68:71], v4, s[4:7], s27 offen offset:1024 sc1
    buffer_load_dwordx4 v[100:103], v4, s[4:7], s28 offen offset:1024 sc1
    buffer_load_dwordx4 v[72:75], v4, s[4:7], s27 offen offset:2048 sc1
    buffer_load_dwordx4 v[104:107], v4, s[4:7], s28 offen offset:2048 sc1
    buffer_load_dwordx4 v[76:79], v4, s[4:7], s27 offen offset:3072 sc1
    buffer_load_dwordx4 v[108:111], v4, s[4:7], s28 offen offset:3072 sc1
    s_add_u32 s21, s27, 4096
    buffer_load_dwordx4 v[80:83], v4, s[4:7], s21 offen sc1
    s_add_u32 s29, s28, 4096
    buffer_load_dwordx4 v[112:115], v4, s[4:7], s29 offen sc1
    buffer_load_dwordx4 v[84:87], v4, s[4:7], s21 offen offset:1024 sc1
    buffer_load_dwordx4 v[116:119], v4, s[4:7], s29 offen offset:1024 sc1
    buffer_load_dwordx4 v[88:91], v4, s[4:7], s21 offen offset:2048 sc1
    buffer_load_dwordx4 v[120:123], v4, s[4:7], s29 offen offset:2048 sc1
    buffer_load_dwordx4 v[92:95], v4, s[4:7], s21 offen offset:3072 sc1
    buffer_load_dwordx4 v[124:127], v4, s[4:7], s29 offen offset:3072 sc1
    s_mov_b32 s8, s32
    s_mov_b32 s9, s33
    s_mov_b32 s10, 2621440
    s_mov_b32 s11, 0x20000
    v_lshl_add_u32 v7, v2, 6, s23
    v_mul_u32_u24 v7, 1280, v7
    v_lshl_add_u32 v7, v3, 4, v7
    s_lshl_b32 s30, s24, 6
    s_add_u32 s31, s30, 40960
    buffer_load_dwordx4 v[128:131], v7, s[8:11], s30 offen offset:0
    buffer_load_dwordx4 v[132:135], v7, s[8:11], s30 offen offset:32
    buffer_load_dwordx4 v[136:139], v7, s[8:11], s31 offen offset:0
    buffer_load_dwordx4 v[140:143], v7, s[8:11], s31 offen offset:32
    s_sub_u32 s25, 32, s23
    s_and_b32 s25, s25, 31
    s_cmp_ge_u32 s24, 10
    s_cselect_b32 s25, s25, s23
    s_cselect_b32 s26, 0x80000000, 0
    s_cselect_b64 s[60:61], -1, 0
    s_lshl_b32 s30, s24, 5
    v_add_u32 v5, s30, v2
    v_sub_u32 v6, 640, v5
    v_cmp_eq_u32 vcc, 320, v6
    s_nop 1
    v_cndmask_b32 v6, v6, 0, vcc
    v_cndmask_b32 v6, v5, v6, s[60:61]
    v_lshlrev_b32 v6, 4, v6
    v_mul_u32_u24 v7, 5120, v3
    v_add_u32 v6, v6, v7
    v_cmp_eq_u32 vcc, 0, v5
    v_mov_b32 v7, 0x7ff00000
    s_nop 0
    v_cndmask_b32 v6, v6, v7, vcc
    s_mul_i32 s25, s25, 81920
    s_add_u32 s25, s25, 7340032
    s_mul_i32 s62, s23, 40960
    s_lshl_b32 s31, s24, 10
    s_add_u32 s62, s62, s31
    v_bfe_u32 v10, v1, 4, 1
    v_mul_u32_u24 v10, 20480, v10
    v_and_b32 v11, 15, v1
    v_lshl_add_u32 v10, v11, 4, v10
    v_lshl_add_u32 v10, v3, 8, v10
    s_add_u32 s62, s62, 13631488
    s_add_u32 s63, s62, 1310720
    s_mul_i32 s28, s23, 5120
    s_lshl_b32 s27, s24, 8
    s_add_u32 s28, s28, s27
    s_add_u32 s28, s28, 36569088
    v_mul_u32_u24 v7, 163840, v3
    v_lshl_add_u32 v7, v2, 3, v7
    s_mov_b32 s27, 0x3f803f80
Lp2l_prompt_30:
L_p1_done:
    s_cmp_lg_u32 s3, 3
    s_cbranch_scc1 Lw_prompt_34
    s_lshl_b32 s21, s17, 12
    s_add_u32 s21, s21, 35652864
    v_mov_b32 v29, s21
    v_mov_b32 v28, 8
    s_lshr_b32 s21, s17, 2
    s_lshl_b32 s21, s21, 2
    s_and_b32 s66, s16, 3
    s_add_u32 s21, s21, s66
    s_lshl_b32 s21, s21, 12
    s_add_u32 s21, s21, 35652992
    v_writelane_b32 v29, s21, 1
    v_writelane_b32 v28, 48, 1
    s_add_u32 s21, s64, 35652736
    v_writelane_b32 v29, s21, 2
    v_writelane_b32 v28, 12, 2
    s_mov_b64 exec, 1
    s_mov_b32 s66, 0
Lp_prompt_33:
    buffer_load_dword v0, v29, s[4:7], 0 offen sc1
    s_add_u32 s66, s66, 1
    s_waitcnt vmcnt(0)
    v_cmp_gt_u32 vcc, v28, v0
    s_cbranch_vccz Lq_prompt_32
    s_cmp_lt_u32 s66, 0x40000
    s_cbranch_scc0 Lq_prompt_32
    s_sleep 4
    s_branch Lp_prompt_33
Lq_prompt_32:
    s_mov_b64 exec, -1
Lw_prompt_34:
    s_barrier
    s_and_b32 s12, s16, 3
    s_mul_i32 s12, s12, 4
    s_lshr_b32 s12, s12, 2
    s_lshl_b32 s12, s12, 14
    s_add_u32 s65, s58, s12
    s_add_u32 s13, s12, 98304
    s_cmp_ge_u32 s13, 147456
    s_cselect_b32 s14, 147456, 0
    s_sub_u32 s13, s13, s14
    s_add_u32 m0, s13, s57
    s_add_u32 s12, s12, 16384
    s_cmp_eq_u32 s12, 65536
    s_cselect_b32 s12, 0, s12
    buffer_load_dwordx4 v4, s[4:7], s65 offen offset:0 sc1 lds
    buffer_load_dwordx4 v4, s[4:7], s65 offen offset:1024 sc1 lds
    buffer_load_dwordx4 v4, s[4:7], s65 offen offset:2048 sc1 lds
    buffer_load_dwordx4 v4, s[4:7], s65 offen offset:3072 sc1 lds
    s_add_u32 s65, s58, s12
    s_add_u32 s13, s12, 98304
    s_cmp_ge_u32 s13, 147456
    s_cselect_b32 s14, 147456, 0
    s_sub_u32 s13, s13, s14
    s_add_u32 m0, s13, s57
    s_add_u32 s12, s12, 16384
    s_cmp_eq_u32 s12, 65536
    s_cselect_b32 s12, 0, s12
    buffer_load_dwordx4 v4, s[4:7], s65 offen offset:0 sc1 lds
    buffer_load_dwordx4 v4, s[4:7], s65 offen offset:1024 sc1 lds
    buffer_load_dwordx4 v4, s[4:7], s65 offen offset:2048 sc1 lds
    buffer_load_dwordx4 v4, s[4:7], s65 offen offset:3072 sc1 lds
    s_add_u32 s65, s58, s12
    s_add_u32 s13, s12, 98304
    s_cmp_ge_u32 s13, 147456
    s_cselect_b32 s14, 147456, 0
    s_sub_u32 s13, s13, s14
    s_add_u32 m0, s13, s57
    s_add_u32 s12, s12, 16384
    s_cmp_eq_u32 s12, 65536
    s_cselect_b32 s12, 0, s12
    buffer_load_dwordx4 v4, s[4:7], s65 offen offset:0 sc1 lds
    buffer_load_dwordx4 v4, s[4:7], s65 offen offset:1024 sc1 lds
    buffer_load_dwordx4 v4, s[4:7], s65 offen offset:2048 sc1 lds
    buffer_load_dwordx4 v4, s[4:7], s65 offen offset:3072 sc1 lds
    s_add_u32 s65, s58, s12
    s_add_u32 s13, s12, 98304
    s_cmp_ge_u32 s13, 147456
    s_cselect_b32 s14, 147456, 0
    s_sub_u32 s13, s13, s14
    s_add_u32 m0, s13, s57
    s_add_u32 s12, s12, 16384
    s_cmp_eq_u32 s12, 65536
    s_cselect_b32 s12, 0, s12
    buffer_load_dwordx4 v4, s[4:7], s65 offen offset:0 sc1 lds
    buffer_load_dwordx4 v4, s[4:7], s65 offen offset:1024 sc1 lds
    buffer_load_dwordx4 v4, s[4:7], s65 offen offset:2048 sc1 lds
    buffer_load_dwordx4 v4, s[4:7], s65 offen offset:3072 sc1 lds
    s_cmp_lg_u32 s3, 3
    s_cbranch_scc1 Lw_prompt_36
    s_sub_u32 s21, s17, 10
    s_lshl_b32 s21, s21, 1
    s_cmp_lt_u32 s17, 10
    s_cselect_b32 s21, s17, s21
    s_lshl_b32 s21, s21, 4
    v_add_u32 v29, s21, v1
    v_subrev_u32 v28, 160, v29
    v_min_u32 v29, v29, v28
    v_lshlrev_b32 v29, 7, v29
    s_mov_b32 s21, 37748736
    s_mov_b32 exec_hi, 0xffff
    s_mov_b32 s66, 0
Lp_prompt_37:
    buffer_load_dword v0, v29, s[4:7], s21 offen sc1
    s_add_u32 s66, s66, 1
    s_waitcnt vmcnt(0)
    v_cmp_gt_u32 vcc, 1, v0
    s_cbranch_vccz Lq_prompt_35
    s_cmp_lt_u32 s66, 0x40000
    s_cbranch_scc0 Lq_prompt_35
    s_sleep 4
    s_branch Lp_prompt_37
Lq_prompt_35:
    s_mov_b64 exec, -1
Lw_prompt_36:
    s_barrier
    s_cmp_lt_u32 s22, 40
    s_cbranch_scc1 Lw4_prompt_38
    s_cmp_lg_u32 s3, 3
    s_cbranch_scc1 Lp2r_prompt_31
    s_waitcnt vmcnt(56)
    s_mov_b32 m0, 16384
    s_add_u32 s65, s56, 65536
    buffer_load_dwordx4 v4, s[4:7], s65 offen offset:0 sc1 lds
    buffer_load_dwordx4 v4, s[4:7], s65 offen offset:1024 sc1 lds
    buffer_load_dwordx4 v4, s[4:7], s65 offen offset:2048 sc1 lds
    buffer_load_dwordx4 v4, s[4:7], s65 offen offset:3072 sc1 lds
    s_waitcnt vmcnt(56)
    s_mov_b32 m0, 20480
    s_add_u32 s65, s56, 69632
    buffer_load_dwordx4 v4, s[4:7], s65 offen offset:0 sc1 lds
    buffer_load_dwordx4 v4, s[4:7], s65 offen offset:1024 sc1 lds
    buffer_load_dwordx4 v4, s[4:7], s65 offen offset:2048 sc1 lds
    buffer_load_dwordx4 v4, s[4:7], s65 offen offset:3072 sc1 lds
    s_waitcnt vmcnt(56)
    s_mov_b32 m0, 24576
    s_add_u32 s65, s56, 73728
    buffer_load_dwordx4 v4, s[4:7], s65 offen offset:0 sc1 lds
    buffer_load_dwordx4 v4, s[4:7], s65 offen offset:1024 sc1 lds
    buffer_load_dwordx4 v4, s[4:7], s65 offen offset:2048 sc1 lds
    buffer_load_dwordx4 v4, s[4:7], s65 offen offset:3072 sc1 lds
    s_waitcnt vmcnt(56)
    s_mov_b32 m0, 28672
    s_add_u32 s65, s56, 77824
    buffer_load_dwordx4 v4, s[4:7], s65 offen offset:0 sc1 lds
    buffer_load_dwordx4 v4, s[4:7], s65 offen offset:1024 sc1 lds
    buffer_load_dwordx4 v4, s[4:7], s65 offen offset:2048 sc1 lds
    buffer_load_dwordx4 v4, s[4:7], s65 offen offset:3072 sc1 lds
    s_waitcnt vmcnt(56)
    s_mov_b32 m0, 32768
    s_add_u32 s65, s56, 81920
    buffer_load_dwordx4 v4, s[4:7], s65 offen offset:0 sc1 lds
    buffer_load_dwordx4 v4, s[4:7], s65 offen offset:1024 sc1 lds
    buffer_load_dwordx4 v4, s[4:7], s65 offen offset:2048 sc1 lds
    buffer_load_dwordx4 v4, s[4:7], s65 offen offset:3072 sc1 lds
    s_waitcnt vmcnt(56)
    s_mov_b32 m0, 36864
    s_add_u32 s65, s56, 86016
    buffer_load_dwordx4 v4, s[4:7], s65 offen offset:0 sc1 lds
    buffer_load_dwordx4 v4, s[4:7], s65 offen offset:1024 sc1 lds
    buffer_load_dwordx4 v4, s[4:7], s65 offen offset:2048 sc1 lds
    buffer_load_dwordx4 v4, s[4:7], s65 offen offset:3072 sc1 lds
    s_waitcnt vmcnt(56)
    s_mov_b32 m0, 40960
    s_add_u32 s65, s56, 90112
    buffer_load_dwordx4 v4, s[4:7], s65 offen offset:0 sc1 lds
    buffer_load_dwordx4 v4, s[4:7], s65 offen offset:1024 sc1 lds
    buffer_load_dwordx4 v4, s[4:7], s65 offen offset:2048 sc1 lds
    buffer_load_dwordx4 v4, s[4:7], s65 offen offset:3072 sc1 lds
    s_waitcnt vmcnt(56)
    s_mov_b32 m0, 45056
    s_add_u32 s65, s56, 94208
    buffer_load_dwordx4 v4, s[4:7], s65 offen offset:0 sc1 lds
    buffer_load_dwordx4 v4, s[4:7], s65 offen offset:1024 sc1 lds
    buffer_load_dwordx4 v4, s[4:7], s65 offen offset:2048 sc1 lds
    buffer_load_dwordx4 v4, s[4:7], s65 offen offset:3072 sc1 lds
    s_waitcnt vmcnt(56)
    s_mov_b32 m0, 49152
    s_add_u32 s65, s56, 98304
    buffer_load_dwordx4 v4, s[4:7], s65 offen offset:0 sc1 lds
    buffer_load_dwordx4 v4, s[4:7], s65 offen offset:1024 sc1 lds
    buffer_load_dwordx4 v4, s[4:7], s65 offen offset:2048 sc1 lds
    buffer_load_dwordx4 v4, s[4:7], s65 offen offset:3072 sc1 lds
    s_waitcnt vmcnt(56)
    s_mov_b32 m0, 53248
    s_add_u32 s65, s56, 102400
    buffer_load_dwordx4 v4, s[4:7], s65 offen offset:0 sc1 lds
    buffer_load_dwordx4 v4, s[4:7], s65 offen offset:1024 sc1 lds
    buffer_load_dwordx4 v4, s[4:7], s65 offen offset:2048 sc1 lds
    buffer_load_dwordx4 v4, s[4:7], s65 offen offset:3072 sc1 lds
    s_waitcnt vmcnt(56)
    s_mov_b32 m0, 57344
    s_add_u32 s65, s56, 106496
    buffer_load_dwordx4 v4, s[4:7], s65 offen offset:0 sc1 lds
    buffer_load_dwordx4 v4, s[4:7], s65 offen offset:1024 sc1 lds
    buffer_load_dwordx4 v4, s[4:7], s65 offen offset:2048 sc1 lds
    buffer_load_dwordx4 v4, s[4:7], s65 offen offset:3072 sc1 lds
    s_waitcnt vmcnt(56)
    s_mov_b32 m0, 61440
    s_add_u32 s65, s56, 110592
    buffer_load_dwordx4 v4, s[4:7], s65 offen offset:0 sc1 lds
    buffer_load_dwordx4 v4, s[4:7], s65 offen offset:1024 sc1 lds
    buffer_load_dwordx4 v4, s[4:7], s65 offen offset:2048 sc1 lds
    buffer_load_dwordx4 v4, s[4:7], s65 offen offset:3072 sc1 lds
    s_waitcnt vmcnt(56)
    s_mov_b32 m0, 65536
    s_add_u32 s65, s56, 114688
    buffer_load_dwordx4 v4, s[4:7], s65 offen offset:0 sc1 lds
    buffer_load_dwordx4 v4, s[4:7], s65 offen offset:1024 sc1 lds
    buffer_load_dwordx4 v4, s[4:7], s65 offen offset:2048 sc1 lds
    buffer_load_dwordx4 v4, s[4:7], s65 offen offset:3072 sc1 lds
    s_waitcnt vmcnt(56)
    s_mov_b32 m0, 69632
    s_add_u32 s65, s56, 118784
    buffer_load_dwordx4 v4, s[4:7], s65 offen offset:0 sc1 lds
    buffer_load_dwordx4 v4, s[4:7], s65 offen offset:1024 sc1 lds
    buffer_load_dwordx4 v4, s[4:7], s65 offen offset:2048 sc1 lds
    buffer_load_dwordx4 v4, s[4:7], s65 offen offset:3072 sc1 lds
    s_waitcnt vmcnt(56)
    s_mov_b32 m0, 73728
    s_add_u32 s65, s56, 122880
    buffer_load_dwordx4 v4, s[4:7], s65 offen offset:0 sc1 lds
    buffer_load_dwordx4 v4, s[4:7], s65 offen offset:1024 sc1 lds
    buffer_load_dwordx4 v4, s[4:7], s65 offen offset:2048 sc1 lds
    buffer_load_dwordx4 v4, s[4:7], s65 offen offset:3072 sc1 lds
    s_waitcnt vmcnt(56)
    s_mov_b32 m0, 77824
    s_add_u32 s65, s56, 126976
    buffer_load_dwordx4 v4, s[4:7], s65 offen offset:0 sc1 lds
    buffer_load_dwordx4 v4, s[4:7], s65 offen offset:1024 sc1 lds
    buffer_load_dwordx4 v4, s[4:7], s65 offen offset:2048 sc1 lds
    buffer_load_dwordx4 v4, s[4:7], s65 offen offset:3072 sc1 lds
    s_waitcnt vmcnt(56)
    s_mov_b32 m0, 81920
    s_add_u32 s65, s56, 131072
    buffer_load_dwordx4 v4, s[4:7], s65 offen offset:0 sc1 lds
    buffer_load_dwordx4 v4, s[4:7], s65 offen offset:1024 sc1 lds
    buffer_load_dwordx4 v4, s[4:7], s65 offen offset:2048 sc1 lds
    buffer_load_dwordx4 v4, s[4:7], s65 offen offset:3072 sc1 lds
    s_waitcnt vmcnt(56)
    s_mov_b32 m0, 86016
    s_add_u32 s65, s56, 135168
    buffer_load_dwordx4 v4, s[4:7], s65 offen offset:0 sc1 lds
    buffer_load_dwordx4 v4, s[4:7], s65 offen offset:1024 sc1 lds
    buffer_load_dwordx4 v4, s[4:7], s65 offen offset:2048 sc1 lds
    buffer_load_dwordx4 v4, s[4:7], s65 offen offset:3072 sc1 lds
    s_waitcnt vmcnt(56)
    s_mov_b32 m0, 90112
    s_add_u32 s65, s56, 139264
    buffer_load_dwordx4 v4, s[4:7], s65 offen offset:0 sc1 lds
    buffer_load_dwordx4 v4, s[4:7], s65 offen offset:1024 sc1 lds
    buffer_load_dwordx4 v4, s[4:7], s65 offen offset:2048 sc1 lds
    buffer_load_dwordx4 v4, s[4:7], s65 offen offset:3072 sc1 lds
    s_waitcnt vmcnt(56)
    s_mov_b32 m0, 94208
    s_add_u32 s65, s56, 143360
    buffer_load_dwordx4 v4, s[4:7], s65 offen offset:0 sc1 lds
    buffer_load_dwordx4 v4, s[4:7], s65 offen offset:1024 sc1 lds
    buffer_load_dwordx4 v4, s[4:7], s65 offen offset:2048 sc1 lds
    buffer_load_dwordx4 v4, s[4:7], s65 offen offset:3072 sc1 lds
    s_lshl_b32 s21, s17, 12
    s_add_u32 s21, s21, 35652864
    v_mov_b32 v29, s21
    v_mov_b32 v28, 8
    s_lshr_b32 s21, s17, 2
    s_lshl_b32 s21, s21, 2
    s_and_b32 s66, s16, 3
    s_add_u32 s21, s21, s66
    s_lshl_b32 s21, s21, 12
    s_add_u32 s21, s21, 35652992
    v_writelane_b32 v29, s21, 1
    v_writelane_b32 v28, 48, 1
    s_add_u32 s21, s64, 35652736
    v_writelane_b32 v29, s21, 2
    v_writelane_b32 v28, 12, 2
    s_mov_b64 exec, 2
    s_mov_b32 s66, 0
Lp_prompt_40:
    buffer_load_dword v0, v29, s[4:7], 0 offen sc1
    s_add_u32 s66, s66, 1
    s_waitcnt vmcnt(0)
    v_cmp_gt_u32 vcc, v28, v0
    s_cbranch_vccz Lq_prompt_39
    s_cmp_lt_u32 s66, 0x40000
    s_cbranch_scc0 Lq_prompt_39
    s_sleep 4
    s_branch Lp_prompt_40
Lq_prompt_39:
    s_mov_b64 exec, -1
    s_branch Lp2r_prompt_31b
    s_branch Lp2r_prompt_31
Lw4_prompt_38:
    s_add_u32 s30, s25, 0
    buffer_load_dwordx4 v[32:35], v6, s[4:7], s30 offen sc1
    s_add_u32 s30, s25, 10240
    buffer_load_dwordx4 v[36:39], v6, s[4:7], s30 offen sc1
    s_add_u32 s30, s25, 20480
    buffer_load_dwordx4 v[40:43], v6, s[4:7], s30 offen sc1
    s_add_u32 s30, s25, 30720
    buffer_load_dwordx4 v[44:47], v6, s[4:7], s30 offen sc1
    s_add_u32 s30, s25, 40960
    buffer_load_dwordx4 v[48:51], v6, s[4:7], s30 offen sc1
    s_add_u32 s30, s25, 51200
    buffer_load_dwordx4 v[52:55], v6, s[4:7], s30 offen sc1
    s_add_u32 s30, s25, 61440
    buffer_load_dwordx4 v[56:59], v6, s[4:7], s30 offen sc1
    s_add_u32 s30, s25, 71680
    buffer_load_dwordx4 v[60:63], v6, s[4:7], s30 offen sc1
    v_mov_b32 v12, 0
    v_mov_b32 v13, 0
    v_mov_b32 v14, 0
    v_mov_b32 v15, 0
    s_waitcnt vmcnt(8)
    v_permlane32_swap_b32 v128, v130
    v_permlane32_swap_b32 v129, v131
    v_permlane32_swap_b32 v132, v134
    v_permlane32_swap_b32 v133, v135
    v_permlane32_swap_b32 v136, v138
    v_permlane32_swap_b32 v137, v139
    v_permlane32_swap_b32 v140, v142
    v_permlane32_swap_b32 v141, v143
    v_lshlrev_b32 v192, 16, v128
    v_and_b32 v193, 0xffff0000, v128
    v_lshlrev_b32 v194, 16, v129
    v_and_b32 v195, 0xffff0000, v129
    v_lshlrev_b32 v196, 16, v130
    v_and_b32 v197, 0xffff0000, v130
    v_lshlrev_b32 v198, 16, v131
    v_and_b32 v199, 0xffff0000, v131
    v_lshlrev_b32 v200, 16, v132
    v_and_b32 v201, 0xffff0000, v132
    v_lshlrev_b32 v202, 16, v133
    v_and_b32 v203, 0xffff0000, v133
    v_lshlrev_b32 v204, 16, v134
    v_and_b32 v205, 0xffff0000, v134
    v_lshlrev_b32 v206, 16, v135
    v_and_b32 v207, 0xffff0000, v135
    v_lshlrev_b32 v208, 16, v136
    v_and_b32 v209, 0xffff0000, v136
    v_lshlrev_b32 v210, 16, v137
    v_and_b32 v211, 0xffff0000, v137
    v_lshlrev_b32 v212, 16, v138
    v_and_b32 v213, 0xffff0000, v138
    v_lshlrev_b32 v214, 16, v139
    v_and_b32 v215, 0xffff0000, v139
    v_lshlrev_b32 v216, 16, v140
    v_and_b32 v217, 0xffff0000, v140
    v_lshlrev_b32 v218, 16, v141
    v_and_b32 v219, 0xffff0000, v141
    v_lshlrev_b32 v220, 16, v142
    v_and_b32 v221, 0xffff0000, v142
    v_lshlrev_b32 v222, 16, v143
    v_and_b32 v223, 0xffff0000, v143
    s_waitcnt vmcnt(7)
    v_xor_b32 v32, s26, v32
    v_xor_b32 v33, s26, v33
    v_xor_b32 v34, s26, v34
    v_xor_b32 v35, s26, v35
    s_nop 1
    v_mfma_f32_32x32x16_bf16 v[160:175], v[32:35], v[64:67], 0
    v_mfma_f32_32x32x16_bf16 v[176:191], v[32:35], v[96:99], 0
    s_waitcnt vmcnt(6)
    v_xor_b32 v36, s26, v36
    v_xor_b32 v37, s26, v37
    v_xor_b32 v38, s26, v38
    v_xor_b32 v39, s26, v39
    s_nop 1
    v_mfma_f32_32x32x16_bf16 v[160:175], v[36:39], v[68:71], v[160:175]
    v_mfma_f32_32x32x16_bf16 v[176:191], v[36:39], v[100:103], v[176:191]
    s_waitcnt vmcnt(5)
    v_xor_b32 v40, s26, v40
    v_xor_b32 v41, s26, v41
    v_xor_b32 v42, s26, v42
    v_xor_b32 v43, s26, v43
    s_nop 1
    v_mfma_f32_32x32x16_bf16 v[160:175], v[40:43], v[72:75], v[160:175]
    v_mfma_f32_32x32x16_bf16 v[176:191], v[40:43], v[104:107], v[176:191]
    s_waitcnt vmcnt(4)
    v_xor_b32 v44, s26, v44
    v_xor_b32 v45, s26, v45
    v_xor_b32 v46, s26, v46
    v_xor_b32 v47, s26, v47
    s_nop 1
    v_mfma_f32_32x32x16_bf16 v[160:175], v[44:47], v[76:79], v[160:175]
    v_mfma_f32_32x32x16_bf16 v[176:191], v[44:47], v[108:111], v[176:191]
    s_waitcnt vmcnt(3)
    v_xor_b32 v48, s26, v48
    v_xor_b32 v49, s26, v49
    v_xor_b32 v50, s26, v50
    v_xor_b32 v51, s26, v51
    s_nop 1
    v_mfma_f32_32x32x16_bf16 v[160:175], v[48:51], v[80:83], v[160:175]
    v_mfma_f32_32x32x16_bf16 v[176:191], v[48:51], v[112:115], v[176:191]
    s_waitcnt vmcnt(2)
    v_xor_b32 v52, s26, v52
    v_xor_b32 v53, s26, v53
    v_xor_b32 v54, s26, v54
    v_xor_b32 v55, s26, v55
    s_nop 1
    v_mfma_f32_32x32x16_bf16 v[160:175], v[52:55], v[84:87], v[160:175]
    v_mfma_f32_32x32x16_bf16 v[176:191], v[52:55], v[116:119], v[176:191]
    s_waitcnt vmcnt(1)
    v_xor_b32 v56, s26, v56
    v_xor_b32 v57, s26, v57
    v_xor_b32 v58, s26, v58
    v_xor_b32 v59, s26, v59
    s_nop 1
    v_mfma_f32_32x32x16_bf16 v[160:175], v[56:59], v[88:91], v[160:175]
    v_mfma_f32_32x32x16_bf16 v[176:191], v[56:59], v[120:123], v[176:191]
    s_waitcnt vmcnt(0)
    v_xor_b32 v60, s26, v60
    v_xor_b32 v61, s26, v61
    v_xor_b32 v62, s26, v62
    v_xor_b32 v63, s26, v63
    s_nop 1
    v_mfma_f32_32x32x16_bf16 v[160:175], v[60:63], v[92:95], v[160:175]
    v_mfma_f32_32x32x16_bf16 v[176:191], v[60:63], v[124:127], v[176:191]
    s_nop 10
    v_pk_add_f32 v[192:193], v[192:193], v[160:161]
    v_pk_add_f32 v[194:195], v[194:195], v[162:163]
    v_pk_add_f32 v[196:197], v[196:197], v[164:165]
    v_pk_add_f32 v[198:199], v[198:199], v[166:167]
    v_cvt_pk_bf16_f32 v128, v192, v193
    v_cvt_pk_bf16_f32 v129, v194, v195
    v_cvt_pk_bf16_f32 v130, v196, v197
    v_cvt_pk_bf16_f32 v131, v198, v199
    buffer_store_dwordx4 v[128:131], v10, s[4:7], s62 offen offset:0 sc1
    v_pk_add_f32 v[200:201], v[200:201], v[168:169]
    v_pk_add_f32 v[202:203], v[202:203], v[170:171]
    v_pk_add_f32 v[204:205], v[204:205], v[172:173]
    v_pk_add_f32 v[206:207], v[206:207], v[174:175]
    v_cvt_pk_bf16_f32 v132, v200, v201
    v_cvt_pk_bf16_f32 v133, v202, v203
    v_cvt_pk_bf16_f32 v134, v204, v205
    v_cvt_pk_bf16_f32 v135, v206, v207
    buffer_store_dwordx4 v[132:135], v10, s[4:7], s62 offen offset:512 sc1
    v_pk_add_f32 v[208:209], v[208:209], v[176:177]
    v_pk_add_f32 v[210:211], v[210:211], v[178:179]
    v_pk_add_f32 v[212:213], v[212:213], v[180:181]
    v_pk_add_f32 v[214:215], v[214:215], v[182:183]
    v_cvt_pk_bf16_f32 v136, v208, v209
    v_cvt_pk_bf16_f32 v137, v210, v211
    v_cvt_pk_bf16_f32 v138, v212, v213
    v_cvt_pk_bf16_f32 v139, v214, v215
    buffer_store_dwordx4 v[136:139], v10, s[4:7], s63 offen offset:0 sc1
    v_pk_add_f32 v[216:217], v[216:217], v[184:185]
    v_pk_add_f32 v[218:219], v[218:219], v[186:187]
    v_pk_add_f32 v[220:221], v[220:221], v[188:189]
    v_pk_add_f32 v[222:223], v[222:223], v[190:191]
    v_cvt_pk_bf16_f32 v140, v216, v217
    v_cvt_pk_bf16_f32 v141, v218, v219
    v_cvt_pk_bf16_f32 v142, v220, v221
    v_cvt_pk_bf16_f32 v143, v222, v223
    buffer_store_dwordx4 v[140:143], v10, s[4:7], s63 offen offset:512 sc1
    v_dot2c_f32_bf16 v12, s27, v128
    v_dot2c_f32_bf16 v13, v128, v128
    v_dot2c_f32_bf16 v12, s27, v129
    v_dot2c_f32_bf16 v13, v129, v129
    v_dot2c_f32_bf16 v12, s27, v130
    v_dot2c_f32_bf16 v13, v130, v130
    v_dot2c_f32_bf16 v12, s27, v131
    v_dot2c_f32_bf16 v13, v131, v131
    v_dot2c_f32_bf16 v12, s27, v132
    v_dot2c_f32_bf16 v13, v132, v132
    v_dot2c_f32_bf16 v12, s27, v133
    v_dot2c_f32_bf16 v13, v133, v133
    v_dot2c_f32_bf16 v12, s27, v134
    v_dot2c_f32_bf16 v13, v134, v134
    v_dot2c_f32_bf16 v12, s27, v135
    v_dot2c_f32_bf16 v13, v135, v135
    v_dot2c_f32_bf16 v14, s27, v136
    v_dot2c_f32_bf16 v15, v136, v136
    v_dot2c_f32_bf16 v14, s27, v137
    v_dot2c_f32_bf16 v15, v137, v137
    v_dot2c_f32_bf16 v14, s27, v138
    v_dot2c_f32_bf16 v15, v138, v138
    v_dot2c_f32_bf16 v14, s27, v139
    v_dot2c_f32_bf16 v15, v139, v139
    v_dot2c_f32_bf16 v14, s27, v140
    v_dot2c_f32_bf16 v15, v140, v140
    v_dot2c_f32_bf16 v14, s27, v141
    v_dot2c_f32_bf16 v15, v141, v141
    v_dot2c_f32_bf16 v14, s27, v142
    v_dot2c_f32_bf16 v15, v142, v142
    v_dot2c_f32_bf16 v14, s27, v143
    v_dot2c_f32_bf16 v15, v143, v143
    s_nop 1
    v_permlane32_swap_b32 v12, v14
    v_permlane32_swap_b32 v13, v15
    v_add_f32 v12, v12, v14
    v_add_f32 v13, v13, v15
    buffer_store_dwordx2 v[12:13], v7, s[4:7], s28 offen sc1
Lp2r_prompt_31:
    s_waitcnt vmcnt(0)
Lp2r_prompt_31b:
    s_barrier
    s_cmp_lg_u32 s3, 0
    s_cbranch_scc1 Lw_prompt_41
    s_add_u32 s21, s64, 35651584
    s_mov_b64 exec, 1
    buffer_atomic_add v31, v30, s[4:7], s21 offen sc1
    s_mov_b64 exec, -1
Lw_prompt_41:
    s_waitcnt vmcnt(32)
    buffer_load_dwordx4 a[0:3], v4, s[4:7], s36 offen sc1
    buffer_load_dwordx4 a[4:7], v4, s[4:7], s36 offen offset:1024 sc1
    buffer_load_dwordx4 a[8:11], v4, s[4:7], s36 offen offset:2048 sc1
    buffer_load_dwordx4 a[12:15], v4, s[4:7], s36 offen offset:3072 sc1
    s_add_u32 s67, s36, 4096
    buffer_load_dwordx4 a[16:19], v4, s[4:7], s67 offen sc1
    buffer_load_dwordx4 a[20:23], v4, s[4:7], s37 offen sc1
    buffer_load_dwordx4 a[24:27], v4, s[4:7], s37 offen offset:1024 sc1
    buffer_load_dwordx4 a[28:31], v4, s[4:7], s37 offen offset:2048 sc1
    buffer_load_dwordx4 a[32:35], v4, s[4:7], s37 offen offset:3072 sc1
    s_add_u32 s67, s37, 4096
    buffer_load_dwordx4 a[36:39], v4, s[4:7], s67 offen sc1
    buffer_load_dwordx4 a[40:43], v4, s[4:7], s38 offen sc1
    buffer_load_dwordx4 a[44:47], v4, s[4:7], s38 offen offset:1024 sc1
    buffer_load_dwordx4 a[48:51], v4, s[4:7], s38 offen offset:2048 sc1
    buffer_load_dwordx4 a[52:55], v4, s[4:7], s38 offen offset:3072 sc1
    s_add_u32 s67, s38, 4096
    buffer_load_dwordx4 a[56:59], v4, s[4:7], s67 offen sc1
    buffer_load_dwordx4 a[60:63], v4, s[4:7], s39 offen sc1
    buffer_load_dwordx4 a[64:67], v4, s[4:7], s39 offen offset:1024 sc1
    buffer_load_dwordx4 a[68:71], v4, s[4:7], s39 offen offset:2048 sc1
    buffer_load_dwordx4 a[72:75], v4, s[4:7], s39 offen offset:3072 sc1
    s_add_u32 s67, s39, 4096
    buffer_load_dwordx4 a[76:79], v4, s[4:7], s67 offen sc1
    s_add_u32 s67, s36, 4096
    buffer_load_dwordx4 a[80:83], v4, s[4:7], s67 offen offset:1024 sc1
    buffer_load_dwordx4 a[84:87], v4, s[4:7], s67 offen offset:2048 sc1
    buffer_load_dwordx4 a[88:91], v4, s[4:7], s67 offen offset:3072 sc1
    s_add_u32 s67, s36, 8192
    buffer_load_dwordx4 a[92:95], v4, s[4:7], s67 offen sc1
Lsf_prompt_43:
    s_cmp_lg_u32 s3, 3
    s_cbranch_scc1 Lw_prompt_45
    s_add_u32 s21, s64, 35651584
    v_lshlrev_b32 v29, 7, v1
    s_mov_b64 exec, 1
    s_mov_b32 s66, 0
Lp_prompt_46:
    buffer_load_dword v0, v29, s[4:7], s21 offen sc1
    s_add_u32 s66, s66, 1
    s_waitcnt vmcnt(0)
    v_cmp_gt_u32 vcc, 16, v0
    s_cbranch_vccz Lq_prompt_44
    s_cmp_lt_u32 s66, 0x40000
    s_cbranch_scc0 Lq_prompt_44
    s_sleep 4
    s_branch Lp_prompt_46
Lq_prompt_44:
    s_mov_b64 exec, -1
Lw_prompt_45:
    s_barrier
    s_mul_i32 s22, s20, 40960
    s_add_u32 s22, s22, 13631488
    s_add_u32 s23, s22, 20480
    buffer_load_dwordx4 v[96:99], v4, s[4:7], s22 offen sc1
    buffer_load_dwordx4 v[100:103], v4, s[4:7], s23 offen sc1
    buffer_load_dwordx4 v[104:107], v4, s[4:7], s22 offen offset:1024 sc1
    buffer_load_dwordx4 v[108:111], v4, s[4:7], s23 offen offset:1024 sc1
    v_add_u32 v5, 0x10000, v4
    v_add_u32 v6, 0x20000, v4
    ds_read_b128 a[240:243], v5 offset:32768
    ds_read_b128 a[244:247], v5 offset:33792
    ds_read_b128 a[248:251], v5 offset:34816
    ds_read_b128 a[252:255], v5 offset:35840
    buffer_load_dwordx4 v[112:115], v4, s[4:7], s22 offen offset:2048 sc1
    buffer_load_dwordx4 v[116:119], v4, s[4:7], s23 offen offset:2048 sc1
    buffer_load_dwordx4 v[120:123], v4, s[4:7], s22 offen offset:3072 sc1
    buffer_load_dwordx4 v[124:127], v4, s[4:7], s23 offen offset:3072 sc1
    s_add_u32 s12, s22, 4096
    buffer_load_dwordx4 v[128:131], v4, s[4:7], s12 offen sc1
    s_add_u32 s13, s23, 4096
    buffer_load_dwordx4 v[132:135], v4, s[4:7], s13 offen sc1
    buffer_load_dwordx4 v[136:139], v4, s[4:7], s12 offen offset:1024 sc1
    buffer_load_dwordx4 v[140:143], v4, s[4:7], s13 offen offset:1024 sc1
    s_mul_i32 s28, s20, 5120
    s_add_u32 s28, s28, 36569088
    v_lshrrev_b32 v28, 4, v1
    v_and_b32 v29, 15, v1
    v_lshlrev_b32 v29, 3, v29
    v_lshl_add_u32 v29, v28, 8, v29
    s_waitcnt vmcnt(10)
    s_waitcnt lgkmcnt(2)
    v_mfma_f32_16x16x32_bf16 v[32:35], a[240:243], v[96:99], 0
    ds_read_b128 v[8:11], v5 offset:36864
    s_mul_i32 s27, s20, 98304
    s_mul_i32 s25, s17, 3072
    v_mfma_f32_16x16x32_bf16 v[40:43], a[240:243], v[100:103], 0
    buffer_load_dwordx4 v[144:147], v4, s[4:7], s12 offen offset:2048 sc1
    s_add_u32 s27, s27, s25
    v_mfma_f32_16x16x32_bf16 v[36:39], a[244:247], v[96:99], 0
    ds_read_b128 v[12:15], v5 offset:37888
    s_add_u32 s27, s27, 19922944
    s_add_u32 s15, s27, 49152
    v_mfma_f32_16x16x32_bf16 v[44:47], a[244:247], v[100:103], 0
    s_and_b32 s25, s17, 1
    s_cmp_eq_u32 s25, 0
    s_cselect_b32 s24, s18, s19
    s_waitcnt lgkmcnt(2)
    v_mfma_f32_16x16x32_bf16 v[48:51], a[248:251], v[96:99], 0
    ds_read_b128 a[240:243], v5 offset:38912
    s_mul_i32 s26, s24, 98304
    s_mul_i32 s25, s3, 12288
    v_mfma_f32_16x16x32_bf16 v[56:59], a[248:251], v[100:103], 0
    buffer_load_dwordx4 v[148:151], v4, s[4:7], s13 offen offset:2048 sc1
    s_add_u32 s26, s26, s25
    v_mfma_f32_16x16x32_bf16 v[52:55], a[252:255], v[96:99], 0
    ds_read_b128 a[244:247], v5 offset:39936
    s_add_u32 s26, s26, 19922944
    s_xor_b32 s60, s3, 0
    v_mfma_f32_16x16x32_bf16 v[60:63], a[252:255], v[100:103], 0
    s_lshr_b32 s25, s60, 1
    s_lshl_b32 s25, s25, 6
    s_waitcnt lgkmcnt(2)
    v_mfma_f32_16x16x32_bf16 v[64:67], v[8:11], v[96:99], 0
    ds_read_b128 a[248:251], v5 offset:40960
    s_and_b32 s60, s60, 1
    s_add_u32 s60, s60, s25
    v_mfma_f32_16x16x32_bf16 v[72:75], v[8:11], v[100:103], 0
    buffer_load_dwordx4 v[152:155], v4, s[4:7], s12 offen offset:3072 sc1
    s_mul_i32 s60, s60, 49152
    v_mfma_f32_16x16x32_bf16 v[68:71], v[12:15], v[96:99], 0
    ds_read_b128 a[252:255], v5 offset:41984
    s_add_u32 s60, s60, s26
    s_xor_b32 s61, s3, 1
    v_mfma_f32_16x16x32_bf16 v[76:79], v[12:15], v[100:103], 0
    s_lshr_b32 s25, s61, 1
    s_lshl_b32 s25, s25, 6
    s_waitcnt lgkmcnt(2)
    v_mfma_f32_16x16x32_bf16 v[80:83], a[240:243], v[96:99], 0
    ds_read_b128 v[8:11], v5 offset:43008
    s_and_b32 s61, s61, 1
    s_add_u32 s61, s61, s25
    v_mfma_f32_16x16x32_bf16 v[88:91], a[240:243], v[100:103], 0
    buffer_load_dwordx4 v[156:159], v4, s[4:7], s13 offen offset:3072 sc1
    s_mul_i32 s61, s61, 49152
    v_mfma_f32_16x16x32_bf16 v[84:87], a[244:247], v[96:99], 0
    ds_read_b128 v[12:15], v5 offset:44032
    s_add_u32 s61, s61, s26
    s_xor_b32 s62, s3, 2
    v_mfma_f32_16x16x32_bf16 v[92:95], a[244:247], v[100:103], 0
    s_lshr_b32 s25, s62, 1
    s_lshl_b32 s25, s25, 6
    s_waitcnt vmcnt(12)
    s_waitcnt lgkmcnt(2)
    v_mfma_f32_16x16x32_bf16 v[32:35], a[248:251], v[104:107], v[32:35]
    ds_read_b128 a[240:243], v5 offset:45056
    s_and_b32 s62, s62, 1
    s_add_u32 s62, s62, s25
    v_mfma_f32_16x16x32_bf16 v[40:43], a[248:251], v[108:111], v[40:43]
    buffer_load_dwordx2 v[236:237], v29, s[4:7], s28 offen sc1
    s_mul_i32 s62, s62, 49152
    s_add_u32 s62, s62, s26
    v_mfma_f32_16x16x32_bf16 v[36:39], a[252:255], v[104:107], v[36:39]
    ds_read_b128 a[244:247], v5 offset:46080
    s_xor_b32 s63, s3, 3
    s_lshr_b32 s25, s63, 1
    v_mfma_f32_16x16x32_bf16 v[44:47], a[252:255], v[108:111], v[44:47]
    s_lshl_b32 s25, s25, 6
    s_and_b32 s63, s63, 1
    s_waitcnt lgkmcnt(2)
    v_mfma_f32_16x16x32_bf16 v[48:51], v[8:11], v[104:107], v[48:51]
    ds_read_b128 a[248:251], v5 offset:47104
    s_add_u32 s63, s63, s25
    s_mul_i32 s63, s63, 49152
    v_mfma_f32_16x16x32_bf16 v[56:59], v[8:11], v[108:111], v[56:59]
    buffer_load_dwordx2 v[238:239], v29, s[4:7], s28 offen offset:1024 sc1
    s_add_u32 s63, s63, s26
    v_mfma_f32_16x16x32_bf16 v[52:55], v[12:15], v[104:107], v[52:55]
    ds_read_b128 a[252:255], v5 offset:48128
    v_mfma_f32_16x16x32_bf16 v[60:63], v[12:15], v[108:111], v[60:63]
    s_waitcnt lgkmcnt(2)
    v_mfma_f32_16x16x32_bf16 v[64:67], a[240:243], v[104:107], v[64:67]
    ds_read_b128 v[8:11], v5 offset:49152
    v_mfma_f32_16x16x32_bf16 v[72:75], a[240:243], v[108:111], v[72:75]
    buffer_load_dwordx2 v[240:241], v29, s[4:7], s28 offen offset:2048 sc1
    v_mfma_f32_16x16x32_bf16 v[68:71], a[244:247], v[104:107], v[68:71]
    ds_read_b128 v[12:15], v5 offset:50176
    v_mfma_f32_16x16x32_bf16 v[76:79], a[244:247], v[108:111], v[76:79]
    s_waitcnt lgkmcnt(2)
    v_mfma_f32_16x16x32_bf16 v[80:83], a[248:251], v[104:107], v[80:83]
    ds_read_b128 a[240:243], v5 offset:51200
    v_mfma_f32_16x16x32_bf16 v[88:91], a[248:251], v[108:111], v[88:91]
    buffer_load_dwordx2 v[242:243], v29, s[4:7], s28 offen offset:3072 sc1
    v_mfma_f32_16x16x32_bf16 v[84:87], a[252:255], v[104:107], v[84:87]
    ds_read_b128 a[244:247], v5 offset:52224
    v_mfma_f32_16x16x32_bf16 v[92:95], a[252:255], v[108:111], v[92:95]
    s_waitcnt vmcnt(14)
    s_waitcnt lgkmcnt(2)
    v_mfma_f32_16x16x32_bf16 v[32:35], v[8:11], v[112:115], v[32:35]
    ds_read_b128 a[248:251], v5 offset:53248
    v_mfma_f32_16x16x32_bf16 v[40:43], v[8:11], v[116:119], v[40:43]
    s_add_u32 s29, s28, 4096
    buffer_load_dwordx2 v[244:245], v29, s[4:7], s29 offen sc1
    v_mfma_f32_16x16x32_bf16 v[36:39], v[12:15], v[112:115], v[36:39]
    ds_read_b128 a[252:255], v5 offset:54272
    v_mfma_f32_16x16x32_bf16 v[44:47], v[12:15], v[116:119], v[44:47]
    s_waitcnt lgkmcnt(2)
    v_mfma_f32_16x16x32_bf16 v[48:51], a[240:243], v[112:115], v[48:51]
    ds_read_b128 v[8:11], v5 offset:55296
    v_mfma_f32_16x16x32_bf16 v[56:59], a[240:243], v[116:119], v[56:59]
    buffer_load_dwordx2 v[246:247], v29, s[4:7], s28 offen offset:128 sc1
    v_mfma_f32_16x16x32_bf16 v[52:55], a[244:247], v[112:115], v[52:55]
    ds_read_b128 v[12:15], v5 offset:56320
    v_mfma_f32_16x16x32_bf16 v[60:63], a[244:247], v[116:119], v[60:63]
    s_waitcnt lgkmcnt(2)
    v_mfma_f32_16x16x32_bf16 v[64:67], a[248:251], v[112:115], v[64:67]
    ds_read_b128 a[240:243], v5 offset:57344
    v_mfma_f32_16x16x32_bf16 v[72:75], a[248:251], v[116:119], v[72:75]
    buffer_load_dwordx2 v[248:249], v29, s[4:7], s28 offen offset:1152 sc1
    v_mfma_f32_16x16x32_bf16 v[68:71], a[252:255], v[112:115], v[68:71]
    ds_read_b128 a[244:247], v5 offset:58368
    v_mfma_f32_16x16x32_bf16 v[76:79], a[252:255], v[116:119], v[76:79]
    s_waitcnt lgkmcnt(2)
    v_mfma_f32_16x16x32_bf16 v[80:83], v[8:11], v[112:115], v[80:83]
    ds_read_b128 a[248:251], v5 offset:59392
    v_mfma_f32_16x16x32_bf16 v[88:91], v[8:11], v[116:119], v[88:91]
    buffer_load_dwordx2 v[250:251], v29, s[4:7], s28 offen offset:2176 sc1
    v_mfma_f32_16x16x32_bf16 v[84:87], v[12:15], v[112:115], v[84:87]
    ds_read_b128 a[252:255], v5 offset:60416
    v_mfma_f32_16x16x32_bf16 v[92:95], v[12:15], v[116:119], v[92:95]
    s_waitcnt vmcnt(16)
    s_waitcnt lgkmcnt(2)
    v_mfma_f32_16x16x32_bf16 v[32:35], a[240:243], v[120:123], v[32:35]
    ds_read_b128 v[8:11], v5 offset:61440
    v_mfma_f32_16x16x32_bf16 v[40:43], a[240:243], v[124:127], v[40:43]
    buffer_load_dwordx2 v[252:253], v29, s[4:7], s28 offen offset:3200 sc1
    v_mfma_f32_16x16x32_bf16 v[36:39], a[244:247], v[120:123], v[36:39]
    ds_read_b128 v[12:15], v5 offset:62464
    v_mfma_f32_16x16x32_bf16 v[44:47], a[244:247], v[124:127], v[44:47]
    s_waitcnt lgkmcnt(2)
    v_mfma_f32_16x16x32_bf16 v[48:51], a[248:251], v[120:123], v[48:51]
    ds_read_b128 a[240:243], v5 offset:63488
    v_mfma_f32_16x16x32_bf16 v[56:59], a[248:251], v[124:127], v[56:59]
    buffer_load_dwordx2 v[254:255], v29, s[4:7], s29 offen offset:128 sc1
    v_mfma_f32_16x16x32_bf16 v[52:55], a[252:255], v[120:123], v[52:55]
    ds_read_b128 a[244:247], v5 offset:64512
    v_mfma_f32_16x16x32_bf16 v[60:63], a[252:255], v[124:127], v[60:63]
    s_waitcnt lgkmcnt(2)
    v_mfma_f32_16x16x32_bf16 v[64:67], v[8:11], v[120:123], v[64:67]
    ds_read_b128 a[248:251], v6 offset:0
    v_mfma_f32_16x16x32_bf16 v[72:75], v[8:11], v[124:127], v[72:75]
    s_add_u32 s12, s22, 8192
    buffer_load_dwordx4 v[160:163], v4, s[4:7], s12 offen sc1
    v_mfma_f32_16x16x32_bf16 v[68:71], v[12:15], v[120:123], v[68:71]
    ds_read_b128 a[252:255], v6 offset:1024
    v_mfma_f32_16x16x32_bf16 v[76:79], v[12:15], v[124:127], v[76:79]
    s_waitcnt lgkmcnt(2)
    v_mfma_f32_16x16x32_bf16 v[80:83], a[240:243], v[120:123], v[80:83]
    ds_read_b128 v[8:11], v6 offset:2048
    v_mfma_f32_16x16x32_bf16 v[88:91], a[240:243], v[124:127], v[88:91]
    s_add_u32 s13, s23, 8192
    buffer_load_dwordx4 v[164:167], v4, s[4:7], s13 offen sc1
    v_mfma_f32_16x16x32_bf16 v[84:87], a[244:247], v[120:123], v[84:87]
    ds_read_b128 v[12:15], v6 offset:3072
    v_mfma_f32_16x16x32_bf16 v[92:95], a[244:247], v[124:127], v[92:95]
    s_waitcnt vmcnt(18)
    s_waitcnt lgkmcnt(2)
    v_mfma_f32_16x16x32_bf16 v[32:35], a[248:251], v[128:131], v[32:35]
    ds_read_b128 a[240:243], v6 offset:4096
    v_mfma_f32_16x16x32_bf16 v[40:43], a[248:251], v[132:135], v[40:43]
    buffer_load_dwordx4 v[168:171], v4, s[4:7], s12 offen offset:1024 sc1
    v_mfma_f32_16x16x32_bf16 v[36:39], a[252:255], v[128:131], v[36:39]
    ds_read_b128 a[244:247], v6 offset:5120
    v_mfma_f32_16x16x32_bf16 v[44:47], a[252:255], v[132:135], v[44:47]
    s_waitcnt lgkmcnt(2)
    v_mfma_f32_16x16x32_bf16 v[48:51], v[8:11], v[128:131], v[48:51]
    ds_read_b128 a[248:251], v6 offset:6144
    v_mfma_f32_16x16x32_bf16 v[56:59], v[8:11], v[132:135], v[56:59]
    buffer_load_dwordx4 v[172:175], v4, s[4:7], s13 offen offset:1024 sc1
    v_mfma_f32_16x16x32_bf16 v[52:55], v[12:15], v[128:131], v[52:55]
    ds_read_b128 a[252:255], v6 offset:7168
    v_mfma_f32_16x16x32_bf16 v[60:63], v[12:15], v[132:135], v[60:63]
    s_waitcnt lgkmcnt(2)
    v_mfma_f32_16x16x32_bf16 v[64:67], a[240:243], v[128:131], v[64:67]
    ds_read_b128 v[8:11], v6 offset:8192
    v_mfma_f32_16x16x32_bf16 v[72:75], a[240:243], v[132:135], v[72:75]
    buffer_load_dwordx4 v[176:179], v4, s[4:7], s12 offen offset:2048 sc1
    v_mfma_f32_16x16x32_bf16 v[68:71], a[244:247], v[128:131], v[68:71]
    ds_read_b128 v[12:15], v6 offset:9216
    v_mfma_f32_16x16x32_bf16 v[76:79], a[244:247], v[132:135], v[76:79]
    s_waitcnt lgkmcnt(2)
    v_mfma_f32_16x16x32_bf16 v[80:83], a[248:251], v[128:131], v[80:83]
    ds_read_b128 a[240:243], v6 offset:10240
    v_mfma_f32_16x16x32_bf16 v[88:91], a[248:251], v[132:135], v[88:91]
    buffer_load_dwordx4 v[180:183], v4, s[4:7], s13 offen offset:2048 sc1
    v_mfma_f32_16x16x32_bf16 v[84:87], a[252:255], v[128:131], v[84:87]
    ds_read_b128 a[244:247], v6 offset:11264
    v_mfma_f32_16x16x32_bf16 v[92:95], a[252:255], v[132:135], v[92:95]
    s_waitcnt vmcnt(20)
    s_waitcnt lgkmcnt(2)
    v_mfma_f32_16x16x32_bf16 v[32:35], v[8:11], v[136:139], v[32:35]
    ds_read_b128 a[248:251], v6 offset:12288
    v_mfma_f32_16x16x32_bf16 v[40:43], v[8:11], v[140:143], v[40:43]
    buffer_load_dwordx4 v[184:187], v4, s[4:7], s12 offen offset:3072 sc1
    v_mfma_f32_16x16x32_bf16 v[36:39], v[12:15], v[136:139], v[36:39]
    ds_read_b128 a[252:255], v6 offset:13312
    v_mfma_f32_16x16x32_bf16 v[44:47], v[12:15], v[140:143], v[44:47]
    s_waitcnt lgkmcnt(2)
    v_mfma_f32_16x16x32_bf16 v[48:51], a[240:243], v[136:139], v[48:51]
    ds_read_b128 v[8:11], v6 offset:14336
    v_mfma_f32_16x16x32_bf16 v[56:59], a[240:243], v[140:143], v[56:59]
    buffer_load_dwordx4 v[188:191], v4, s[4:7], s13 offen offset:3072 sc1
    v_mfma_f32_16x16x32_bf16 v[52:55], a[244:247], v[136:139], v[52:55]
    ds_read_b128 v[12:15], v6 offset:15360
    v_mfma_f32_16x16x32_bf16 v[60:63], a[244:247], v[140:143], v[60:63]
    s_waitcnt lgkmcnt(2)
    v_mfma_f32_16x16x32_bf16 v[64:67], a[248:251], v[136:139], v[64:67]
    ds_read_b128 a[240:243], v4 offset:0
    v_mfma_f32_16x16x32_bf16 v[72:75], a[248:251], v[140:143], v[72:75]
    s_add_u32 s12, s22, 12288
    buffer_load_dwordx4 v[192:195], v4, s[4:7], s12 offen sc1
    v_mfma_f32_16x16x32_bf16 v[68:71], a[252:255], v[136:139], v[68:71]
    ds_read_b128 a[244:247], v4 offset:1024
    v_mfma_f32_16x16x32_bf16 v[76:79], a[252:255], v[140:143], v[76:79]
    s_waitcnt lgkmcnt(2)
    v_mfma_f32_16x16x32_bf16 v[80:83], v[8:11], v[136:139], v[80:83]
    ds_read_b128 a[248:251], v4 offset:2048
    v_mfma_f32_16x16x32_bf16 v[88:91], v[8:11], v[140:143], v[88:91]
    s_add_u32 s13, s23, 12288
    buffer_load_dwordx4 v[196:199], v4, s[4:7], s13 offen sc1
    v_mfma_f32_16x16x32_bf16 v[84:87], v[12:15], v[136:139], v[84:87]
    ds_read_b128 a[252:255], v4 offset:3072
    v_mfma_f32_16x16x32_bf16 v[92:95], v[12:15], v[140:143], v[92:95]
    s_waitcnt vmcnt(22)
    s_waitcnt lgkmcnt(2)
    v_mfma_f32_16x16x32_bf16 v[32:35], a[240:243], v[144:147], v[32:35]
    ds_read_b128 v[8:11], v4 offset:4096
    v_mfma_f32_16x16x32_bf16 v[40:43], a[240:243], v[148:151], v[40:43]
    buffer_load_dwordx4 v[200:203], v4, s[4:7], s12 offen offset:1024 sc1
    v_mfma_f32_16x16x32_bf16 v[36:39], a[244:247], v[144:147], v[36:39]
    ds_read_b128 v[12:15], v4 offset:5120
    v_mfma_f32_16x16x32_bf16 v[44:47], a[244:247], v[148:151], v[44:47]
    s_waitcnt lgkmcnt(2)
    v_mfma_f32_16x16x32_bf16 v[48:51], a[248:251], v[144:147], v[48:51]
    ds_read_b128 a[240:243], v4 offset:6144
    v_mfma_f32_16x16x32_bf16 v[56:59], a[248:251], v[148:151], v[56:59]
    buffer_load_dwordx4 v[204:207], v4, s[4:7], s13 offen offset:1024 sc1
    v_mfma_f32_16x16x32_bf16 v[52:55], a[252:255], v[144:147], v[52:55]
    ds_read_b128 a[244:247], v4 offset:7168
    v_mfma_f32_16x16x32_bf16 v[60:63], a[252:255], v[148:151], v[60:63]
    s_waitcnt lgkmcnt(2)
    v_mfma_f32_16x16x32_bf16 v[64:67], v[8:11], v[144:147], v[64:67]
    ds_read_b128 a[248:251], v4 offset:8192
    v_mfma_f32_16x16x32_bf16 v[72:75], v[8:11], v[148:151], v[72:75]
    buffer_load_dwordx4 v[208:211], v4, s[4:7], s12 offen offset:2048 sc1
    v_mfma_f32_16x16x32_bf16 v[68:71], v[12:15], v[144:147], v[68:71]
    ds_read_b128 a[252:255], v4 offset:9216
    v_mfma_f32_16x16x32_bf16 v[76:79], v[12:15], v[148:151], v[76:79]
    s_waitcnt lgkmcnt(2)
    v_mfma_f32_16x16x32_bf16 v[80:83], a[240:243], v[144:147], v[80:83]
    ds_read_b128 v[8:11], v4 offset:10240
    v_mfma_f32_16x16x32_bf16 v[88:91], a[240:243], v[148:151], v[88:91]
    buffer_load_dwordx4 v[212:215], v4, s[4:7], s13 offen offset:2048 sc1
    v_mfma_f32_16x16x32_bf16 v[84:87], a[244:247], v[144:147], v[84:87]
    ds_read_b128 v[12:15], v4 offset:11264
    v_mfma_f32_16x16x32_bf16 v[92:95], a[244:247], v[148:151], v[92:95]
    s_waitcnt vmcnt(24)
    s_waitcnt lgkmcnt(2)
    v_mfma_f32_16x16x32_bf16 v[32:35], a[248:251], v[152:155], v[32:35]
    ds_read_b128 a[240:243], v4 offset:12288
    v_mfma_f32_16x16x32_bf16 v[40:43], a[248:251], v[156:159], v[40:43]
    buffer_load_dwordx4 v[216:219], v4, s[4:7], s12 offen offset:3072 sc1
    v_mfma_f32_16x16x32_bf16 v[36:39], a[252:255], v[152:155], v[36:39]
    ds_read_b128 a[244:247], v4 offset:13312
    v_mfma_f32_16x16x32_bf16 v[44:47], a[252:255], v[156:159], v[44:47]
    s_waitcnt lgkmcnt(2)
    v_mfma_f32_16x16x32_bf16 v[48:51], v[8:11], v[152:155], v[48:51]
    ds_read_b128 a[248:251], v4 offset:14336
    v_mfma_f32_16x16x32_bf16 v[56:59], v[8:11], v[156:159], v[56:59]
    buffer_load_dwordx4 v[220:223], v4, s[4:7], s13 offen offset:3072 sc1
    v_mfma_f32_16x16x32_bf16 v[52:55], v[12:15], v[152:155], v[52:55]
    ds_read_b128 a[252:255], v4 offset:15360
    v_mfma_f32_16x16x32_bf16 v[60:63], v[12:15], v[156:159], v[60:63]
    s_waitcnt lgkmcnt(2)
    v_mfma_f32_16x16x32_bf16 v[64:67], a[240:243], v[152:155], v[64:67]
    ds_read_b128 v[8:11], v4 offset:16384
    s_waitcnt vmcnt(16)
    v_add_f32 v16, v236, v238
    v_mfma_f32_16x16x32_bf16 v[72:75], a[240:243], v[156:159], v[72:75]
    s_add_u32 s12, s22, 16384
    buffer_load_dwordx4 v[224:227], v4, s[4:7], s12 offen sc1
    v_add_f32 v17, v237, v239
    v_mfma_f32_16x16x32_bf16 v[68:71], a[244:247], v[152:155], v[68:71]
    ds_read_b128 v[12:15], v4 offset:17408
    v_add_f32 v16, v16, v240
    v_add_f32 v17, v17, v241
    v_mfma_f32_16x16x32_bf16 v[76:79], a[244:247], v[156:159], v[76:79]
    v_add_f32 v16, v16, v242
    v_add_f32 v17, v17, v243
    s_waitcnt lgkmcnt(2)
    v_mfma_f32_16x16x32_bf16 v[80:83], a[248:251], v[152:155], v[80:83]
    ds_read_b128 a[240:243], v4 offset:18432
    v_add_f32 v16, v16, v244
    v_add_f32 v17, v17, v245
    v_mfma_f32_16x16x32_bf16 v[88:91], a[248:251], v[156:159], v[88:91]
    s_add_u32 s13, s23, 16384
    buffer_load_dwordx4 v[228:231], v4, s[4:7], s13 offen sc1
    v_add_f32 v20, v246, v248
    v_mfma_f32_16x16x32_bf16 v[84:87], a[252:255], v[152:155], v[84:87]
    ds_read_b128 a[244:247], v4 offset:19456
    v_add_f32 v21, v247, v249
    v_add_f32 v20, v20, v250
    v_mfma_f32_16x16x32_bf16 v[92:95], a[252:255], v[156:159], v[92:95]
    v_add_f32 v21, v21, v251
    v_add_f32 v20, v20, v252
    s_waitcnt vmcnt(16)
    s_waitcnt lgkmcnt(2)
    v_mfma_f32_16x16x32_bf16 v[32:35], v[8:11], v[160:163], v[32:35]
    ds_read_b128 a[248:251], v4 offset:20480
    v_add_f32 v21, v21, v253
    v_add_f32 v20, v20, v254
    v_mfma_f32_16x16x32_bf16 v[40:43], v[8:11], v[164:167], v[40:43]
    buffer_load_dwordx4 v[232:235], v4, s[4:7], s12 offen offset:1024 sc1
    v_add_f32 v21, v21, v255
    v_mfma_f32_16x16x32_bf16 v[36:39], v[12:15], v[160:163], v[36:39]
    ds_read_b128 a[252:255], v4 offset:21504
    v_mov_b32 v18, v16
    v_mov_b32 v19, v16
    v_mfma_f32_16x16x32_bf16 v[44:47], v[12:15], v[164:167], v[44:47]
    s_nop 0
    v_permlane16_swap_b32 v18, v19
    s_waitcnt lgkmcnt(2)
    v_mfma_f32_16x16x32_bf16 v[48:51], a[240:243], v[160:163], v[48:51]
    ds_read_b128 v[8:11], v4 offset:22528
    v_add_f32 v16, v18, v19
    v_mov_b32 v18, v16
    v_mfma_f32_16x16x32_bf16 v[56:59], a[240:243], v[164:167], v[56:59]
    buffer_load_dwordx4 v[236:239], v4, s[4:7], s13 offen offset:1024 sc1
    v_mov_b32 v19, v16
    v_mfma_f32_16x16x32_bf16 v[52:55], a[244:247], v[160:163], v[52:55]
    ds_read_b128 v[12:15], v4 offset:23552
    s_nop 0
    v_permlane32_swap_b32 v18, v19
    v_mfma_f32_16x16x32_bf16 v[60:63], a[244:247], v[164:167], v[60:63]
    v_add_f32 v16, v18, v19
    v_mov_b32 v18, v17
    s_waitcnt lgkmcnt(2)
    v_mfma_f32_16x16x32_bf16 v[64:67], a[248:251], v[160:163], v[64:67]
    ds_read_b128 a[240:243], v4 offset:24576
    v_mov_b32 v19, v17
    s_nop 0
    v_mfma_f32_16x16x32_bf16 v[72:75], a[248:251], v[164:167], v[72:75]
    buffer_load_dwordx4 v[240:243], v4, s[4:7], s12 offen offset:2048 sc1
    v_permlane16_swap_b32 v18, v19
    v_mfma_f32_16x16x32_bf16 v[68:71], a[252:255], v[160:163], v[68:71]
    ds_read_b128 a[244:247], v4 offset:25600
    v_add_f32 v17, v18, v19
    v_mov_b32 v18, v17
    v_mfma_f32_16x16x32_bf16 v[76:79], a[252:255], v[164:167], v[76:79]
    v_mov_b32 v19, v17
    s_nop 0
    s_waitcnt lgkmcnt(2)
    v_mfma_f32_16x16x32_bf16 v[80:83], v[8:11], v[160:163], v[80:83]
    ds_read_b128 a[248:251], v4 offset:26624
    v_permlane32_swap_b32 v18, v19
    v_add_f32 v17, v18, v19
    v_mfma_f32_16x16x32_bf16 v[88:91], v[8:11], v[164:167], v[88:91]
    buffer_load_dwordx4 v[244:247], v4, s[4:7], s13 offen offset:2048 sc1
    v_mul_f32 v16, 0xbacccccd, v16
    v_mfma_f32_16x16x32_bf16 v[84:87], v[12:15], v[160:163], v[84:87]
    ds_read_b128 a[252:255], v4 offset:27648
    v_mul_f32 v17, 0x3acccccd, v17
    v_fma_f32 v17, -v16, v16, v17
    v_mfma_f32_16x16x32_bf16 v[92:95], v[12:15], v[164:167], v[92:95]
    v_max_f32 v17, 0, v17
    v_add_f32 v17, 0x3727c5ac, v17
    s_waitcnt vmcnt(18)
    s_waitcnt lgkmcnt(2)
    v_mfma_f32_16x16x32_bf16 v[32:35], a[240:243], v[168:171], v[32:35]
    ds_read_b128 v[8:11], v4 offset:28672
    v_rsq_f32 v24, v17
    v_mfma_f32_16x16x32_bf16 v[40:43], a[240:243], v[172:175], v[40:43]
    buffer_load_dwordx4 v[248:251], v4, s[4:7], s12 offen offset:3072 sc1
    v_mfma_f32_16x16x32_bf16 v[36:39], a[244:247], v[168:171], v[36:39]
    ds_read_b128 v[12:15], v4 offset:29696
    v_sqrt_f32 v26, v17
    v_mfma_f32_16x16x32_bf16 v[44:47], a[244:247], v[172:175], v[44:47]
    v_cvt_pk_bf16_f32 v17, v16, v16
    v_mul_f32 v24, 0xbfb8aa3b, v24
    s_waitcnt lgkmcnt(2)
    v_mfma_f32_16x16x32_bf16 v[48:51], a[248:251], v[168:171], v[48:51]
    ds_read_b128 a[240:243], v4 offset:30720
    v_and_b32 v18, 0xffff0000, v17
    v_sub_f32 v18, v16, v18
    v_mfma_f32_16x16x32_bf16 v[56:59], a[248:251], v[172:175], v[56:59]
    buffer_load_dwordx4 v[252:255], v4, s[4:7], s13 offen offset:3072 sc1
    v_cvt_pk_bf16_f32 v16, v16, v18
    v_mfma_f32_16x16x32_bf16 v[52:55], a[252:255], v[168:171], v[52:55]
    ds_read_b128 a[244:247], v4 offset:31744
    v_and_b32 v17, 0xffff, v17
    v_mov_b32 v18, 0
    v_mfma_f32_16x16x32_bf16 v[60:63], a[252:255], v[172:175], v[60:63]
    v_mov_b32 v19, 0
    v_mov_b32 v22, v20
    s_waitcnt lgkmcnt(2)
    v_mfma_f32_16x16x32_bf16 v[64:67], v[8:11], v[168:171], v[64:67]
    ds_read_b128 a[248:251], v4 offset:32768
    v_mov_b32 v23, v20
    s_nop 0
    v_mfma_f32_16x16x32_bf16 v[72:75], v[8:11], v[172:175], v[72:75]
    v_permlane16_swap_b32 v22, v23
    v_add_f32 v20, v22, v23
    v_mov_b32 v22, v20
    v_mfma_f32_16x16x32_bf16 v[68:71], v[12:15], v[168:171], v[68:71]
    ds_read_b128 a[252:255], v4 offset:33792
    v_mov_b32 v23, v20
    s_nop 0
    v_mfma_f32_16x16x32_bf16 v[76:79], v[12:15], v[172:175], v[76:79]
    s_add_u32 s67, s36, 8192
    buffer_load_dwordx4 a[96:99], v4, s[4:7], s67 offen offset:1024 sc1
Lb_prompt_47:
    s_waitcnt lgkmcnt(2)
    v_mfma_f32_16x16x32_bf16 v[80:83], a[240:243], v[168:171], v[80:83]
    ds_read_b128 v[8:11], v4 offset:34816
    v_permlane32_swap_b32 v22, v23
    v_add_f32 v20, v22, v23
    v_mfma_f32_16x16x32_bf16 v[88:91], a[240:243], v[172:175], v[88:91]
    v_mov_b32 v22, v21
    v_mov_b32 v23, v21
    s_nop 0
    v_mfma_f32_16x16x32_bf16 v[84:87], a[244:247], v[168:171], v[84:87]
    ds_read_b128 v[12:15], v4 offset:35840
    v_permlane16_swap_b32 v22, v23
    v_add_f32 v21, v22, v23
    v_mfma_f32_16x16x32_bf16 v[92:95], a[244:247], v[172:175], v[92:95]
    v_mov_b32 v22, v21
    v_mov_b32 v23, v21
    s_waitcnt vmcnt(18)
    s_waitcnt lgkmcnt(2)
    v_mfma_f32_16x16x32_bf16 v[32:35], a[248:251], v[176:179], v[32:35]
    ds_read_b128 a[240:243], v4 offset:36864
    s_nop 0
    v_permlane32_swap_b32 v22, v23
    v_mfma_f32_16x16x32_bf16 v[40:43], a[248:251], v[180:183], v[40:43]
    s_add_u32 s67, s37, 4096
    buffer_load_dwordx4 a[100:103], v4, s[4:7], s67 offen offset:1024 sc1
Lb_prompt_48:
    v_add_f32 v21, v22, v23
    v_mfma_f32_16x16x32_bf16 v[36:39], a[252:255], v[176:179], v[36:39]
    ds_read_b128 a[244:247], v4 offset:37888
    v_mul_f32 v20, 0xbacccccd, v20
    v_mul_f32 v21, 0x3acccccd, v21
    v_mfma_f32_16x16x32_bf16 v[44:47], a[252:255], v[180:183], v[44:47]
    v_fma_f32 v21, -v20, v20, v21
    v_max_f32 v21, 0, v21
    s_waitcnt lgkmcnt(2)
    v_mfma_f32_16x16x32_bf16 v[48:51], v[8:11], v[176:179], v[48:51]
    ds_read_b128 a[248:251], v4 offset:38912
    v_add_f32 v21, 0x3727c5ac, v21
    v_mfma_f32_16x16x32_bf16 v[56:59], v[8:11], v[180:183], v[56:59]
    v_rsq_f32 v25, v21
    v_mfma_f32_16x16x32_bf16 v[52:55], v[12:15], v[176:179], v[52:55]
    ds_read_b128 a[252:255], v4 offset:39936
    v_sqrt_f32 v27, v21
    v_mfma_f32_16x16x32_bf16 v[60:63], v[12:15], v[180:183], v[60:63]
    buffer_load_dwordx4 a[104:107], v4, s[4:7], s67 offen offset:2048 sc1
Lb_prompt_49:
    s_barrier
    s_waitcnt vmcnt(16)
    s_waitcnt lgkmcnt(2)
    v_mfma_f32_16x16x32_bf16 v[32:35], a[240:243], v[184:187], v[32:35]
    ds_read_b128 v[8:11], v4 offset:40960
    v_cvt_pk_bf16_f32 v21, v20, v20
    v_mul_f32 v25, 0xbfb8aa3b, v25
    v_mfma_f32_16x16x32_bf16 v[40:43], a[240:243], v[188:191], v[40:43]
    v_and_b32 v22, 0xffff0000, v21
    v_sub_f32 v22, v20, v22
    v_cvt_pk_bf16_f32 v20, v20, v22
    v_mfma_f32_16x16x32_bf16 v[36:39], a[244:247], v[184:187], v[36:39]
    ds_read_b128 v[12:15], v4 offset:41984
    v_and_b32 v21, 0xffff, v21
    v_mov_b32 v22, 0
    v_mfma_f32_16x16x32_bf16 v[44:47], a[244:247], v[188:191], v[44:47]
    s_add_u32 m0, s57, 98304
    s_add_u32 s65, s58, 147456
    buffer_load_dwordx4 v4, s[4:7], s65 offen sc1 lds
    s_waitcnt lgkmcnt(2)
    v_mfma_f32_16x16x32_bf16 v[48:51], a[248:251], v[184:187], v[48:51]
    ds_read_b128 a[240:243], v4 offset:43008
    v_mov_b32 v23, 0
    v_mfma_f32_16x16x32_bf16 v[56:59], a[248:251], v[188:191], v[56:59]
    v_mfma_f32_16x16x32_bf16 v[52:55], a[252:255], v[184:187], v[52:55]
    ds_read_b128 a[244:247], v4 offset:44032
    v_mfma_f32_16x16x32_bf16 v[60:63], a[252:255], v[188:191], v[60:63]
    buffer_load_dwordx4 v4, s[4:7], s65 offen offset:1024 sc1 lds
    s_waitcnt vmcnt(16)
    s_waitcnt lgkmcnt(2)
    v_mfma_f32_16x16x32_bf16 v[32:35], v[8:11], v[192:195], v[32:35]
    ds_read_b128 a[248:251], v4 offset:45056
    v_mfma_f32_16x16x32_bf16 v[40:43], v[8:11], v[196:199], v[40:43]
    v_mfma_f32_16x16x32_bf16 v[36:39], v[12:15], v[192:195], v[36:39]
    ds_read_b128 a[252:255], v4 offset:46080
    v_mfma_f32_16x16x32_bf16 v[44:47], v[12:15], v[196:199], v[44:47]
    buffer_load_dwordx4 v4, s[4:7], s65 offen offset:2048 sc1 lds
    s_waitcnt lgkmcnt(2)
    v_mfma_f32_16x16x32_bf16 v[48:51], a[240:243], v[192:195], v[48:51]
    ds_read_b128 v[8:11], v4 offset:47104
    v_mfma_f32_16x16x32_bf16 v[56:59], a[240:243], v[196:199], v[56:59]
    v_mfma_f32_16x16x32_bf16 v[52:55], a[244:247], v[192:195], v[52:55]
    ds_read_b128 v[12:15], v4 offset:48128
    v_mfma_f32_16x16x32_bf16 v[60:63], a[244:247], v[196:199], v[60:63]
    buffer_load_dwordx4 v4, s[4:7], s65 offen offset:3072 sc1 lds
    s_waitcnt vmcnt(16)
    s_waitcnt lgkmcnt(2)
    v_mfma_f32_16x16x32_bf16 v[32:35], a[248:251], v[200:203], v[32:35]
    ds_read_b128 a[240:243], v4 offset:49152
    v_mfma_f32_16x16x32_bf16 v[40:43], a[248:251], v[204:207], v[40:43]
    v_mfma_f32_16x16x32_bf16 v[36:39], a[252:255], v[200:203], v[36:39]
    ds_read_b128 a[244:247], v4 offset:50176
    v_mfma_f32_16x16x32_bf16 v[44:47], a[252:255], v[204:207], v[44:47]
    s_add_u32 m0, s57, 114688
    s_add_u32 s65, s58, 163840
    buffer_load_dwordx4 v4, s[4:7], s65 offen sc1 lds
    s_waitcnt lgkmcnt(2)
    v_mfma_f32_16x16x32_bf16 v[48:51], v[8:11], v[200:203], v[48:51]
    ds_read_b128 a[248:251], v4 offset:51200
    v_mfma_f32_16x16x32_bf16 v[56:59], v[8:11], v[204:207], v[56:59]
    v_mfma_f32_16x16x32_bf16 v[52:55], v[12:15], v[200:203], v[52:55]
    ds_read_b128 a[252:255], v4 offset:52224
    v_mfma_f32_16x16x32_bf16 v[60:63], v[12:15], v[204:207], v[60:63]
    buffer_load_dwordx4 v4, s[4:7], s65 offen offset:1024 sc1 lds
    s_waitcnt vmcnt(16)
    s_waitcnt lgkmcnt(2)
    v_mfma_f32_16x16x32_bf16 v[32:35], a[240:243], v[208:211], v[32:35]
    ds_read_b128 v[8:11], v4 offset:53248
    v_mfma_f32_16x16x32_bf16 v[40:43], a[240:243], v[212:215], v[40:43]
    v_mfma_f32_16x16x32_bf16 v[36:39], a[244:247], v[208:211], v[36:39]
    ds_read_b128 v[12:15], v4 offset:54272
    v_mfma_f32_16x16x32_bf16 v[44:47], a[244:247], v[212:215], v[44:47]
    buffer_load_dwordx4 v4, s[4:7], s65 offen offset:2048 sc1 lds
    s_waitcnt lgkmcnt(2)
    v_mfma_f32_16x16x32_bf16 v[48:51], a[248:251], v[208:211], v[48:51]
    ds_read_b128 a[240:243], v4 offset:55296
    v_mfma_f32_16x16x32_bf16 v[56:59], a[248:251], v[212:215], v[56:59]
    v_mfma_f32_16x16x32_bf16 v[52:55], a[252:255], v[208:211], v[52:55]
    ds_read_b128 a[244:247], v4 offset:56320
    v_mfma_f32_16x16x32_bf16 v[60:63], a[252:255], v[212:215], v[60:63]
    buffer_load_dwordx4 v4, s[4:7], s65 offen offset:3072 sc1 lds
    s_waitcnt vmcnt(16)
    s_waitcnt lgkmcnt(2)
    v_mfma_f32_16x16x32_bf16 v[32:35], v[8:11], v[216:219], v[32:35]
    ds_read_b128 a[248:251], v4 offset:57344
    v_mfma_f32_16x16x32_bf16 v[40:43], v[8:11], v[220:223], v[40:43]
    v_mfma_f32_16x16x32_bf16 v[36:39], v[12:15], v[216:219], v[36:39]
    ds_read_b128 a[252:255], v4 offset:58368
    v_mfma_f32_16x16x32_bf16 v[44:47], v[12:15], v[220:223], v[44:47]
    s_add_u32 m0, s57, 131072
    s_add_u32 s65, s58, 180224
    buffer_load_dwordx4 v4, s[4:7], s65 offen sc1 lds
    s_waitcnt lgkmcnt(2)
    v_mfma_f32_16x16x32_bf16 v[48:51], a[240:243], v[216:219], v[48:51]
    ds_read_b128 v[8:11], v4 offset:59392
    v_mfma_f32_16x16x32_bf16 v[56:59], a[240:243], v[220:223], v[56:59]
    v_mfma_f32_16x16x32_bf16 v[52:55], a[244:247], v[216:219], v[52:55]
    ds_read_b128 v[12:15], v4 offset:60416
    v_mfma_f32_16x16x32_bf16 v[60:63], a[244:247], v[220:223], v[60:63]
    buffer_load_dwordx4 v4, s[4:7], s65 offen offset:1024 sc1 lds
    s_waitcnt vmcnt(16)
    s_waitcnt lgkmcnt(2)
    v_mfma_f32_16x16x32_bf16 v[32:35], a[248:251], v[224:227], v[32:35]
    ds_read_b128 a[240:243], v4 offset:61440
    v_mfma_f32_16x16x32_bf16 v[40:43], a[248:251], v[228:231], v[40:43]
    v_mfma_f32_16x16x32_bf16 v[36:39], a[252:255], v[224:227], v[36:39]
    ds_read_b128 a[244:247], v4 offset:62464
    v_mfma_f32_16x16x32_bf16 v[44:47], a[252:255], v[228:231], v[44:47]
    buffer_load_dwordx4 v4, s[4:7], s65 offen offset:2048 sc1 lds
    s_waitcnt lgkmcnt(2)
    v_mfma_f32_16x16x32_bf16 v[48:51], v[8:11], v[224:227], v[48:51]
    ds_read_b128 a[248:251], v4 offset:63488
    v_mfma_f32_16x16x32_bf16 v[56:59], v[8:11], v[228:231], v[56:59]
    v_mfma_f32_16x16x32_bf16 v[52:55], v[12:15], v[224:227], v[52:55]
    ds_read_b128 a[252:255], v4 offset:64512
    v_mfma_f32_16x16x32_bf16 v[60:63], v[12:15], v[228:231], v[60:63]
    buffer_load_dwordx4 v4, s[4:7], s65 offen offset:3072 sc1 lds
    s_waitcnt vmcnt(16)
    s_waitcnt lgkmcnt(2)
    v_mfma_f32_16x16x32_bf16 v[32:35], a[240:243], v[232:235], v[32:35]
    ds_read_b128 v[8:11], v5 offset:0
    v_mfma_f32_16x16x32_bf16 v[40:43], a[240:243], v[236:239], v[40:43]
    v_mfma_f32_16x16x32_bf16 v[36:39], a[244:247], v[232:235], v[36:39]
    ds_read_b128 v[12:15], v5 offset:1024
    v_mfma_f32_16x16x32_bf16 v[44:47], a[244:247], v[236:239], v[44:47]
    s_add_u32 m0, s57, 0
    s_add_u32 s65, s58, 196608
    buffer_load_dwordx4 v4, s[4:7], s65 offen sc1 lds
    s_waitcnt lgkmcnt(2)
    v_mfma_f32_16x16x32_bf16 v[48:51], a[248:251], v[232:235], v[48:51]
    ds_read_b128 a[240:243], v5 offset:2048
    v_mfma_f32_16x16x32_bf16 v[56:59], a[248:251], v[236:239], v[56:59]
    v_mfma_f32_16x16x32_bf16 v[52:55], a[252:255], v[232:235], v[52:55]
    ds_read_b128 a[244:247], v5 offset:3072
    v_mfma_f32_16x16x32_bf16 v[60:63], a[252:255], v[236:239], v[60:63]
    buffer_load_dwordx4 v4, s[4:7], s65 offen offset:1024 sc1 lds
    s_waitcnt vmcnt(16)
    s_waitcnt lgkmcnt(2)
    v_mfma_f32_16x16x32_bf16 v[32:35], v[8:11], v[240:243], v[32:35]
    ds_read_b128 a[248:251], v5 offset:4096
    v_mfma_f32_16x16x32_bf16 v[40:43], v[8:11], v[244:247], v[40:43]
    v_mfma_f32_16x16x32_bf16 v[36:39], v[12:15], v[240:243], v[36:39]
    ds_read_b128 a[252:255], v5 offset:5120
    v_mfma_f32_16x16x32_bf16 v[44:47], v[12:15], v[244:247], v[44:47]
    buffer_load_dwordx4 v4, s[4:7], s65 offen offset:2048 sc1 lds
    s_waitcnt lgkmcnt(2)
    v_mfma_f32_16x16x32_bf16 v[48:51], a[240:243], v[240:243], v[48:51]
    ds_read_b128 v[8:11], v5 offset:6144
    v_mfma_f32_16x16x32_bf16 v[56:59], a[240:243], v[244:247], v[56:59]
    v_mfma_f32_16x16x32_bf16 v[52:55], a[244:247], v[240:243], v[52:55]
    ds_read_b128 v[12:15], v5 offset:7168
    v_mfma_f32_16x16x32_bf16 v[60:63], a[244:247], v[244:247], v[60:63]
    buffer_load_dwordx4 v4, s[4:7], s65 offen offset:3072 sc1 lds
    s_waitcnt vmcnt(16)
    s_waitcnt lgkmcnt(2)
    v_mfma_f32_16x16x32_bf16 v[32:35], a[248:251], v[248:251], v[32:35]
    ds_read_b128 a[240:243], v5 offset:8192
    v_mfma_f32_16x16x32_bf16 v[40:43], a[248:251], v[252:255], v[40:43]
    v_mfma_f32_16x16x32_bf16 v[36:39], a[252:255], v[248:251], v[36:39]
    ds_read_b128 a[244:247], v5 offset:9216
    v_mfma_f32_16x16x32_bf16 v[44:47], a[252:255], v[252:255], v[44:47]
    s_add_u32 m0, s57, 16384
    s_add_u32 s65, s58, 212992
    buffer_load_dwordx4 v4, s[4:7], s65 offen sc1 lds
    s_waitcnt lgkmcnt(2)
    v_mfma_f32_16x16x32_bf16 v[48:51], v[8:11], v[248:251], v[48:51]
    ds_read_b128 a[248:251], v5 offset:10240
    v_mfma_f32_16x16x32_bf16 v[56:59], v[8:11], v[252:255], v[56:59]
    v_mfma_f32_16x16x32_bf16 v[52:55], v[12:15], v[248:251], v[52:55]
    ds_read_b128 a[252:255], v5 offset:11264
    v_mfma_f32_16x16x32_bf16 v[60:63], v[12:15], v[252:255], v[60:63]
    buffer_load_dwordx4 v4, s[4:7], s65 offen offset:1024 sc1 lds
    s_waitcnt lgkmcnt(2)
    v_mfma_f32_16x16x32_bf16 v[32:35], a[240:243], v[16:19], v[32:35]
    ds_read_b128 v[8:11], v5 offset:12288
    v_mfma_f32_16x16x32_bf16 v[40:43], a[240:243], v[20:23], v[40:43]
    v_mfma_f32_16x16x32_bf16 v[36:39], a[244:247], v[16:19], v[36:39]
    ds_read_b128 v[12:15], v5 offset:13312
    v_mfma_f32_16x16x32_bf16 v[44:47], a[244:247], v[20:23], v[44:47]
    buffer_load_dwordx4 v4, s[4:7], s65 offen offset:2048 sc1 lds
    s_waitcnt lgkmcnt(2)
    v_mfma_f32_16x16x32_bf16 v[48:51], a[248:251], v[16:19], v[48:51]
    ds_read_b128 a[240:243], v5 offset:14336
    v_mfma_f32_16x16x32_bf16 v[56:59], a[248:251], v[20:23], v[56:59]
    v_mfma_f32_16x16x32_bf16 v[52:55], a[252:255], v[16:19], v[52:55]
    ds_read_b128 a[244:247], v5 offset:15360
    v_mfma_f32_16x16x32_bf16 v[60:63], a[252:255], v[20:23], v[60:63]
    buffer_load_dwordx4 v4, s[4:7], s65 offen offset:3072 sc1 lds
    s_waitcnt lgkmcnt(2)
    v_mfma_f32_16x16x32_bf16 v[64:67], v[8:11], v[176:179], v[64:67]
    ds_read_b128 a[248:251], v5 offset:16384
    v_mfma_f32_16x16x32_bf16 v[72:75], v[8:11], v[180:183], v[72:75]
    v_mfma_f32_16x16x32_bf16 v[68:71], v[12:15], v[176:179], v[68:71]
    ds_read_b128 a[252:255], v5 offset:17408
    v_mfma_f32_16x16x32_bf16 v[76:79], v[12:15], v[180:183], v[76:79]
    s_waitcnt lgkmcnt(2)
    v_mfma_f32_16x16x32_bf16 v[80:83], a[240:243], v[176:179], v[80:83]
    ds_read_b128 v[8:11], v5 offset:18432
    v_mul_f32 v32, v32, v24
    v_mul_f32 v33, v33, v24
    v_mfma_f32_16x16x32_bf16 v[88:91], a[240:243], v[180:183], v[88:91]
    buffer_load_dwordx4 a[108:111], v4, s[4:7], s67 offen offset:3072 sc1
Lb_prompt_50:
    v_mul_f32 v34, v34, v24
    v_mfma_f32_16x16x32_bf16 v[84:87], a[244:247], v[176:179], v[84:87]
    ds_read_b128 v[12:15], v5 offset:19456
    v_exp_f32 v32, v32
    v_mfma_f32_16x16x32_bf16 v[92:95], a[244:247], v[180:183], v[92:95]
    v_mul_f32 v35, v35, v24
    s_waitcnt lgkmcnt(2)
    v_mfma_f32_16x16x32_bf16 v[64:67], a[248:251], v[184:187], v[64:67]
    ds_read_b128 a[240:243], v5 offset:20480
    v_exp_f32 v33, v33
    v_mfma_f32_16x16x32_bf16 v[72:75], a[248:251], v[188:191], v[72:75]
    v_mul_f32 v36, v36, v24
    v_exp_f32 v34, v34
    v_mfma_f32_16x16x32_bf16 v[68:71], a[252:255], v[184:187], v[68:71]
    ds_read_b128 a[244:247], v5 offset:21504
    v_fma_f32 v32, v32, v26, v26
    v_mul_f32 v37, v37, v24
    v_mfma_f32_16x16x32_bf16 v[76:79], a[252:255], v[188:191], v[76:79]
    v_exp_f32 v35, v35
    s_waitcnt lgkmcnt(2)
    v_mfma_f32_16x16x32_bf16 v[80:83], v[8:11], v[184:187], v[80:83]
    ds_read_b128 a[248:251], v5 offset:22528
    v_fma_f32 v33, v33, v26, v26
    v_mul_f32 v38, v38, v24
    v_mfma_f32_16x16x32_bf16 v[88:91], v[8:11], v[188:191], v[88:91]
    v_exp_f32 v36, v36
    v_fma_f32 v34, v34, v26, v26
    v_mfma_f32_16x16x32_bf16 v[84:87], v[12:15], v[184:187], v[84:87]
    ds_read_b128 a[252:255], v5 offset:23552
    v_rcp_f32 v32, v32
    v_mfma_f32_16x16x32_bf16 v[92:95], v[12:15], v[188:191], v[92:95]
    v_mul_f32 v39, v39, v24
    s_waitcnt lgkmcnt(2)
    v_mfma_f32_16x16x32_bf16 v[64:67], a[240:243], v[192:195], v[64:67]
    ds_read_b128 v[8:11], v5 offset:24576
    v_exp_f32 v37, v37
    v_mfma_f32_16x16x32_bf16 v[72:75], a[240:243], v[196:199], v[72:75]
    v_fma_f32 v35, v35, v26, v26
    v_rcp_f32 v33, v33
    v_mfma_f32_16x16x32_bf16 v[68:71], a[244:247], v[192:195], v[68:71]
    ds_read_b128 v[12:15], v5 offset:25600
    v_mul_f32 v40, v40, v25
    v_mfma_f32_16x16x32_bf16 v[76:79], a[244:247], v[196:199], v[76:79]
    v_exp_f32 v38, v38
    s_waitcnt lgkmcnt(2)
    v_mfma_f32_16x16x32_bf16 v[80:83], a[248:251], v[192:195], v[80:83]
    ds_read_b128 a[240:243], v5 offset:26624
    v_fma_f32 v36, v36, v26, v26
    v_mfma_f32_16x16x32_bf16 v[88:91], a[248:251], v[196:199], v[88:91]
    v_rcp_f32 v34, v34
    v_mul_f32 v48, v48, v32
    v_mfma_f32_16x16x32_bf16 v[84:87], a[252:255], v[192:195], v[84:87]
    ds_read_b128 a[244:247], v5 offset:27648
    v_mul_f32 v41, v41, v25
    v_mfma_f32_16x16x32_bf16 v[92:95], a[252:255], v[196:199], v[92:95]
    v_exp_f32 v39, v39
    s_waitcnt lgkmcnt(2)
    v_mfma_f32_16x16x32_bf16 v[64:67], v[8:11], v[200:203], v[64:67]
    ds_read_b128 a[248:251], v5 offset:28672
    v_fma_f32 v37, v37, v26, v26
    v_mfma_f32_16x16x32_bf16 v[72:75], v[8:11], v[204:207], v[72:75]
    v_rcp_f32 v35, v35
    v_mul_f32 v49, v49, v33
    v_mfma_f32_16x16x32_bf16 v[68:71], v[12:15], v[200:203], v[68:71]
    ds_read_b128 a[252:255], v5 offset:29696
    v_mul_f32 v42, v42, v25
    v_mfma_f32_16x16x32_bf16 v[76:79], v[12:15], v[204:207], v[76:79]
    v_exp_f32 v40, v40
    s_waitcnt lgkmcnt(2)
    v_mfma_f32_16x16x32_bf16 v[80:83], a[240:243], v[200:203], v[80:83]
    ds_read_b128 v[8:11], v5 offset:30720
    v_fma_f32 v38, v38, v26, v26
    v_mfma_f32_16x16x32_bf16 v[88:91], a[240:243], v[204:207], v[88:91]
    v_rcp_f32 v36, v36
    v_mul_f32 v50, v50, v34
    v_mfma_f32_16x16x32_bf16 v[84:87], a[244:247], v[200:203], v[84:87]
    ds_read_b128 v[12:15], v5 offset:31744
    v_mul_f32 v43, v43, v25
    v_mfma_f32_16x16x32_bf16 v[92:95], a[244:247], v[204:207], v[92:95]
    v_exp_f32 v41, v41
    s_waitcnt vmcnt(4)
    s_barrier
    s_waitcnt lgkmcnt(2)
    v_mfma_f32_16x16x32_bf16 v[64:67], a[248:251], v[208:211], v[64:67]
    ds_read_b128 a[240:243], v5 offset:32768
    v_fma_f32 v39, v39, v26, v26
    v_mfma_f32_16x16x32_bf16 v[72:75], a[248:251], v[212:215], v[72:75]
    s_add_u32 m0, s57, 32768
    s_add_u32 s65, s58, 229376
    buffer_load_dwordx4 v4, s[4:7], s65 offen sc1 lds
    v_mfma_f32_16x16x32_bf16 v[68:71], a[252:255], v[208:211], v[68:71]
    ds_read_b128 a[244:247], v5 offset:33792
    v_rcp_f32 v37, v37
    v_mfma_f32_16x16x32_bf16 v[76:79], a[252:255], v[212:215], v[76:79]
    v_mul_f32 v51, v51, v35
    v_cvt_pk_bf16_f32 v32, v48, v49
    s_waitcnt lgkmcnt(2)
    v_mfma_f32_16x16x32_bf16 v[80:83], v[8:11], v[208:211], v[80:83]
    ds_read_b128 a[248:251], v5 offset:34816
    v_mul_f32 v44, v44, v25
    v_mfma_f32_16x16x32_bf16 v[88:91], v[8:11], v[212:215], v[88:91]
    buffer_load_dwordx4 v4, s[4:7], s65 offen offset:1024 sc1 lds
    v_exp_f32 v42, v42
    v_mfma_f32_16x16x32_bf16 v[84:87], v[12:15], v[208:211], v[84:87]
    ds_read_b128 a[252:255], v5 offset:35840
    v_fma_f32 v40, v40, v27, v27
    v_mfma_f32_16x16x32_bf16 v[92:95], v[12:15], v[212:215], v[92:95]
    v_rcp_f32 v38, v38
    s_waitcnt lgkmcnt(2)
    v_mfma_f32_16x16x32_bf16 v[64:67], a[240:243], v[216:219], v[64:67]
    ds_read_b128 v[8:11], v5 offset:36864
    v_mul_f32 v52, v52, v36
    v_mul_f32 v45, v45, v25
    v_mfma_f32_16x16x32_bf16 v[72:75], a[240:243], v[220:223], v[72:75]
    buffer_load_dwordx4 v4, s[4:7], s65 offen offset:2048 sc1 lds
    v_exp_f32 v43, v43
    v_mfma_f32_16x16x32_bf16 v[68:71], a[244:247], v[216:219], v[68:71]
    ds_read_b128 v[12:15], v5 offset:37888
    v_fma_f32 v41, v41, v27, v27
    v_mfma_f32_16x16x32_bf16 v[76:79], a[244:247], v[220:223], v[76:79]
    v_rcp_f32 v39, v39
    s_waitcnt lgkmcnt(2)
    v_mfma_f32_16x16x32_bf16 v[80:83], a[248:251], v[216:219], v[80:83]
    ds_read_b128 a[240:243], v5 offset:38912
    v_mul_f32 v53, v53, v37
    v_cvt_pk_bf16_f32 v33, v50, v51
    v_mfma_f32_16x16x32_bf16 v[88:91], a[248:251], v[220:223], v[88:91]
    buffer_load_dwordx4 v4, s[4:7], s65 offen offset:3072 sc1 lds
    v_mul_f32 v46, v46, v25
    v_mfma_f32_16x16x32_bf16 v[84:87], a[252:255], v[216:219], v[84:87]
    ds_read_b128 a[244:247], v5 offset:39936
    v_exp_f32 v44, v44
    v_mfma_f32_16x16x32_bf16 v[92:95], a[252:255], v[220:223], v[92:95]
    v_fma_f32 v42, v42, v27, v27
    s_waitcnt lgkmcnt(2)
    v_mfma_f32_16x16x32_bf16 v[64:67], v[8:11], v[224:227], v[64:67]
    ds_read_b128 a[248:251], v5 offset:40960
    v_rcp_f32 v40, v40
    v_mfma_f32_16x16x32_bf16 v[72:75], v[8:11], v[228:231], v[72:75]
    s_add_u32 m0, s57, 49152
    s_add_u32 s65, s58, 245760
    buffer_load_dwordx4 v4, s[4:7], s65 offen sc1 lds
    v_mfma_f32_16x16x32_bf16 v[68:71], v[12:15], v[224:227], v[68:71]
    ds_read_b128 a[252:255], v5 offset:41984
    v_mul_f32 v54, v54, v38
    v_mul_f32 v47, v47, v25
    v_mfma_f32_16x16x32_bf16 v[76:79], v[12:15], v[228:231], v[76:79]
    v_exp_f32 v45, v45
    s_waitcnt lgkmcnt(2)
    v_mfma_f32_16x16x32_bf16 v[80:83], a[240:243], v[224:227], v[80:83]
    ds_read_b128 v[8:11], v5 offset:43008
    v_fma_f32 v43, v43, v27, v27
    v_mfma_f32_16x16x32_bf16 v[88:91], a[240:243], v[228:231], v[88:91]
    buffer_load_dwordx4 v4, s[4:7], s65 offen offset:1024 sc1 lds
    v_rcp_f32 v41, v41
    v_mfma_f32_16x16x32_bf16 v[84:87], a[244:247], v[224:227], v[84:87]
    ds_read_b128 v[12:15], v5 offset:44032
    v_mul_f32 v55, v55, v39
    v_cvt_pk_bf16_f32 v34, v52, v53
    v_mfma_f32_16x16x32_bf16 v[92:95], a[244:247], v[228:231], v[92:95]
    v_exp_f32 v46, v46
    s_waitcnt lgkmcnt(2)
    v_mfma_f32_16x16x32_bf16 v[64:67], a[248:251], v[232:235], v[64:67]
    ds_read_b128 a[240:243], v5 offset:45056
    v_fma_f32 v44, v44, v27, v27
    v_mfma_f32_16x16x32_bf16 v[72:75], a[248:251], v[236:239], v[72:75]
    buffer_load_dwordx4 v4, s[4:7], s65 offen offset:2048 sc1 lds
    v_rcp_f32 v42, v42
    v_mfma_f32_16x16x32_bf16 v[68:71], a[252:255], v[232:235], v[68:71]
    ds_read_b128 a[244:247], v5 offset:46080
    v_mul_f32 v56, v56, v40
    v_mfma_f32_16x16x32_bf16 v[76:79], a[252:255], v[236:239], v[76:79]
    v_exp_f32 v47, v47
    s_waitcnt lgkmcnt(2)
    v_mfma_f32_16x16x32_bf16 v[80:83], v[8:11], v[232:235], v[80:83]
    ds_read_b128 a[248:251], v5 offset:47104
    v_fma_f32 v45, v45, v27, v27
    v_mfma_f32_16x16x32_bf16 v[88:91], v[8:11], v[236:239], v[88:91]
    buffer_load_dwordx4 v4, s[4:7], s65 offen offset:3072 sc1 lds
    v_rcp_f32 v43, v43
    v_mfma_f32_16x16x32_bf16 v[84:87], v[12:15], v[232:235], v[84:87]
    ds_read_b128 a[252:255], v5 offset:48128
    v_mul_f32 v57, v57, v41
    v_cvt_pk_bf16_f32 v35, v54, v55
    v_mfma_f32_16x16x32_bf16 v[92:95], v[12:15], v[236:239], v[92:95]
    buffer_store_dwordx4 v[32:35], v4, s[4:7], s27 offen offset:0 sc1
    v_fma_f32 v46, v46, v27, v27
    s_waitcnt lgkmcnt(2)
    v_mfma_f32_16x16x32_bf16 v[64:67], a[240:243], v[240:243], v[64:67]
    ds_read_b128 v[8:11], v5 offset:49152
    v_rcp_f32 v44, v44
    v_mfma_f32_16x16x32_bf16 v[72:75], a[240:243], v[244:247], v[72:75]
    v_mul_f32 v58, v58, v42
    v_fma_f32 v47, v47, v27, v27
    v_mfma_f32_16x16x32_bf16 v[68:71], a[244:247], v[240:243], v[68:71]
    ds_read_b128 v[12:15], v5 offset:50176
    v_rcp_f32 v45, v45
    v_mfma_f32_16x16x32_bf16 v[76:79], a[244:247], v[244:247], v[76:79]
    s_add_u32 s67, s37, 8192
    buffer_load_dwordx4 a[112:115], v4, s[4:7], s67 offen sc1
Lb_prompt_51:
    s_waitcnt lgkmcnt(2)
    v_mfma_f32_16x16x32_bf16 v[80:83], a[248:251], v[240:243], v[80:83]
    ds_read_b128 a[240:243], v5 offset:51200
    v_mul_f32 v59, v59, v43
    v_cvt_pk_bf16_f32 v36, v56, v57
    v_mfma_f32_16x16x32_bf16 v[88:91], a[248:251], v[244:247], v[88:91]
    v_rcp_f32 v46, v46
    v_mul_f32 v60, v60, v44
    v_mfma_f32_16x16x32_bf16 v[84:87], a[252:255], v[240:243], v[84:87]
    ds_read_b128 a[244:247], v5 offset:52224
    v_rcp_f32 v47, v47
    v_mfma_f32_16x16x32_bf16 v[92:95], a[252:255], v[244:247], v[92:95]
    v_mul_f32 v61, v61, v45
    v_cvt_pk_bf16_f32 v37, v58, v59
    s_waitcnt lgkmcnt(2)
    v_mfma_f32_16x16x32_bf16 v[64:67], v[8:11], v[248:251], v[64:67]
    ds_read_b128 a[248:251], v5 offset:53248
    v_mul_f32 v62, v62, v46
    v_mul_f32 v63, v63, v47
    v_mfma_f32_16x16x32_bf16 v[72:75], v[8:11], v[252:255], v[72:75]
    buffer_load_dwordx4 a[116:119], v4, s[4:7], s67 offen offset:1024 sc1
Lb_prompt_52:
    v_cvt_pk_bf16_f32 v38, v60, v61
    v_mfma_f32_16x16x32_bf16 v[68:71], v[12:15], v[248:251], v[68:71]
    ds_read_b128 a[252:255], v5 offset:54272
    v_cvt_pk_bf16_f32 v39, v62, v63
    buffer_store_dwordx4 v[36:39], v4, s[4:7], s15 offen offset:0 sc1
    v_mfma_f32_16x16x32_bf16 v[76:79], v[12:15], v[252:255], v[76:79]
    s_waitcnt lgkmcnt(2)
    v_mfma_f32_16x16x32_bf16 v[80:83], a[240:243], v[248:251], v[80:83]
    ds_read_b128 v[8:11], v5 offset:55296
    v_mfma_f32_16x16x32_bf16 v[88:91], a[240:243], v[252:255], v[88:91]
    v_mfma_f32_16x16x32_bf16 v[84:87], a[244:247], v[248:251], v[84:87]
    ds_read_b128 v[12:15], v5 offset:56320
    v_mfma_f32_16x16x32_bf16 v[92:95], a[244:247], v[252:255], v[92:95]
    s_add_u32 s67, s38, 4096
    buffer_load_dwordx4 a[120:123], v4, s[4:7], s67 offen offset:1024 sc1
Lb_prompt_53:
    s_waitcnt lgkmcnt(2)
    v_mfma_f32_16x16x32_bf16 v[64:67], a[248:251], v[16:19], v[64:67]
    ds_read_b128 a[240:243], v5 offset:57344
    v_mfma_f32_16x16x32_bf16 v[72:75], a[248:251], v[20:23], v[72:75]
    v_mfma_f32_16x16x32_bf16 v[68:71], a[252:255], v[16:19], v[68:71]
    ds_read_b128 a[244:247], v5 offset:58368
    v_mfma_f32_16x16x32_bf16 v[76:79], a[252:255], v[20:23], v[76:79]
    s_waitcnt lgkmcnt(2)
    v_mfma_f32_16x16x32_bf16 v[80:83], v[8:11], v[16:19], v[80:83]
    ds_read_b128 a[248:251], v5 offset:59392
    v_mfma_f32_16x16x32_bf16 v[88:91], v[8:11], v[20:23], v[88:91]
    buffer_load_dwordx4 a[124:127], v4, s[4:7], s67 offen offset:2048 sc1
Lb_prompt_54:
    v_mfma_f32_16x16x32_bf16 v[84:87], v[12:15], v[16:19], v[84:87]
    ds_read_b128 a[252:255], v5 offset:60416
    v_mfma_f32_16x16x32_bf16 v[92:95], v[12:15], v[20:23], v[92:95]
    s_waitcnt lgkmcnt(2)
    v_mfma_f32_16x16x32_bf16 v[32:35], a[240:243], v[96:99], 0
    ds_read_b128 v[8:11], v5 offset:61440
    v_mfma_f32_16x16x32_bf16 v[40:43], a[240:243], v[100:103], 0
    v_mfma_f32_16x16x32_bf16 v[36:39], a[244:247], v[96:99], 0
    ds_read_b128 v[12:15], v5 offset:62464
    v_mfma_f32_16x16x32_bf16 v[44:47], a[244:247], v[100:103], 0
    buffer_load_dwordx4 a[128:131], v4, s[4:7], s67 offen offset:3072 sc1
Lb_prompt_55:
    s_waitcnt lgkmcnt(2)
    v_mfma_f32_16x16x32_bf16 v[48:51], a[248:251], v[96:99], 0
    ds_read_b128 a[240:243], v5 offset:63488
    v_mul_f32 v64, v64, v24
    v_mul_f32 v65, v65, v24
    v_mfma_f32_16x16x32_bf16 v[56:59], a[248:251], v[100:103], 0
    v_mul_f32 v66, v66, v24
    v_exp_f32 v64, v64
    v_mfma_f32_16x16x32_bf16 v[52:55], a[252:255], v[96:99], 0
    ds_read_b128 a[244:247], v5 offset:64512
    v_mul_f32 v67, v67, v24
    v_mfma_f32_16x16x32_bf16 v[60:63], a[252:255], v[100:103], 0
    v_exp_f32 v65, v65
    s_waitcnt lgkmcnt(2)
    v_mfma_f32_16x16x32_bf16 v[32:35], v[8:11], v[104:107], v[32:35]
    ds_read_b128 a[248:251], v6 offset:0
    v_mul_f32 v68, v68, v24
    v_mfma_f32_16x16x32_bf16 v[40:43], v[8:11], v[108:111], v[40:43]
    s_add_u32 s67, s38, 8192
    buffer_load_dwordx4 a[132:135], v4, s[4:7], s67 offen sc1
Lb_prompt_56:
    v_mfma_f32_16x16x32_bf16 v[36:39], v[12:15], v[104:107], v[36:39]
    ds_read_b128 a[252:255], v6 offset:1024
    v_exp_f32 v66, v66
    v_mfma_f32_16x16x32_bf16 v[44:47], v[12:15], v[108:111], v[44:47]
    v_fma_f32 v64, v64, v26, v26
    v_mul_f32 v69, v69, v24
    s_waitcnt lgkmcnt(2)
    v_mfma_f32_16x16x32_bf16 v[48:51], a[240:243], v[104:107], v[48:51]
    ds_read_b128 v[8:11], v6 offset:2048
    v_exp_f32 v67, v67
    v_mfma_f32_16x16x32_bf16 v[56:59], a[240:243], v[108:111], v[56:59]
    v_fma_f32 v65, v65, v26, v26
    v_mul_f32 v70, v70, v24
    v_mfma_f32_16x16x32_bf16 v[52:55], a[244:247], v[104:107], v[52:55]
    ds_read_b128 v[12:15], v6 offset:3072
    v_exp_f32 v68, v68
    v_mfma_f32_16x16x32_bf16 v[60:63], a[244:247], v[108:111], v[60:63]
    buffer_load_dwordx4 a[136:139], v4, s[4:7], s67 offen offset:1024 sc1
Lb_prompt_57:
    s_waitcnt lgkmcnt(2)
    v_mfma_f32_16x16x32_bf16 v[32:35], a[248:251], v[112:115], v[32:35]
    ds_read_b128 a[240:243], v6 offset:4096
    v_fma_f32 v66, v66, v26, v26
    v_mfma_f32_16x16x32_bf16 v[40:43], a[248:251], v[116:119], v[40:43]
    v_rcp_f32 v64, v64
    v_mul_f32 v71, v71, v24
    v_mfma_f32_16x16x32_bf16 v[36:39], a[252:255], v[112:115], v[36:39]
    ds_read_b128 a[244:247], v6 offset:5120
    v_exp_f32 v69, v69
    v_mfma_f32_16x16x32_bf16 v[44:47], a[252:255], v[116:119], v[44:47]
    v_fma_f32 v67, v67, v26, v26
    s_waitcnt lgkmcnt(2)
    v_mfma_f32_16x16x32_bf16 v[48:51], v[8:11], v[112:115], v[48:51]
    ds_read_b128 a[248:251], v6 offset:6144
    v_rcp_f32 v65, v65
    v_mfma_f32_16x16x32_bf16 v[56:59], v[8:11], v[116:119], v[56:59]
    s_add_u32 s67, s39, 4096
    buffer_load_dwordx4 a[140:143], v4, s[4:7], s67 offen offset:1024 sc1
Lb_prompt_58:
    v_mul_f32 v72, v72, v25
    v_mfma_f32_16x16x32_bf16 v[52:55], v[12:15], v[112:115], v[52:55]
    ds_read_b128 a[252:255], v6 offset:7168
    v_exp_f32 v70, v70
    v_mfma_f32_16x16x32_bf16 v[60:63], v[12:15], v[116:119], v[60:63]
    v_fma_f32 v68, v68, v26, v26
    s_waitcnt lgkmcnt(2)
    v_mfma_f32_16x16x32_bf16 v[32:35], a[240:243], v[120:123], v[32:35]
    ds_read_b128 v[8:11], v6 offset:8192
    v_rcp_f32 v66, v66
    v_mfma_f32_16x16x32_bf16 v[40:43], a[240:243], v[124:127], v[40:43]
    v_mul_f32 v80, v80, v64
    v_mul_f32 v73, v73, v25
    v_mfma_f32_16x16x32_bf16 v[36:39], a[244:247], v[120:123], v[36:39]
    ds_read_b128 v[12:15], v6 offset:9216
    v_exp_f32 v71, v71
    v_mfma_f32_16x16x32_bf16 v[44:47], a[244:247], v[124:127], v[44:47]
    buffer_load_dwordx4 a[144:147], v4, s[4:7], s67 offen offset:2048 sc1
Lb_prompt_59:
    s_waitcnt lgkmcnt(2)
    v_mfma_f32_16x16x32_bf16 v[48:51], a[248:251], v[120:123], v[48:51]
    ds_read_b128 a[240:243], v6 offset:10240
    v_fma_f32 v69, v69, v26, v26
    v_mfma_f32_16x16x32_bf16 v[56:59], a[248:251], v[124:127], v[56:59]
    v_rcp_f32 v67, v67
    v_mul_f32 v81, v81, v65
    v_mfma_f32_16x16x32_bf16 v[52:55], a[252:255], v[120:123], v[52:55]
    ds_read_b128 a[244:247], v6 offset:11264
    v_mul_f32 v74, v74, v25
    v_mfma_f32_16x16x32_bf16 v[60:63], a[252:255], v[124:127], v[60:63]
    v_exp_f32 v72, v72
    s_waitcnt lgkmcnt(2)
    v_mfma_f32_16x16x32_bf16 v[32:35], v[8:11], v[128:131], v[32:35]
    ds_read_b128 a[248:251], v6 offset:12288
    v_fma_f32 v70, v70, v26, v26
    v_mfma_f32_16x16x32_bf16 v[40:43], v[8:11], v[132:135], v[40:43]
    buffer_load_dwordx4 a[148:151], v4, s[4:7], s67 offen offset:3072 sc1
Lb_prompt_60:
    v_mfma_f32_16x16x32_bf16 v[36:39], v[12:15], v[128:131], v[36:39]
    ds_read_b128 a[252:255], v6 offset:13312
    v_rcp_f32 v68, v68
    v_mfma_f32_16x16x32_bf16 v[44:47], v[12:15], v[132:135], v[44:47]
    v_mul_f32 v82, v82, v66
    v_mul_f32 v75, v75, v25
    s_waitcnt lgkmcnt(2)
    v_mfma_f32_16x16x32_bf16 v[48:51], a[240:243], v[128:131], v[48:51]
    ds_read_b128 v[8:11], v6 offset:14336
    v_exp_f32 v73, v73
    v_mfma_f32_16x16x32_bf16 v[56:59], a[240:243], v[132:135], v[56:59]
    v_fma_f32 v71, v71, v26, v26
    v_rcp_f32 v69, v69
    v_mfma_f32_16x16x32_bf16 v[52:55], a[244:247], v[128:131], v[52:55]
    ds_read_b128 v[12:15], v6 offset:15360
    v_mul_f32 v83, v83, v67
    v_cvt_pk_bf16_f32 v64, v80, v81
    v_mfma_f32_16x16x32_bf16 v[60:63], a[244:247], v[132:135], v[60:63]
    s_add_u32 s67, s39, 8192
    buffer_load_dwordx4 a[152:155], v4, s[4:7], s67 offen sc1
Lb_prompt_61:
    s_waitcnt lgkmcnt(2)
    v_mfma_f32_16x16x32_bf16 v[32:35], a[248:251], v[136:139], v[32:35]
    ds_read_b128 a[240:243], v4 offset:0
    v_mul_f32 v76, v76, v25
    v_mfma_f32_16x16x32_bf16 v[40:43], a[248:251], v[140:143], v[40:43]
    v_exp_f32 v74, v74
    v_fma_f32 v72, v72, v27, v27
    s_waitcnt vmcnt(0)
    s_barrier
    s_cmp_lg_u32 s3, 0
    s_cbranch_scc1 Lw_prompt_62
    s_add_u32 s21, s64, 35651840
    s_mov_b64 exec, 1
    buffer_atomic_add v31, v30, s[4:7], s21 offen sc1
    s_mov_b64 exec, -1
Lw_prompt_62:
    v_mfma_f32_16x16x32_bf16 v[36:39], a[252:255], v[136:139], v[36:39]
    ds_read_b128 a[244:247], v4 offset:1024
    v_rcp_f32 v70, v70
    v_mfma_f32_16x16x32_bf16 v[44:47], a[252:255], v[140:143], v[44:47]
    v_mul_f32 v84, v84, v68
    v_mul_f32 v77, v77, v25
    s_waitcnt lgkmcnt(2)
    v_mfma_f32_16x16x32_bf16 v[48:51], v[8:11], v[136:139], v[48:51]
    ds_read_b128 a[248:251], v4 offset:2048
    v_exp_f32 v75, v75
    v_mfma_f32_16x16x32_bf16 v[56:59], v[8:11], v[140:143], v[56:59]
    buffer_load_dwordx4 a[156:159], v4, s[4:7], s67 offen offset:1024 sc1
Lb_prompt_63:
    v_fma_f32 v73, v73, v27, v27
    v_mfma_f32_16x16x32_bf16 v[52:55], v[12:15], v[136:139], v[52:55]
    ds_read_b128 a[252:255], v4 offset:3072
    v_rcp_f32 v71, v71
    v_mfma_f32_16x16x32_bf16 v[60:63], v[12:15], v[140:143], v[60:63]
    v_mul_f32 v85, v85, v69
    v_cvt_pk_bf16_f32 v65, v82, v83
    s_waitcnt lgkmcnt(2)
    v_mfma_f32_16x16x32_bf16 v[32:35], a[240:243], v[144:147], v[32:35]
    ds_read_b128 v[8:11], v4 offset:4096
    v_mul_f32 v78, v78, v25
    v_mfma_f32_16x16x32_bf16 v[40:43], a[240:243], v[148:151], v[40:43]
    v_exp_f32 v76, v76
    v_fma_f32 v74, v74, v27, v27
    v_mfma_f32_16x16x32_bf16 v[36:39], a[244:247], v[144:147], v[36:39]
    ds_read_b128 v[12:15], v4 offset:5120
    v_rcp_f32 v72, v72
    v_mfma_f32_16x16x32_bf16 v[44:47], a[244:247], v[148:151], v[44:47]
    s_add_u32 s67, s36, 8192
    buffer_load_dwordx4 a[160:163], v4, s[4:7], s67 offen offset:2048 sc1
Lb_prompt_64:
    s_waitcnt lgkmcnt(2)
    v_mfma_f32_16x16x32_bf16 v[48:51], a[248:251], v[144:147], v[48:51]
    ds_read_b128 a[240:243], v4 offset:6144
    v_mul_f32 v86, v86, v70
    v_mul_f32 v79, v79, v25
    v_mfma_f32_16x16x32_bf16 v[56:59], a[248:251], v[148:151], v[56:59]
    v_exp_f32 v77, v77
    v_fma_f32 v75, v75, v27, v27
    v_mfma_f32_16x16x32_bf16 v[52:55], a[252:255], v[144:147], v[52:55]
    ds_read_b128 a[244:247], v4 offset:7168
    v_rcp_f32 v73, v73
    v_mfma_f32_16x16x32_bf16 v[60:63], a[252:255], v[148:151], v[60:63]
    v_mul_f32 v87, v87, v71
    v_cvt_pk_bf16_f32 v66, v84, v85
    s_waitcnt lgkmcnt(2)
    v_mfma_f32_16x16x32_bf16 v[32:35], v[8:11], v[152:155], v[32:35]
    ds_read_b128 a[248:251], v4 offset:8192
    v_exp_f32 v78, v78
    v_mfma_f32_16x16x32_bf16 v[40:43], v[8:11], v[156:159], v[40:43]
    buffer_load_dwordx4 a[164:167], v4, s[4:7], s67 offen offset:3072 sc1
Lb_prompt_65:
    v_fma_f32 v76, v76, v27, v27
    v_mfma_f32_16x16x32_bf16 v[36:39], v[12:15], v[152:155], v[36:39]
    ds_read_b128 a[252:255], v4 offset:9216
    v_rcp_f32 v74, v74
    v_mfma_f32_16x16x32_bf16 v[44:47], v[12:15], v[156:159], v[44:47]
    v_mul_f32 v88, v88, v72
    s_waitcnt lgkmcnt(2)
    v_mfma_f32_16x16x32_bf16 v[48:51], a[240:243], v[152:155], v[48:51]
    ds_read_b128 v[8:11], v4 offset:10240
    v_exp_f32 v79, v79
    v_mfma_f32_16x16x32_bf16 v[56:59], a[240:243], v[156:159], v[56:59]
    v_fma_f32 v77, v77, v27, v27
    v_rcp_f32 v75, v75
    v_mfma_f32_16x16x32_bf16 v[52:55], a[244:247], v[152:155], v[52:55]
    ds_read_b128 v[12:15], v4 offset:11264
    v_mul_f32 v89, v89, v73
    v_cvt_pk_bf16_f32 v67, v86, v87
    v_mfma_f32_16x16x32_bf16 v[60:63], a[244:247], v[156:159], v[60:63]
    s_add_u32 s67, s36, 12288
    buffer_load_dwordx4 a[168:171], v4, s[4:7], s67 offen sc1
Lb_prompt_66:
    s_waitcnt lgkmcnt(2)
    v_mfma_f32_16x16x32_bf16 v[32:35], a[248:251], v[160:163], v[32:35]
    ds_read_b128 a[240:243], v4 offset:12288
    buffer_store_dwordx4 v[64:67], v4, s[4:7], s27 offen offset:1024 sc1
    v_fma_f32 v78, v78, v27, v27
    v_mfma_f32_16x16x32_bf16 v[40:43], a[248:251], v[164:167], v[40:43]
    v_rcp_f32 v76, v76
    v_mul_f32 v90, v90, v74
    v_mfma_f32_16x16x32_bf16 v[36:39], a[252:255], v[160:163], v[36:39]
    ds_read_b128 a[244:247], v4 offset:13312
    v_fma_f32 v79, v79, v27, v27
    v_mfma_f32_16x16x32_bf16 v[44:47], a[252:255], v[164:167], v[44:47]
    v_rcp_f32 v77, v77
    s_waitcnt lgkmcnt(2)
    v_mfma_f32_16x16x32_bf16 v[48:51], v[8:11], v[160:163], v[48:51]
    ds_read_b128 a[248:251], v4 offset:14336
    v_mul_f32 v91, v91, v75
    v_cvt_pk_bf16_f32 v68, v88, v89
    v_mfma_f32_16x16x32_bf16 v[56:59], v[8:11], v[164:167], v[56:59]
    buffer_load_dwordx4 a[172:175], v4, s[4:7], s67 offen offset:1024 sc1
Lb_prompt_67:
    v_mfma_f32_16x16x32_bf16 v[52:55], v[12:15], v[160:163], v[52:55]
    ds_read_b128 a[252:255], v4 offset:15360
    v_rcp_f32 v78, v78
    v_mfma_f32_16x16x32_bf16 v[60:63], v[12:15], v[164:167], v[60:63]
    v_mul_f32 v92, v92, v76
    s_waitcnt lgkmcnt(2)
    v_mfma_f32_16x16x32_bf16 v[32:35], a[240:243], v[168:171], v[32:35]
    ds_read_b128 v[8:11], v4 offset:16384
    v_rcp_f32 v79, v79
    v_mfma_f32_16x16x32_bf16 v[40:43], a[240:243], v[172:175], v[40:43]
    v_mul_f32 v93, v93, v77
    v_cvt_pk_bf16_f32 v69, v90, v91
    v_mul_f32 v94, v94, v78
    v_mfma_f32_16x16x32_bf16 v[36:39], a[244:247], v[168:171], v[36:39]
    ds_read_b128 v[12:15], v4 offset:17408
    v_mul_f32 v95, v95, v79
    v_cvt_pk_bf16_f32 v70, v92, v93
    v_mfma_f32_16x16x32_bf16 v[44:47], a[244:247], v[172:175], v[44:47]
    buffer_load_dwordx4 a[176:179], v4, s[4:7], s67 offen offset:2048 sc1
Lb_prompt_68:
    s_waitcnt lgkmcnt(2)
    v_mfma_f32_16x16x32_bf16 v[48:51], a[248:251], v[168:171], v[48:51]
    ds_read_b128 a[240:243], v4 offset:18432
    v_cvt_pk_bf16_f32 v71, v94, v95
    buffer_store_dwordx4 v[68:71], v4, s[4:7], s15 offen offset:1024 sc1
    v_mfma_f32_16x16x32_bf16 v[56:59], a[248:251], v[172:175], v[56:59]
    v_mfma_f32_16x16x32_bf16 v[52:55], a[252:255], v[168:171], v[52:55]
    ds_read_b128 a[244:247], v4 offset:19456
    v_mfma_f32_16x16x32_bf16 v[60:63], a[252:255], v[172:175], v[60:63]
    s_waitcnt lgkmcnt(2)
    v_mfma_f32_16x16x32_bf16 v[32:35], v[8:11], v[176:179], v[32:35]
    ds_read_b128 a[248:251], v4 offset:20480
    v_mfma_f32_16x16x32_bf16 v[40:43], v[8:11], v[180:183], v[40:43]
    s_add_u32 s67, s37, 8192
    buffer_load_dwordx4 a[180:183], v4, s[4:7], s67 offen offset:2048 sc1
Lb_prompt_69:
    v_mfma_f32_16x16x32_bf16 v[36:39], v[12:15], v[176:179], v[36:39]
    ds_read_b128 a[252:255], v4 offset:21504
    v_mfma_f32_16x16x32_bf16 v[44:47], v[12:15], v[180:183], v[44:47]
    s_waitcnt lgkmcnt(2)
    v_mfma_f32_16x16x32_bf16 v[48:51], a[240:243], v[176:179], v[48:51]
    ds_read_b128 v[8:11], v4 offset:22528
    v_mfma_f32_16x16x32_bf16 v[56:59], a[240:243], v[180:183], v[56:59]
    v_mfma_f32_16x16x32_bf16 v[52:55], a[244:247], v[176:179], v[52:55]
    ds_read_b128 v[12:15], v4 offset:23552
    v_mfma_f32_16x16x32_bf16 v[60:63], a[244:247], v[180:183], v[60:63]
    buffer_load_dwordx4 a[184:187], v4, s[4:7], s67 offen offset:3072 sc1
Lb_prompt_70:
    s_waitcnt lgkmcnt(2)
    v_mfma_f32_16x16x32_bf16 v[32:35], a[248:251], v[184:187], v[32:35]
    ds_read_b128 a[240:243], v4 offset:24576
    v_mfma_f32_16x16x32_bf16 v[40:43], a[248:251], v[188:191], v[40:43]
    v_mfma_f32_16x16x32_bf16 v[36:39], a[252:255], v[184:187], v[36:39]
    ds_read_b128 a[244:247], v4 offset:25600
    v_mfma_f32_16x16x32_bf16 v[44:47], a[252:255], v[188:191], v[44:47]
    s_waitcnt lgkmcnt(2)
    v_mfma_f32_16x16x32_bf16 v[48:51], v[8:11], v[184:187], v[48:51]
    ds_read_b128 a[248:251], v4 offset:26624
    v_mfma_f32_16x16x32_bf16 v[56:59], v[8:11], v[188:191], v[56:59]
    s_add_u32 s67, s37, 12288
    buffer_load_dwordx4 a[188:191], v4, s[4:7], s67 offen sc1
Lb_prompt_71:
    v_mfma_f32_16x16x32_bf16 v[52:55], v[12:15], v[184:187], v[52:55]
    ds_read_b128 a[252:255], v4 offset:27648
    v_mfma_f32_16x16x32_bf16 v[60:63], v[12:15], v[188:191], v[60:63]
    s_waitcnt lgkmcnt(2)
    v_mfma_f32_16x16x32_bf16 v[32:35], a[240:243], v[192:195], v[32:35]
    ds_read_b128 v[8:11], v4 offset:28672
    v_mfma_f32_16x16x32_bf16 v[40:43], a[240:243], v[196:199], v[40:43]
    v_mfma_f32_16x16x32_bf16 v[36:39], a[244:247], v[192:195], v[36:39]
    ds_read_b128 v[12:15], v4 offset:29696
    v_mfma_f32_16x16x32_bf16 v[44:47], a[244:247], v[196:199], v[44:47]
    buffer_load_dwordx4 a[192:195], v4, s[4:7], s67 offen offset:1024 sc1
Lb_prompt_72:
    s_waitcnt lgkmcnt(2)
    v_mfma_f32_16x16x32_bf16 v[48:51], a[248:251], v[192:195], v[48:51]
    ds_read_b128 a[240:243], v4 offset:30720
    v_mfma_f32_16x16x32_bf16 v[56:59], a[248:251], v[196:199], v[56:59]
    v_mfma_f32_16x16x32_bf16 v[52:55], a[252:255], v[192:195], v[52:55]
    ds_read_b128 a[244:247], v4 offset:31744
    v_mfma_f32_16x16x32_bf16 v[60:63], a[252:255], v[196:199], v[60:63]
    s_waitcnt lgkmcnt(2)
    v_mfma_f32_16x16x32_bf16 v[32:35], v[8:11], v[200:203], v[32:35]
    ds_read_b128 a[248:251], v4 offset:32768
    v_mfma_f32_16x16x32_bf16 v[40:43], v[8:11], v[204:207], v[40:43]
    buffer_load_dwordx4 a[196:199], v4, s[4:7], s67 offen offset:2048 sc1
Lb_prompt_73:
    v_mfma_f32_16x16x32_bf16 v[36:39], v[12:15], v[200:203], v[36:39]
    ds_read_b128 a[252:255], v4 offset:33792
    v_mfma_f32_16x16x32_bf16 v[44:47], v[12:15], v[204:207], v[44:47]
    s_waitcnt lgkmcnt(2)
    v_mfma_f32_16x16x32_bf16 v[48:51], a[240:243], v[200:203], v[48:51]
    ds_read_b128 v[8:11], v4 offset:34816
    v_mfma_f32_16x16x32_bf16 v[56:59], a[240:243], v[204:207], v[56:59]
    v_mfma_f32_16x16x32_bf16 v[52:55], a[244:247], v[200:203], v[52:55]
    ds_read_b128 v[12:15], v4 offset:35840
    v_mfma_f32_16x16x32_bf16 v[60:63], a[244:247], v[204:207], v[60:63]
    s_add_u32 s67, s38, 8192
    buffer_load_dwordx4 a[200:203], v4, s[4:7], s67 offen offset:2048 sc1
Lb_prompt_74:
    s_cmp_lg_u32 s3, 3
    s_cbranch_scc1 Lw_prompt_75
    v_mov_b32 v0, 0
    s_add_u32 s21, s64, 35651840
    buffer_load_dword v0, v30, s[4:7], s21 offen sc1
Lw_prompt_75:
    s_waitcnt lgkmcnt(2)
    v_mfma_f32_16x16x32_bf16 v[32:35], a[248:251], v[208:211], v[32:35]
    ds_read_b128 a[240:243], v4 offset:36864
    v_mfma_f32_16x16x32_bf16 v[40:43], a[248:251], v[212:215], v[40:43]
    v_mfma_f32_16x16x32_bf16 v[36:39], a[252:255], v[208:211], v[36:39]
    ds_read_b128 a[244:247], v4 offset:37888
    v_mfma_f32_16x16x32_bf16 v[44:47], a[252:255], v[212:215], v[44:47]
    s_waitcnt lgkmcnt(2)
    v_mfma_f32_16x16x32_bf16 v[48:51], v[8:11], v[208:211], v[48:51]
    ds_read_b128 a[248:251], v4 offset:38912
    v_mfma_f32_16x16x32_bf16 v[56:59], v[8:11], v[212:215], v[56:59]
    buffer_load_dwordx4 a[204:207], v4, s[4:7], s67 offen offset:3072 sc1
Lb_prompt_76:
    v_mfma_f32_16x16x32_bf16 v[52:55], v[12:15], v[208:211], v[52:55]
    ds_read_b128 a[252:255], v4 offset:39936
    v_mfma_f32_16x16x32_bf16 v[60:63], v[12:15], v[212:215], v[60:63]
    s_waitcnt lgkmcnt(2)
    v_mfma_f32_16x16x32_bf16 v[32:35], a[240:243], v[216:219], v[32:35]
    ds_read_b128 v[8:11], v4 offset:40960
    v_mfma_f32_16x16x32_bf16 v[40:43], a[240:243], v[220:223], v[40:43]
    v_mfma_f32_16x16x32_bf16 v[36:39], a[244:247], v[216:219], v[36:39]
    ds_read_b128 v[12:15], v4 offset:41984
    v_mfma_f32_16x16x32_bf16 v[44:47], a[244:247], v[220:223], v[44:47]
    s_add_u32 s67, s38, 12288
    buffer_load_dwordx4 a[208:211], v4, s[4:7], s67 offen sc1
Lb_prompt_77:
    s_waitcnt lgkmcnt(2)
    v_mfma_f32_16x16x32_bf16 v[48:51], a[248:251], v[216:219], v[48:51]
    ds_read_b128 a[240:243], v4 offset:43008
    v_mfma_f32_16x16x32_bf16 v[56:59], a[248:251], v[220:223], v[56:59]
    v_mfma_f32_16x16x32_bf16 v[52:55], a[252:255], v[216:219], v[52:55]
    ds_read_b128 a[244:247], v4 offset:44032
    v_mfma_f32_16x16x32_bf16 v[60:63], a[252:255], v[220:223], v[60:63]
    s_waitcnt lgkmcnt(2)
    v_mfma_f32_16x16x32_bf16 v[32:35], v[8:11], v[224:227], v[32:35]
    ds_read_b128 a[248:251], v4 offset:45056
    v_mfma_f32_16x16x32_bf16 v[40:43], v[8:11], v[228:231], v[40:43]
    buffer_load_dwordx4 a[212:215], v4, s[4:7], s67 offen offset:1024 sc1
Lb_prompt_78:
    v_mfma_f32_16x16x32_bf16 v[36:39], v[12:15], v[224:227], v[36:39]
    ds_read_b128 a[252:255], v4 offset:46080
    v_mfma_f32_16x16x32_bf16 v[44:47], v[12:15], v[228:231], v[44:47]
    s_cmp_lg_u32 s3, 3
    s_cbranch_scc1 Lw_prompt_80
    s_waitcnt vmcnt(0)
    v_cmp_gt_u32 vcc, 16, v0
    s_cbranch_vccz Lq_prompt_79
    s_add_u32 s21, s64, 35651840
    s_mov_b32 s66, 0
Lp_prompt_81:
    buffer_load_dword v0, v30, s[4:7], s21 offen sc1
    s_add_u32 s66, s66, 1
    s_waitcnt vmcnt(0)
    v_cmp_gt_u32 vcc, 16, v0
    s_cbranch_vccz Lq_prompt_79
    s_cmp_lt_u32 s66, 0x40000
    s_cbranch_scc0 Lq_prompt_79
    s_sleep 4
    s_branch Lp_prompt_81
Lq_prompt_79:
Lw_prompt_80:
    s_waitcnt vmcnt(0)
    s_barrier
    s_cmp_lg_u32 s3, 0
    s_cbranch_scc1 Lw_prompt_82
    s_add_u32 s21, s64, 35651968
    s_mov_b64 exec, 1
    buffer_atomic_add v31, v30, s[4:7], s21 offen sc1
    s_mov_b64 exec, -1
Lw_prompt_82:
    s_waitcnt lgkmcnt(2)
    v_mfma_f32_16x16x32_bf16 v[48:51], a[240:243], v[224:227], v[48:51]
    ds_read_b128 v[8:11], v4 offset:47104
    v_mfma_f32_16x16x32_bf16 v[56:59], a[240:243], v[228:231], v[56:59]
    s_add_u32 s21, s61, s40
    buffer_load_dwordx4 v[116:119], v4, s[4:7], s21 offen offset:0 sc1
    v_mfma_f32_16x16x32_bf16 v[52:55], a[244:247], v[224:227], v[52:55]
    ds_read_b128 v[12:15], v4 offset:48128
    v_mfma_f32_16x16x32_bf16 v[60:63], a[244:247], v[228:231], v[60:63]
    s_waitcnt lgkmcnt(2)
    v_mfma_f32_16x16x32_bf16 v[32:35], a[248:251], v[232:235], v[32:35]
    ds_read_b128 a[240:243], v4 offset:49152
    v_mfma_f32_16x16x32_bf16 v[40:43], a[248:251], v[236:239], v[40:43]
    s_add_u32 s21, s62, s40
    buffer_load_dwordx4 v[120:123], v4, s[4:7], s21 offen offset:0 sc1
    v_mfma_f32_16x16x32_bf16 v[36:39], a[252:255], v[232:235], v[36:39]
    ds_read_b128 a[244:247], v4 offset:50176
    v_mfma_f32_16x16x32_bf16 v[44:47], a[252:255], v[236:239], v[44:47]
    s_waitcnt lgkmcnt(2)
    v_mfma_f32_16x16x32_bf16 v[48:51], v[8:11], v[232:235], v[48:51]
    ds_read_b128 a[248:251], v4 offset:51200
    v_mfma_f32_16x16x32_bf16 v[56:59], v[8:11], v[236:239], v[56:59]
    s_add_u32 s21, s63, s40
    buffer_load_dwordx4 v[124:127], v4, s[4:7], s21 offen offset:0 sc1
    v_mfma_f32_16x16x32_bf16 v[52:55], v[12:15], v[232:235], v[52:55]
    ds_read_b128 a[252:255], v4 offset:52224
    v_mfma_f32_16x16x32_bf16 v[60:63], v[12:15], v[236:239], v[60:63]
    s_waitcnt lgkmcnt(2)
    v_mfma_f32_16x16x32_bf16 v[32:35], a[240:243], v[240:243], v[32:35]
    ds_read_b128 v[8:11], v4 offset:53248
    v_mfma_f32_16x16x32_bf16 v[40:43], a[240:243], v[244:247], v[40:43]
    s_add_u32 s21, s60, s40
    buffer_load_dwordx4 v[112:115], v4, s[4:7], s21 offen offset:0 sc1
    v_mfma_f32_16x16x32_bf16 v[36:39], a[244:247], v[240:243], v[36:39]
    ds_read_b128 v[12:15], v4 offset:54272
    v_mfma_f32_16x16x32_bf16 v[44:47], a[244:247], v[244:247], v[44:47]
    s_waitcnt lgkmcnt(2)
    v_mfma_f32_16x16x32_bf16 v[48:51], a[248:251], v[240:243], v[48:51]
    ds_read_b128 a[240:243], v4 offset:55296
    v_mfma_f32_16x16x32_bf16 v[56:59], a[248:251], v[244:247], v[56:59]
    s_add_u32 s21, s61, s41
    buffer_load_dwordx4 v[132:135], v4, s[4:7], s21 offen offset:0 sc1
    v_mfma_f32_16x16x32_bf16 v[52:55], a[252:255], v[240:243], v[52:55]
    ds_read_b128 a[244:247], v4 offset:56320
    v_mfma_f32_16x16x32_bf16 v[60:63], a[252:255], v[244:247], v[60:63]
    s_waitcnt lgkmcnt(2)
    v_mfma_f32_16x16x32_bf16 v[32:35], v[8:11], v[248:251], v[32:35]
    ds_read_b128 a[248:251], v4 offset:57344
    v_mfma_f32_16x16x32_bf16 v[40:43], v[8:11], v[252:255], v[40:43]
    s_add_u32 s21, s62, s41
    buffer_load_dwordx4 v[136:139], v4, s[4:7], s21 offen offset:0 sc1
    v_mfma_f32_16x16x32_bf16 v[36:39], v[12:15], v[248:251], v[36:39]
    ds_read_b128 a[252:255], v4 offset:58368
    v_mfma_f32_16x16x32_bf16 v[44:47], v[12:15], v[252:255], v[44:47]
    s_waitcnt lgkmcnt(2)
    v_mfma_f32_16x16x32_bf16 v[48:51], a[240:243], v[248:251], v[48:51]
    ds_read_b128 v[8:11], v4 offset:59392
    v_mfma_f32_16x16x32_bf16 v[56:59], a[240:243], v[252:255], v[56:59]
    s_add_u32 s21, s63, s41
    buffer_load_dwordx4 v[140:143], v4, s[4:7], s21 offen offset:0 sc1
    v_mfma_f32_16x16x32_bf16 v[52:55], a[244:247], v[248:251], v[52:55]
    ds_read_b128 v[12:15], v4 offset:60416
    v_mfma_f32_16x16x32_bf16 v[60:63], a[244:247], v[252:255], v[60:63]
    s_waitcnt lgkmcnt(2)
    v_mfma_f32_16x16x32_bf16 v[32:35], a[248:251], v[16:19], v[32:35]
    v_mfma_f32_16x16x32_bf16 v[40:43], a[248:251], v[20:23], v[40:43]
    s_add_u32 s21, s60, s41
    buffer_load_dwordx4 v[128:131], v4, s[4:7], s21 offen offset:0 sc1
    v_mfma_f32_16x16x32_bf16 v[36:39], a[252:255], v[16:19], v[36:39]
    v_mfma_f32_16x16x32_bf16 v[44:47], a[252:255], v[20:23], v[44:47]
    s_waitcnt lgkmcnt(0)
    v_mfma_f32_16x16x32_bf16 v[48:51], v[8:11], v[16:19], v[48:51]
    v_mfma_f32_16x16x32_bf16 v[56:59], v[8:11], v[20:23], v[56:59]
    s_add_u32 s21, s61, s42
    buffer_load_dwordx4 v[148:151], v4, s[4:7], s21 offen offset:0 sc1
    v_mfma_f32_16x16x32_bf16 v[52:55], v[12:15], v[16:19], v[52:55]
    v_mfma_f32_16x16x32_bf16 v[60:63], v[12:15], v[20:23], v[60:63]
    v_pk_mul_f32 v[32:33], v[32:33], v[24:25] op_sel_hi:[1,0]
    s_add_u32 s21, s62, s42
    buffer_load_dwordx4 v[152:155], v4, s[4:7], s21 offen offset:0 sc1
    v_pk_mul_f32 v[34:35], v[34:35], v[24:25] op_sel_hi:[1,0]
    v_exp_f32 v32, v32
    v_exp_f32 v33, v33
    v_pk_mul_f32 v[36:37], v[36:37], v[24:25] op_sel_hi:[1,0]
    v_exp_f32 v34, v34
    v_exp_f32 v35, v35
    s_add_u32 s21, s63, s42
    buffer_load_dwordx4 v[156:159], v4, s[4:7], s21 offen offset:0 sc1
    v_pk_fma_f32 v[32:33], v[32:33], v[26:27], v[26:27] op_sel_hi:[1,0,0]
    v_pk_mul_f32 v[38:39], v[38:39], v[24:25] op_sel_hi:[1,0]
    v_exp_f32 v36, v36
    v_exp_f32 v37, v37
    v_pk_fma_f32 v[34:35], v[34:35], v[26:27], v[26:27] op_sel_hi:[1,0,0]
    v_rcp_f32 v32, v32
    s_add_u32 s21, s60, s42
    buffer_load_dwordx4 v[144:147], v4, s[4:7], s21 offen offset:0 sc1
    v_rcp_f32 v33, v33
    v_pk_mul_f32 v[40:41], v[40:41], v[24:25] op_sel:[0,1]
    v_exp_f32 v38, v38
    v_exp_f32 v39, v39
    v_pk_fma_f32 v[36:37], v[36:37], v[26:27], v[26:27] op_sel_hi:[1,0,0]
    v_rcp_f32 v34, v34
    s_add_u32 s21, s61, s43
    buffer_load_dwordx4 v[164:167], v4, s[4:7], s21 offen offset:0 sc1
    v_rcp_f32 v35, v35
    v_pk_mul_f32 v[48:49], v[48:49], v[32:33]
    v_pk_mul_f32 v[42:43], v[42:43], v[24:25] op_sel:[0,1]
    v_exp_f32 v40, v40
    v_exp_f32 v41, v41
    v_pk_fma_f32 v[38:39], v[38:39], v[26:27], v[26:27] op_sel_hi:[1,0,0]
    s_add_u32 s21, s62, s43
    buffer_load_dwordx4 v[168:171], v4, s[4:7], s21 offen offset:0 sc1
    v_rcp_f32 v36, v36
    v_rcp_f32 v37, v37
    v_pk_mul_f32 v[50:51], v[50:51], v[34:35]
    v_cvt_pk_bf16_f32 v32, v48, v49
    v_pk_mul_f32 v[44:45], v[44:45], v[24:25] op_sel:[0,1]
    v_exp_f32 v42, v42
    s_add_u32 s21, s63, s43
    buffer_load_dwordx4 v[172:175], v4, s[4:7], s21 offen offset:0 sc1
    v_exp_f32 v43, v43
    v_pk_fma_f32 v[40:41], v[40:41], v[26:27], v[26:27] op_sel:[0,1,1]
    v_rcp_f32 v38, v38
    v_rcp_f32 v39, v39
    v_pk_mul_f32 v[52:53], v[52:53], v[36:37]
    v_cvt_pk_bf16_f32 v33, v50, v51
    s_add_u32 s21, s60, s43
    buffer_load_dwordx4 v[160:163], v4, s[4:7], s21 offen offset:0 sc1
    s_cmp_lg_u32 s3, 3
    s_cbranch_scc1 Lw_prompt_83
    v_mov_b32 v0, 0
    s_add_u32 s21, s64, 35651968
    buffer_load_dword v0, v30, s[4:7], s21 offen sc1
Lw_prompt_83:
    v_pk_mul_f32 v[46:47], v[46:47], v[24:25] op_sel:[0,1]
    v_exp_f32 v44, v44
    v_exp_f32 v45, v45
    v_pk_fma_f32 v[42:43], v[42:43], v[26:27], v[26:27] op_sel:[0,1,1]
    v_rcp_f32 v40, v40
    v_rcp_f32 v41, v41
    buffer_load_dwordx4 a[216:219], v4, s[4:7], s67 offen offset:2048 sc1
Lb_prompt_84:
    v_pk_mul_f32 v[54:55], v[54:55], v[38:39]
    v_cvt_pk_bf16_f32 v34, v52, v53
    v_exp_f32 v46, v46
    v_exp_f32 v47, v47
    v_pk_fma_f32 v[44:45], v[44:45], v[26:27], v[26:27] op_sel:[0,1,1]
    v_rcp_f32 v42, v42
    s_add_u32 s67, s39, 8192
    buffer_load_dwordx4 a[220:223], v4, s[4:7], s67 offen offset:2048 sc1
Lb_prompt_85:
    v_rcp_f32 v43, v43
    v_pk_mul_f32 v[56:57], v[56:57], v[40:41]
    v_cvt_pk_bf16_f32 v35, v54, v55
    buffer_store_dwordx4 v[32:35], v4, s[4:7], s27 offen offset:2048 sc1
    v_pk_fma_f32 v[46:47], v[46:47], v[26:27], v[26:27] op_sel:[0,1,1]
    v_rcp_f32 v44, v44
    buffer_load_dwordx4 a[224:227], v4, s[4:7], s67 offen offset:3072 sc1
Lb_prompt_86:
    v_rcp_f32 v45, v45
    v_pk_mul_f32 v[58:59], v[58:59], v[42:43]
    v_cvt_pk_bf16_f32 v36, v56, v57
    v_rcp_f32 v46, v46
    v_rcp_f32 v47, v47
    v_pk_mul_f32 v[60:61], v[60:61], v[44:45]
    s_add_u32 s67, s39, 12288
    buffer_load_dwordx4 a[228:231], v4, s[4:7], s67 offen sc1
Lb_prompt_87:
    v_cvt_pk_bf16_f32 v37, v58, v59
    v_pk_mul_f32 v[62:63], v[62:63], v[46:47]
    v_cvt_pk_bf16_f32 v38, v60, v61
    v_cvt_pk_bf16_f32 v39, v62, v63
    buffer_store_dwordx4 v[36:39], v4, s[4:7], s15 offen offset:2048 sc1
    s_waitcnt vmcnt(17)
    v_mfma_f32_16x16x32_bf16 v[52:55], a[0:3], v[116:119], 0
    buffer_load_dwordx4 a[232:235], v4, s[4:7], s67 offen offset:1024 sc1
Lb_prompt_88:
    v_mfma_f32_16x16x32_bf16 v[56:59], a[4:7], v[116:119], 0
    s_lshr_b32 s23, s17, 1
    s_lshr_b32 s27, s3, 1
    v_mfma_f32_16x16x32_bf16 v[60:63], a[8:11], v[116:119], 0
    s_lshl_b32 s27, s27, 5
    s_add_u32 s27, s27, s24
    v_mfma_f32_16x16x32_bf16 v[64:67], a[12:15], v[116:119], 0
    s_and_b32 s28, s3, 1
    s_lshl_b32 s28, s28, 4
    v_mfma_f32_16x16x32_bf16 v[68:71], a[16:19], v[116:119], 0
    buffer_load_dwordx4 a[236:239], v4, s[4:7], s67 offen offset:2048 sc1
Lb_prompt_89:
    s_waitcnt vmcnt(16)
    v_mfma_f32_16x16x32_bf16 v[72:75], a[0:3], v[120:123], 0
    v_and_b32 v5, 15, v1
    v_add_u32 v5, s28, v5
    v_mfma_f32_16x16x32_bf16 v[76:79], a[4:7], v[120:123], 0
    v_bfe_u32 v6, v1, 4, 1
    v_lshlrev_b32 v7, 4, v5
    v_mfma_f32_16x16x32_bf16 v[80:83], a[8:11], v[120:123], 0
    v_and_b32 v8, 15, v1
    v_lshlrev_b32 v8, 4, v8
    v_mfma_f32_16x16x32_bf16 v[84:87], a[12:15], v[120:123], 0
    v_lshl_add_u32 v8, v6, 8, v8
    v_lshl_add_u32 v8, v3, 3, v8
    v_mfma_f32_16x16x32_bf16 v[88:91], a[16:19], v[120:123], 0
    s_mul_i32 s29, s27, 40960
    s_mul_i32 s30, s28, 1280
    s_waitcnt vmcnt(15)
    v_mfma_f32_16x16x32_bf16 v[92:95], a[0:3], v[124:127], 0
    s_add_u32 s30, s30, s29
    s_mul_i32 s31, s23, 2560
    v_mfma_f32_16x16x32_bf16 v[96:99], a[4:7], v[124:127], 0
    s_add_u32 s30, s30, s31
    s_add_u32 s30, s30, 13631488
    v_mfma_f32_16x16x32_bf16 v[100:103], a[8:11], v[124:127], 0
    s_lshl_b32 s31, s31, 1
    s_add_u32 s29, s29, s31
    v_mfma_f32_16x16x32_bf16 v[104:107], a[12:15], v[124:127], 0
    buffer_load_dwordx2 v[14:15], v8, s[4:7], s30 offen offset:0 sc1
    buffer_load_dwordx2 v[16:17], v8, s[4:7], s30 offen offset:512 sc1
    v_mfma_f32_16x16x32_bf16 v[108:111], a[16:19], v[124:127], 0
    buffer_load_dwordx2 v[18:19], v8, s[4:7], s30 offen offset:1024 sc1
    buffer_load_dwordx2 v[20:21], v8, s[4:7], s30 offen offset:1536 sc1
    s_waitcnt vmcnt(18)
    v_mfma_f32_16x16x32_bf16 v[32:35], a[0:3], v[112:115], 0
    buffer_load_dwordx2 v[22:23], v8, s[4:7], s30 offen offset:2048 sc1
    v_lshl_add_u32 v9, v3, 9, v7
    s_cmp_lg_u32 s3, 3
    s_cbranch_scc1 Lw_prompt_91
    s_waitcnt vmcnt(7)
    v_cmp_gt_u32 vcc, 16, v0
    s_cbranch_vccz Lq_prompt_90
    s_add_u32 s21, s64, 35651968
    s_mov_b32 s66, 0
Lp_prompt_92:
    buffer_load_dword v0, v30, s[4:7], s21 offen sc1
    s_add_u32 s66, s66, 1
    s_waitcnt vmcnt(0)
    v_cmp_gt_u32 vcc, 16, v0
    s_cbranch_vccz Lq_prompt_90
    s_cmp_lt_u32 s66, 0x40000
    s_cbranch_scc0 Lq_prompt_90
    s_sleep 4
    s_branch Lp_prompt_92
Lq_prompt_90:
Lw_prompt_91:
    s_barrier
    v_mfma_f32_16x16x32_bf16 v[36:39], a[4:7], v[112:115], 0
    s_add_u32 s21, s61, s40
    buffer_load_dwordx4 v[180:183], v4, s[4:7], s21 offen offset:1024 sc1
    v_mfma_f32_16x16x32_bf16 v[40:43], a[8:11], v[112:115], 0
    v_lshl_add_u32 v9, v6, 10, v9
    s_add_u32 s30, s29, 32505856
    v_mfma_f32_16x16x32_bf16 v[44:47], a[12:15], v[112:115], 0
    s_add_u32 s29, s30, 4096
    s_lshl_b32 s31, s27, 11
    v_mfma_f32_16x16x32_bf16 v[48:51], a[16:19], v[112:115], 0
    s_add_u32 s21, s62, s40
    buffer_load_dwordx4 v[184:187], v4, s[4:7], s21 offen offset:1024 sc1
    s_waitcnt vmcnt(20)
    v_mfma_f32_16x16x32_bf16 v[52:55], a[20:23], v[132:135], v[52:55]
    s_lshl_b32 s28, s23, 8
    s_add_u32 s31, s31, s28
    v_mfma_f32_16x16x32_bf16 v[56:59], a[24:27], v[132:135], v[56:59]
    s_add_u32 s31, s31, 37224448
    v_lshlrev_b32 v24, 3, v5
    v_mfma_f32_16x16x32_bf16 v[60:63], a[28:31], v[132:135], v[60:63]
    s_add_u32 s21, s63, s40
    buffer_load_dwordx4 v[188:191], v4, s[4:7], s21 offen offset:1024 sc1
    v_mfma_f32_16x16x32_bf16 v[64:67], a[32:35], v[132:135], v[64:67]
    s_min_u32 s22, s17, 9
    s_mul_i32 s22, s22, 40960
    v_mfma_f32_16x16x32_bf16 v[68:71], a[36:39], v[132:135], v[68:71]
    s_add_u32 s22, s22, s57
    s_add_u32 s22, s22, 35733504
    s_waitcnt vmcnt(20)
    v_mfma_f32_16x16x32_bf16 v[72:75], a[20:23], v[136:139], v[72:75]
    s_add_u32 s21, s60, s40
    buffer_load_dwordx4 v[176:179], v4, s[4:7], s21 offen offset:1024 sc1
    v_mfma_f32_16x16x32_bf16 v[76:79], a[24:27], v[136:139], v[76:79]
    s_xor_b32 s27, s3, 1
    s_mul_i32 s27, s27, 15360
    v_mfma_f32_16x16x32_bf16 v[80:83], a[28:31], v[136:139], v[80:83]
    s_add_u32 s27, s27, 81920
    v_add_u32 v11, s27, v4
    v_mfma_f32_16x16x32_bf16 v[84:87], a[32:35], v[136:139], v[84:87]
    s_add_u32 s21, s61, s41
    buffer_load_dwordx4 v[196:199], v4, s[4:7], s21 offen offset:1024 sc1
    v_mfma_f32_16x16x32_bf16 v[88:91], a[36:39], v[136:139], v[88:91]
    s_xor_b32 s27, s3, 2
    s_mul_i32 s27, s27, 15360
    s_waitcnt vmcnt(21)
    v_mfma_f32_16x16x32_bf16 v[92:95], a[20:23], v[140:143], v[92:95]
    s_add_u32 s27, s27, 81920
    v_add_u32 v12, s27, v4
    v_mfma_f32_16x16x32_bf16 v[96:99], a[24:27], v[140:143], v[96:99]
    s_add_u32 s21, s62, s41
    buffer_load_dwordx4 v[200:203], v4, s[4:7], s21 offen offset:1024 sc1
    v_mfma_f32_16x16x32_bf16 v[100:103], a[28:31], v[140:143], v[100:103]
    s_xor_b32 s27, s3, 3
    s_mul_i32 s27, s27, 15360
    v_mfma_f32_16x16x32_bf16 v[104:107], a[32:35], v[140:143], v[104:107]
    s_add_u32 s27, s27, 81920
    v_add_u32 v13, s27, v4
    v_mfma_f32_16x16x32_bf16 v[108:111], a[36:39], v[140:143], v[108:111]
    s_add_u32 s21, s63, s41
    buffer_load_dwordx4 v[204:207], v4, s[4:7], s21 offen offset:1024 sc1
    s_waitcnt vmcnt(22)
    v_mfma_f32_16x16x32_bf16 v[32:35], a[20:23], v[128:131], v[32:35]
    s_mul_i32 s27, s3, 15360
    s_add_u32 s27, s27, 81920
    s_waitcnt vmcnt(12)
    s_barrier
    s_cmp_lg_u32 s3, 0
    s_cbranch_scc1 Lw_prompt_93
    s_add_u32 s21, s64, 35652096
    s_mov_b64 exec, 1
    buffer_atomic_add v31, v30, s[4:7], s21 offen sc1
    s_mov_b64 exec, -1
Lw_prompt_93:
    v_mfma_f32_16x16x32_bf16 v[36:39], a[24:27], v[128:131], v[36:39]
    v_add_u32 v10, s27, v4
    v_mfma_f32_16x16x32_bf16 v[40:43], a[28:31], v[128:131], v[40:43]
    s_add_u32 s21, s60, s41
    buffer_load_dwordx4 v[192:195], v4, s[4:7], s21 offen offset:1024 sc1
    v_mfma_f32_16x16x32_bf16 v[44:47], a[32:35], v[128:131], v[44:47]
    v_mfma_f32_16x16x32_bf16 v[48:51], a[36:39], v[128:131], v[48:51]
    v_mfma_f32_16x16x32_bf16 v[52:55], a[40:43], v[148:151], v[52:55]
    s_add_u32 s21, s61, s42
    buffer_load_dwordx4 v[212:215], v4, s[4:7], s21 offen offset:1024 sc1
    v_mfma_f32_16x16x32_bf16 v[56:59], a[44:47], v[148:151], v[56:59]
    v_mfma_f32_16x16x32_bf16 v[60:63], a[48:51], v[148:151], v[60:63]
    v_mfma_f32_16x16x32_bf16 v[64:67], a[52:55], v[148:151], v[64:67]
    s_add_u32 s21, s62, s42
    buffer_load_dwordx4 v[216:219], v4, s[4:7], s21 offen offset:1024 sc1
    v_mfma_f32_16x16x32_bf16 v[68:71], a[56:59], v[148:151], v[68:71]
    v_mfma_f32_16x16x32_bf16 v[72:75], a[40:43], v[152:155], v[72:75]
    v_mfma_f32_16x16x32_bf16 v[76:79], a[44:47], v[152:155], v[76:79]
    s_add_u32 s21, s63, s42
    buffer_load_dwordx4 v[220:223], v4, s[4:7], s21 offen offset:1024 sc1
    v_mfma_f32_16x16x32_bf16 v[80:83], a[48:51], v[152:155], v[80:83]
    v_mfma_f32_16x16x32_bf16 v[84:87], a[52:55], v[152:155], v[84:87]
    v_mfma_f32_16x16x32_bf16 v[88:91], a[56:59], v[152:155], v[88:91]
    s_add_u32 s21, s60, s42
    buffer_load_dwordx4 v[208:211], v4, s[4:7], s21 offen offset:1024 sc1
    v_mfma_f32_16x16x32_bf16 v[92:95], a[40:43], v[156:159], v[92:95]
    v_mfma_f32_16x16x32_bf16 v[96:99], a[44:47], v[156:159], v[96:99]
    v_mfma_f32_16x16x32_bf16 v[100:103], a[48:51], v[156:159], v[100:103]
    s_add_u32 s21, s61, s43
    buffer_load_dwordx4 v[228:231], v4, s[4:7], s21 offen offset:1024 sc1
    v_mfma_f32_16x16x32_bf16 v[104:107], a[52:55], v[156:159], v[104:107]
    v_mfma_f32_16x16x32_bf16 v[108:111], a[56:59], v[156:159], v[108:111]
    v_mfma_f32_16x16x32_bf16 v[32:35], a[40:43], v[144:147], v[32:35]
    s_add_u32 s21, s62, s43
    buffer_load_dwordx4 v[232:235], v4, s[4:7], s21 offen offset:1024 sc1
    v_mfma_f32_16x16x32_bf16 v[36:39], a[44:47], v[144:147], v[36:39]
    v_mfma_f32_16x16x32_bf16 v[40:43], a[48:51], v[144:147], v[40:43]
    v_mfma_f32_16x16x32_bf16 v[44:47], a[52:55], v[144:147], v[44:47]
    s_add_u32 s21, s63, s43
    buffer_load_dwordx4 v[236:239], v4, s[4:7], s21 offen offset:1024 sc1
    v_mfma_f32_16x16x32_bf16 v[48:51], a[56:59], v[144:147], v[48:51]
    v_mfma_f32_16x16x32_bf16 v[52:55], a[60:63], v[164:167], v[52:55]
    v_mfma_f32_16x16x32_bf16 v[56:59], a[64:67], v[164:167], v[56:59]
    s_add_u32 s21, s60, s43
    buffer_load_dwordx4 v[224:227], v4, s[4:7], s21 offen offset:1024 sc1
    v_mfma_f32_16x16x32_bf16 v[60:63], a[68:71], v[164:167], v[60:63]
    v_mfma_f32_16x16x32_bf16 v[64:67], a[72:75], v[164:167], v[64:67]
    v_mfma_f32_16x16x32_bf16 v[68:71], a[76:79], v[164:167], v[68:71]
    v_mfma_f32_16x16x32_bf16 v[72:75], a[60:63], v[168:171], v[72:75]
    s_add_u32 m0, s57, 0
    s_add_u32 s65, s22, 0
    buffer_load_dwordx4 v4, s[4:7], s65 offen sc1 lds
    v_mfma_f32_16x16x32_bf16 v[76:79], a[64:67], v[168:171], v[76:79]
    v_mfma_f32_16x16x32_bf16 v[80:83], a[68:71], v[168:171], v[80:83]
    v_mfma_f32_16x16x32_bf16 v[84:87], a[72:75], v[168:171], v[84:87]
    v_mfma_f32_16x16x32_bf16 v[88:91], a[76:79], v[168:171], v[88:91]
    buffer_load_dwordx4 v4, s[4:7], s65 offen offset:1024 sc1 lds
    v_mfma_f32_16x16x32_bf16 v[92:95], a[60:63], v[172:175], v[92:95]
    v_mfma_f32_16x16x32_bf16 v[96:99], a[64:67], v[172:175], v[96:99]
    v_mfma_f32_16x16x32_bf16 v[100:103], a[68:71], v[172:175], v[100:103]
    v_mfma_f32_16x16x32_bf16 v[104:107], a[72:75], v[172:175], v[104:107]
    buffer_load_dwordx4 v4, s[4:7], s65 offen offset:2048 sc1 lds
    v_mfma_f32_16x16x32_bf16 v[108:111], a[76:79], v[172:175], v[108:111]
    v_mfma_f32_16x16x32_bf16 v[32:35], a[60:63], v[160:163], v[32:35]
    v_mfma_f32_16x16x32_bf16 v[36:39], a[64:67], v[160:163], v[36:39]
    v_mfma_f32_16x16x32_bf16 v[40:43], a[68:71], v[160:163], v[40:43]
    buffer_load_dwordx4 v4, s[4:7], s65 offen offset:3072 sc1 lds
    v_mfma_f32_16x16x32_bf16 v[44:47], a[72:75], v[160:163], v[44:47]
    v_mfma_f32_16x16x32_bf16 v[48:51], a[76:79], v[160:163], v[48:51]
    s_waitcnt vmcnt(19)
    v_mfma_f32_16x16x32_bf16 v[52:55], a[80:83], v[180:183], v[52:55]
    v_mfma_f32_16x16x32_bf16 v[56:59], a[84:87], v[180:183], v[56:59]
    s_add_u32 m0, s57, 16384
    s_add_u32 s65, s22, 16384
    buffer_load_dwordx4 v4, s[4:7], s65 offen sc1 lds
    v_mfma_f32_16x16x32_bf16 v[60:63], a[88:91], v[180:183], v[60:63]
    v_mfma_f32_16x16x32_bf16 v[64:67], a[92:95], v[180:183], v[64:67]
    v_mfma_f32_16x16x32_bf16 v[68:71], a[96:99], v[180:183], v[68:71]
    s_waitcnt vmcnt(19)
    v_mfma_f32_16x16x32_bf16 v[72:75], a[80:83], v[184:187], v[72:75]
    buffer_load_dwordx4 v4, s[4:7], s65 offen offset:1024 sc1 lds
    v_mfma_f32_16x16x32_bf16 v[76:79], a[84:87], v[184:187], v[76:79]
    v_mfma_f32_16x16x32_bf16 v[80:83], a[88:91], v[184:187], v[80:83]
    s_cmp_lg_u32 s3, 3
    s_cbranch_scc1 Lw_prompt_94
    v_mov_b32 v0, 0
    s_add_u32 s21, s64, 35652096
    buffer_load_dword v0, v30, s[4:7], s21 offen sc1
Lw_prompt_94:
    v_mfma_f32_16x16x32_bf16 v[84:87], a[92:95], v[184:187], v[84:87]
    v_mfma_f32_16x16x32_bf16 v[88:91], a[96:99], v[184:187], v[88:91]
    buffer_load_dwordx4 v4, s[4:7], s65 offen offset:2048 sc1 lds
    s_waitcnt vmcnt(20)
    v_mfma_f32_16x16x32_bf16 v[92:95], a[80:83], v[188:191], v[92:95]
    v_mfma_f32_16x16x32_bf16 v[96:99], a[84:87], v[188:191], v[96:99]
    v_mfma_f32_16x16x32_bf16 v[100:103], a[88:91], v[188:191], v[100:103]
    v_mfma_f32_16x16x32_bf16 v[104:107], a[92:95], v[188:191], v[104:107]
    buffer_load_dwordx4 v4, s[4:7], s65 offen offset:3072 sc1 lds
    v_mfma_f32_16x16x32_bf16 v[108:111], a[96:99], v[188:191], v[108:111]
    s_waitcnt vmcnt(20)
    v_mfma_f32_16x16x32_bf16 v[32:35], a[80:83], v[176:179], v[32:35]
    v_mfma_f32_16x16x32_bf16 v[36:39], a[84:87], v[176:179], v[36:39]
    v_mfma_f32_16x16x32_bf16 v[40:43], a[88:91], v[176:179], v[40:43]
    s_lshr_b32 s13, s57, 1
    s_sub_u32 s12, s22, s13
    v_mfma_f32_16x16x32_bf16 v[44:47], a[92:95], v[176:179], v[44:47]
    v_mfma_f32_16x16x32_bf16 v[48:51], a[96:99], v[176:179], v[48:51]
    s_cmp_lg_u32 s3, 3
    s_cbranch_scc1 Lw_prompt_96
    s_waitcnt vmcnt(2)
    v_cmp_gt_u32 vcc, 16, v0
    s_cbranch_vccz Lq_prompt_95
    s_add_u32 s21, s64, 35652096
    s_mov_b32 s66, 0
Lp_prompt_97:
    buffer_load_dword v0, v30, s[4:7], s21 offen sc1
    s_add_u32 s66, s66, 1
    s_waitcnt vmcnt(0)
    v_cmp_gt_u32 vcc, 16, v0
    s_cbranch_vccz Lq_prompt_95
    s_cmp_lt_u32 s66, 0x40000
    s_cbranch_scc0 Lq_prompt_95
    s_sleep 4
    s_branch Lp_prompt_97
Lq_prompt_95:
Lw_prompt_96:
    s_barrier
    s_waitcnt vmcnt(19)
    v_mfma_f32_16x16x32_bf16 v[52:55], a[100:103], v[196:199], v[52:55]
    s_add_u32 s21, s61, s40
    buffer_load_dwordx4 v[244:247], v4, s[4:7], s21 offen offset:2048 sc1
    v_mfma_f32_16x16x32_bf16 v[56:59], a[104:107], v[196:199], v[56:59]
    v_mfma_f32_16x16x32_bf16 v[60:63], a[108:111], v[196:199], v[60:63]
    v_mfma_f32_16x16x32_bf16 v[64:67], a[112:115], v[196:199], v[64:67]
    s_add_u32 s21, s61, s41
    buffer_load_dwordx4 v[116:119], v4, s[4:7], s21 offen offset:2048 sc1
    v_mfma_f32_16x16x32_bf16 v[68:71], a[116:119], v[196:199], v[68:71]
    s_waitcnt vmcnt(20)
    v_mfma_f32_16x16x32_bf16 v[72:75], a[100:103], v[200:203], v[72:75]
    v_mfma_f32_16x16x32_bf16 v[76:79], a[104:107], v[200:203], v[76:79]
    s_add_u32 s21, s61, s42
    buffer_load_dwordx4 v[132:135], v4, s[4:7], s21 offen offset:2048 sc1
    v_mfma_f32_16x16x32_bf16 v[80:83], a[108:111], v[200:203], v[80:83]
    v_mfma_f32_16x16x32_bf16 v[84:87], a[112:115], v[200:203], v[84:87]
    v_mfma_f32_16x16x32_bf16 v[88:91], a[116:119], v[200:203], v[88:91]
    s_add_u32 s21, s61, s43
    buffer_load_dwordx4 v[148:151], v4, s[4:7], s21 offen offset:2048 sc1
    s_waitcnt vmcnt(21)
    v_mfma_f32_16x16x32_bf16 v[92:95], a[100:103], v[204:207], v[92:95]
    v_mfma_f32_16x16x32_bf16 v[96:99], a[104:107], v[204:207], v[96:99]
    v_mfma_f32_16x16x32_bf16 v[100:103], a[108:111], v[204:207], v[100:103]
    s_add_u32 s21, s62, s40
    buffer_load_dwordx4 v[248:251], v4, s[4:7], s21 offen offset:2048 sc1
    v_mfma_f32_16x16x32_bf16 v[104:107], a[112:115], v[204:207], v[104:107]
    v_mfma_f32_16x16x32_bf16 v[108:111], a[116:119], v[204:207], v[108:111]
    s_waitcnt vmcnt(21)
    v_mfma_f32_16x16x32_bf16 v[32:35], a[100:103], v[192:195], v[32:35]
    s_add_u32 s21, s62, s41
    buffer_load_dwordx4 v[120:123], v4, s[4:7], s21 offen offset:2048 sc1
    v_mfma_f32_16x16x32_bf16 v[36:39], a[104:107], v[192:195], v[36:39]
    v_mfma_f32_16x16x32_bf16 v[40:43], a[108:111], v[192:195], v[40:43]
    v_mfma_f32_16x16x32_bf16 v[44:47], a[112:115], v[192:195], v[44:47]
    s_add_u32 s21, s62, s42
    buffer_load_dwordx4 v[136:139], v4, s[4:7], s21 offen offset:2048 sc1
    v_mfma_f32_16x16x32_bf16 v[48:51], a[116:119], v[192:195], v[48:51]
    s_waitcnt vmcnt(22)
    v_mfma_f32_16x16x32_bf16 v[52:55], a[120:123], v[212:215], v[52:55]
    v_mfma_f32_16x16x32_bf16 v[56:59], a[124:127], v[212:215], v[56:59]
    s_add_u32 s21, s62, s43
    buffer_load_dwordx4 v[152:155], v4, s[4:7], s21 offen offset:2048 sc1
    v_mfma_f32_16x16x32_bf16 v[60:63], a[128:131], v[212:215], v[60:63]
    v_mfma_f32_16x16x32_bf16 v[64:67], a[132:135], v[212:215], v[64:67]
    v_mfma_f32_16x16x32_bf16 v[68:71], a[136:139], v[212:215], v[68:71]
    s_add_u32 s21, s63, s40
    buffer_load_dwordx4 v[252:255], v4, s[4:7], s21 offen offset:2048 sc1
    s_waitcnt vmcnt(23)
    v_mfma_f32_16x16x32_bf16 v[72:75], a[120:123], v[216:219], v[72:75]
    v_mfma_f32_16x16x32_bf16 v[76:79], a[124:127], v[216:219], v[76:79]
    v_mfma_f32_16x16x32_bf16 v[80:83], a[128:131], v[216:219], v[80:83]
    s_add_u32 s21, s63, s41
    buffer_load_dwordx4 v[124:127], v4, s[4:7], s21 offen offset:2048 sc1
    v_mfma_f32_16x16x32_bf16 v[84:87], a[132:135], v[216:219], v[84:87]
    v_mfma_f32_16x16x32_bf16 v[88:91], a[136:139], v[216:219], v[88:91]
    s_waitcnt vmcnt(23)
    v_mfma_f32_16x16x32_bf16 v[92:95], a[120:123], v[220:223], v[92:95]
    s_add_u32 s21, s63, s42
    buffer_load_dwordx4 v[140:143], v4, s[4:7], s21 offen offset:2048 sc1
    v_mfma_f32_16x16x32_bf16 v[96:99], a[124:127], v[220:223], v[96:99]
    v_mfma_f32_16x16x32_bf16 v[100:103], a[128:131], v[220:223], v[100:103]
    v_mfma_f32_16x16x32_bf16 v[104:107], a[132:135], v[220:223], v[104:107]
    s_add_u32 s21, s63, s43
    buffer_load_dwordx4 v[156:159], v4, s[4:7], s21 offen offset:2048 sc1
    v_mfma_f32_16x16x32_bf16 v[108:111], a[136:139], v[220:223], v[108:111]
    s_waitcnt vmcnt(24)
    v_mfma_f32_16x16x32_bf16 v[32:35], a[120:123], v[208:211], v[32:35]
    v_mfma_f32_16x16x32_bf16 v[36:39], a[124:127], v[208:211], v[36:39]
    s_add_u32 s21, s60, s40
    buffer_load_dwordx4 v[240:243], v4, s[4:7], s21 offen offset:2048 sc1
    v_mfma_f32_16x16x32_bf16 v[40:43], a[128:131], v[208:211], v[40:43]
    v_mfma_f32_16x16x32_bf16 v[44:47], a[132:135], v[208:211], v[44:47]
    v_mfma_f32_16x16x32_bf16 v[48:51], a[136:139], v[208:211], v[48:51]
    s_add_u32 s21, s60, s41
    buffer_load_dwordx4 v[112:115], v4, s[4:7], s21 offen offset:2048 sc1
    s_waitcnt vmcnt(25)
    v_mfma_f32_16x16x32_bf16 v[52:55], a[140:143], v[228:231], v[52:55]
    v_mfma_f32_16x16x32_bf16 v[56:59], a[144:147], v[228:231], v[56:59]
    v_mfma_f32_16x16x32_bf16 v[60:63], a[148:151], v[228:231], v[60:63]
    s_add_u32 s21, s60, s42
    buffer_load_dwordx4 v[128:131], v4, s[4:7], s21 offen offset:2048 sc1
    v_mfma_f32_16x16x32_bf16 v[64:67], a[152:155], v[228:231], v[64:67]
    v_mfma_f32_16x16x32_bf16 v[68:71], a[156:159], v[228:231], v[68:71]
    s_waitcnt vmcnt(25)
    v_mfma_f32_16x16x32_bf16 v[72:75], a[140:143], v[232:235], v[72:75]
    s_add_u32 s21, s60, s43
    buffer_load_dwordx4 v[144:147], v4, s[4:7], s21 offen offset:2048 sc1
    v_mfma_f32_16x16x32_bf16 v[76:79], a[144:147], v[232:235], v[76:79]
    v_mfma_f32_16x16x32_bf16 v[80:83], a[148:151], v[232:235], v[80:83]
    v_mfma_f32_16x16x32_bf16 v[84:87], a[152:155], v[232:235], v[84:87]
    v_mfma_f32_16x16x32_bf16 v[88:91], a[156:159], v[232:235], v[88:91]
    s_add_u32 m0, s13, 32768
    s_add_u32 s65, s12, 32768
    buffer_load_dwordx4 v4, s[4:7], s65 offen sc1 lds
    s_waitcnt vmcnt(26)
    v_mfma_f32_16x16x32_bf16 v[92:95], a[140:143], v[236:239], v[92:95]
    v_mfma_f32_16x16x32_bf16 v[96:99], a[144:147], v[236:239], v[96:99]
    v_mfma_f32_16x16x32_bf16 v[100:103], a[148:151], v[236:239], v[100:103]
    v_mfma_f32_16x16x32_bf16 v[104:107], a[152:155], v[236:239], v[104:107]
    buffer_load_dwordx4 v4, s[4:7], s65 offen offset:1024 sc1 lds
    v_mfma_f32_16x16x32_bf16 v[108:111], a[156:159], v[236:239], v[108:111]
    s_waitcnt vmcnt(26)
    v_mfma_f32_16x16x32_bf16 v[32:35], a[140:143], v[224:227], v[32:35]
    v_mfma_f32_16x16x32_bf16 v[36:39], a[144:147], v[224:227], v[36:39]
    v_mfma_f32_16x16x32_bf16 v[40:43], a[148:151], v[224:227], v[40:43]
    s_add_u32 m0, s57, 49152
    s_add_u32 s65, s58, 98304
    buffer_load_dwordx4 v4, s[4:7], s65 offen sc1 lds
    v_mfma_f32_16x16x32_bf16 v[44:47], a[152:155], v[224:227], v[44:47]
    v_mfma_f32_16x16x32_bf16 v[48:51], a[156:159], v[224:227], v[48:51]
    s_waitcnt vmcnt(18)
    v_mfma_f32_16x16x32_bf16 v[52:55], a[160:163], v[244:247], v[52:55]
    v_mfma_f32_16x16x32_bf16 v[56:59], a[164:167], v[244:247], v[56:59]
    buffer_load_dwordx4 v4, s[4:7], s65 offen offset:1024 sc1 lds
    v_mfma_f32_16x16x32_bf16 v[60:63], a[168:171], v[244:247], v[60:63]
    v_mfma_f32_16x16x32_bf16 v[64:67], a[172:175], v[244:247], v[64:67]
    v_mfma_f32_16x16x32_bf16 v[68:71], a[176:179], v[244:247], v[68:71]
    s_waitcnt vmcnt(18)
    v_mfma_f32_16x16x32_bf16 v[52:55], a[180:183], v[116:119], v[52:55]
    buffer_load_dwordx4 v4, s[4:7], s65 offen offset:2048 sc1 lds
    v_mfma_f32_16x16x32_bf16 v[56:59], a[184:187], v[116:119], v[56:59]
    v_mfma_f32_16x16x32_bf16 v[60:63], a[188:191], v[116:119], v[60:63]
    v_mfma_f32_16x16x32_bf16 v[64:67], a[192:195], v[116:119], v[64:67]
    v_mfma_f32_16x16x32_bf16 v[68:71], a[196:199], v[116:119], v[68:71]
    buffer_load_dwordx4 v4, s[4:7], s65 offen offset:3072 sc1 lds
    s_waitcnt vmcnt(19)
    v_mfma_f32_16x16x32_bf16 v[52:55], a[200:203], v[132:135], v[52:55]
    v_mfma_f32_16x16x32_bf16 v[56:59], a[204:207], v[132:135], v[56:59]
    v_mfma_f32_16x16x32_bf16 v[60:63], a[208:211], v[132:135], v[60:63]
    v_mfma_f32_16x16x32_bf16 v[64:67], a[212:215], v[132:135], v[64:67]
    s_add_u32 m0, s57, 65536
    s_add_u32 s65, s58, 114688
    buffer_load_dwordx4 v4, s[4:7], s65 offen sc1 lds
    v_mfma_f32_16x16x32_bf16 v[68:71], a[216:219], v[132:135], v[68:71]
    s_waitcnt vmcnt(19)
    v_mfma_f32_16x16x32_bf16 v[52:55], a[220:223], v[148:151], v[52:55]
    v_mfma_f32_16x16x32_bf16 v[56:59], a[224:227], v[148:151], v[56:59]
    v_mfma_f32_16x16x32_bf16 v[60:63], a[228:231], v[148:151], v[60:63]
    buffer_load_dwordx4 v4, s[4:7], s65 offen offset:1024 sc1 lds
    v_mfma_f32_16x16x32_bf16 v[64:67], a[232:235], v[148:151], v[64:67]
    v_mfma_f32_16x16x32_bf16 v[68:71], a[236:239], v[148:151], v[68:71]
    s_waitcnt vmcnt(19)
    v_mfma_f32_16x16x32_bf16 v[72:75], a[160:163], v[248:251], v[72:75]
    v_mfma_f32_16x16x32_bf16 v[76:79], a[164:167], v[248:251], v[76:79]
    buffer_load_dwordx4 v4, s[4:7], s65 offen offset:2048 sc1 lds
    v_mfma_f32_16x16x32_bf16 v[80:83], a[168:171], v[248:251], v[80:83]
    v_mfma_f32_16x16x32_bf16 v[84:87], a[172:175], v[248:251], v[84:87]
    v_mfma_f32_16x16x32_bf16 v[88:91], a[176:179], v[248:251], v[88:91]
    s_waitcnt vmcnt(19)
    v_mfma_f32_16x16x32_bf16 v[72:75], a[180:183], v[120:123], v[72:75]
    buffer_load_dwordx4 v4, s[4:7], s65 offen offset:3072 sc1 lds
    v_mfma_f32_16x16x32_bf16 v[76:79], a[184:187], v[120:123], v[76:79]
    ds_write_b128 v11, v[52:55] offset:0
    v_mfma_f32_16x16x32_bf16 v[80:83], a[188:191], v[120:123], v[80:83]
    v_mfma_f32_16x16x32_bf16 v[84:87], a[192:195], v[120:123], v[84:87]
    v_mfma_f32_16x16x32_bf16 v[88:91], a[196:199], v[120:123], v[88:91]
    ds_write_b128 v11, v[56:59] offset:1024
    s_waitcnt vmcnt(19)
    v_mfma_f32_16x16x32_bf16 v[72:75], a[200:203], v[136:139], v[72:75]
    v_mfma_f32_16x16x32_bf16 v[76:79], a[204:207], v[136:139], v[76:79]
    v_mfma_f32_16x16x32_bf16 v[80:83], a[208:211], v[136:139], v[80:83]
    ds_write_b128 v11, v[60:63] offset:2048
    v_mfma_f32_16x16x32_bf16 v[84:87], a[212:215], v[136:139], v[84:87]
    v_mfma_f32_16x16x32_bf16 v[88:91], a[216:219], v[136:139], v[88:91]
    s_waitcnt vmcnt(18)
    v_mfma_f32_16x16x32_bf16 v[72:75], a[220:223], v[152:155], v[72:75]
    ds_write_b128 v11, v[64:67] offset:3072
    v_mfma_f32_16x16x32_bf16 v[76:79], a[224:227], v[152:155], v[76:79]
    v_mfma_f32_16x16x32_bf16 v[80:83], a[228:231], v[152:155], v[80:83]
    v_mfma_f32_16x16x32_bf16 v[84:87], a[232:235], v[152:155], v[84:87]
    ds_write_b128 v11, v[68:71] offset:4096
    v_mfma_f32_16x16x32_bf16 v[88:91], a[236:239], v[152:155], v[88:91]
    s_waitcnt vmcnt(17)
    v_mfma_f32_16x16x32_bf16 v[92:95], a[160:163], v[252:255], v[92:95]
    v_lshlrev_b32 v176, 16, v14
    v_and_b32 v177, 0xffff0000, v14
    v_mfma_f32_16x16x32_bf16 v[96:99], a[164:167], v[252:255], v[96:99]
    v_lshlrev_b32 v178, 16, v15
    v_and_b32 v179, 0xffff0000, v15
    v_mfma_f32_16x16x32_bf16 v[100:103], a[168:171], v[252:255], v[100:103]
    v_lshlrev_b32 v180, 16, v16
    v_and_b32 v181, 0xffff0000, v16
    v_mfma_f32_16x16x32_bf16 v[104:107], a[172:175], v[252:255], v[104:107]
    v_lshlrev_b32 v182, 16, v17
    v_and_b32 v183, 0xffff0000, v17
    v_mfma_f32_16x16x32_bf16 v[108:111], a[176:179], v[252:255], v[108:111]
    ds_write_b128 v12, v[72:75] offset:5120
    v_lshlrev_b32 v184, 16, v18
    s_waitcnt vmcnt(16)
    v_mfma_f32_16x16x32_bf16 v[92:95], a[180:183], v[124:127], v[92:95]
    v_and_b32 v185, 0xffff0000, v18
    v_lshlrev_b32 v186, 16, v19
    v_mfma_f32_16x16x32_bf16 v[96:99], a[184:187], v[124:127], v[96:99]
    v_and_b32 v187, 0xffff0000, v19
    v_lshlrev_b32 v188, 16, v20
    v_mfma_f32_16x16x32_bf16 v[100:103], a[188:191], v[124:127], v[100:103]
    ds_write_b128 v12, v[76:79] offset:6144
    v_and_b32 v189, 0xffff0000, v20
    v_mfma_f32_16x16x32_bf16 v[104:107], a[192:195], v[124:127], v[104:107]
    v_lshlrev_b32 v190, 16, v21
    v_and_b32 v191, 0xffff0000, v21
    v_mfma_f32_16x16x32_bf16 v[108:111], a[196:199], v[124:127], v[108:111]
    v_lshlrev_b32 v192, 16, v22
    v_and_b32 v193, 0xffff0000, v22
    s_waitcnt vmcnt(15)
    v_mfma_f32_16x16x32_bf16 v[92:95], a[200:203], v[140:143], v[92:95]
    ds_write_b128 v12, v[80:83] offset:7168
    v_lshlrev_b32 v194, 16, v23
    v_mfma_f32_16x16x32_bf16 v[96:99], a[204:207], v[140:143], v[96:99]
    v_and_b32 v195, 0xffff0000, v23
    v_mfma_f32_16x16x32_bf16 v[100:103], a[208:211], v[140:143], v[100:103]
    v_mfma_f32_16x16x32_bf16 v[104:107], a[212:215], v[140:143], v[104:107]
    ds_write_b128 v12, v[84:87] offset:8192
    v_mfma_f32_16x16x32_bf16 v[108:111], a[216:219], v[140:143], v[108:111]
    s_waitcnt vmcnt(14)
    v_mfma_f32_16x16x32_bf16 v[92:95], a[220:223], v[156:159], v[92:95]
    v_mfma_f32_16x16x32_bf16 v[96:99], a[224:227], v[156:159], v[96:99]
    ds_write_b128 v12, v[88:91] offset:9216
    v_mfma_f32_16x16x32_bf16 v[100:103], a[228:231], v[156:159], v[100:103]
    v_mfma_f32_16x16x32_bf16 v[104:107], a[232:235], v[156:159], v[104:107]
    v_mfma_f32_16x16x32_bf16 v[108:111], a[236:239], v[156:159], v[108:111]
    s_waitcnt vmcnt(13)
    v_mfma_f32_16x16x32_bf16 v[32:35], a[160:163], v[240:243], v[32:35]
    v_mfma_f32_16x16x32_bf16 v[36:39], a[164:167], v[240:243], v[36:39]
    v_mfma_f32_16x16x32_bf16 v[40:43], a[168:171], v[240:243], v[40:43]
    v_mfma_f32_16x16x32_bf16 v[44:47], a[172:175], v[240:243], v[44:47]
    v_mfma_f32_16x16x32_bf16 v[48:51], a[176:179], v[240:243], v[48:51]
    s_waitcnt vmcnt(12)
    v_mfma_f32_16x16x32_bf16 v[32:35], a[180:183], v[112:115], v[32:35]
    ds_write_b128 v13, v[92:95] offset:10240
    v_mfma_f32_16x16x32_bf16 v[36:39], a[184:187], v[112:115], v[36:39]
    v_mfma_f32_16x16x32_bf16 v[40:43], a[188:191], v[112:115], v[40:43]
    v_mfma_f32_16x16x32_bf16 v[44:47], a[192:195], v[112:115], v[44:47]
    ds_write_b128 v13, v[96:99] offset:11264
    v_mfma_f32_16x16x32_bf16 v[48:51], a[196:199], v[112:115], v[48:51]
    s_waitcnt vmcnt(11)
    v_mfma_f32_16x16x32_bf16 v[32:35], a[200:203], v[128:131], v[32:35]
    v_mfma_f32_16x16x32_bf16 v[36:39], a[204:207], v[128:131], v[36:39]
    ds_write_b128 v13, v[100:103] offset:12288
    v_mfma_f32_16x16x32_bf16 v[40:43], a[208:211], v[128:131], v[40:43]
    v_mfma_f32_16x16x32_bf16 v[44:47], a[212:215], v[128:131], v[44:47]
    v_mfma_f32_16x16x32_bf16 v[48:51], a[216:219], v[128:131], v[48:51]
    ds_write_b128 v13, v[104:107] offset:13312
    s_waitcnt vmcnt(10)
    v_mfma_f32_16x16x32_bf16 v[32:35], a[220:223], v[144:147], v[32:35]
    v_mfma_f32_16x16x32_bf16 v[36:39], a[224:227], v[144:147], v[36:39]
    v_mfma_f32_16x16x32_bf16 v[40:43], a[228:231], v[144:147], v[40:43]
    ds_write_b128 v13, v[108:111] offset:14336
    v_mfma_f32_16x16x32_bf16 v[44:47], a[232:235], v[144:147], v[44:47]
    v_mfma_f32_16x16x32_bf16 v[48:51], a[236:239], v[144:147], v[48:51]
    s_waitcnt lgkmcnt(0)
    s_barrier
    ds_read_b128 v[196:199], v10 offset:0
    ds_read_b128 v[200:203], v10 offset:5120
    ds_read_b128 v[204:207], v10 offset:10240
    ds_read_b128 v[208:211], v10 offset:1024
    ds_read_b128 v[212:215], v10 offset:6144
    ds_read_b128 v[216:219], v10 offset:11264
    ds_read_b128 v[220:223], v10 offset:2048
    ds_read_b128 v[224:227], v10 offset:7168
    ds_read_b128 v[228:231], v10 offset:12288
    ds_read_b128 v[232:235], v10 offset:3072
    ds_read_b128 v[236:239], v10 offset:8192
    ds_read_b128 v[240:243], v10 offset:13312
    ds_read_b128 v[244:247], v10 offset:4096
    ds_read_b128 v[248:251], v10 offset:9216
    ds_read_b128 v[252:255], v10 offset:14336
    v_pk_add_f32 v[32:33], v[32:33], v[176:177]
    v_pk_add_f32 v[34:35], v[34:35], v[178:179]
    v_pk_add_f32 v[36:37], v[36:37], v[180:181]
    v_pk_add_f32 v[38:39], v[38:39], v[182:183]
    v_pk_add_f32 v[40:41], v[40:41], v[184:185]
    v_pk_add_f32 v[42:43], v[42:43], v[186:187]
    v_pk_add_f32 v[44:45], v[44:45], v[188:189]
    v_pk_add_f32 v[46:47], v[46:47], v[190:191]
    v_pk_add_f32 v[48:49], v[48:49], v[192:193]
    v_pk_add_f32 v[50:51], v[50:51], v[194:195]
    v_mov_b32 v26, 0
    v_mov_b32 v27, 0
    s_mov_b32 s27, 0x3f803f80
    s_waitcnt lgkmcnt(12)
    v_pk_add_f32 v[32:33], v[32:33], v[196:197]
    v_pk_add_f32 v[200:201], v[200:201], v[204:205]
    v_pk_add_f32 v[34:35], v[34:35], v[198:199]
    v_pk_add_f32 v[202:203], v[202:203], v[206:207]
    v_pk_add_f32 v[32:33], v[32:33], v[200:201]
    v_pk_add_f32 v[34:35], v[34:35], v[202:203]
    v_cvt_pk_bf16_f32 v112, v32, v33
    v_cvt_pk_bf16_f32 v113, v34, v35
    v_dot2c_f32_bf16 v26, s27, v112
    v_dot2c_f32_bf16 v27, v112, v112
    v_dot2c_f32_bf16 v26, s27, v113
    v_dot2c_f32_bf16 v27, v113, v113
    s_waitcnt lgkmcnt(9)
    v_pk_add_f32 v[36:37], v[36:37], v[208:209]
    v_pk_add_f32 v[212:213], v[212:213], v[216:217]
    v_pk_add_f32 v[38:39], v[38:39], v[210:211]
    v_pk_add_f32 v[214:215], v[214:215], v[218:219]
    v_pk_add_f32 v[36:37], v[36:37], v[212:213]
    v_pk_add_f32 v[38:39], v[38:39], v[214:215]
    v_cvt_pk_bf16_f32 v114, v36, v37
    v_cvt_pk_bf16_f32 v115, v38, v39
    v_dot2c_f32_bf16 v26, s27, v114
    v_dot2c_f32_bf16 v27, v114, v114
    v_dot2c_f32_bf16 v26, s27, v115
    v_dot2c_f32_bf16 v27, v115, v115
    v_permlane16_swap_b32 v112, v114
    v_permlane16_swap_b32 v113, v115
    buffer_store_dwordx4 v[112:115], v9, s[4:7], s30 offen offset:0 sc1
    s_waitcnt lgkmcnt(6)
    v_pk_add_f32 v[40:41], v[40:41], v[220:221]
    v_pk_add_f32 v[224:225], v[224:225], v[228:229]
    v_pk_add_f32 v[42:43], v[42:43], v[222:223]
    v_pk_add_f32 v[226:227], v[226:227], v[230:231]
    v_pk_add_f32 v[40:41], v[40:41], v[224:225]
    v_pk_add_f32 v[42:43], v[42:43], v[226:227]
    v_cvt_pk_bf16_f32 v116, v40, v41
    v_cvt_pk_bf16_f32 v117, v42, v43
    v_dot2c_f32_bf16 v26, s27, v116
    v_dot2c_f32_bf16 v27, v116, v116
    v_dot2c_f32_bf16 v26, s27, v117
    v_dot2c_f32_bf16 v27, v117, v117
    s_waitcnt lgkmcnt(3)
    v_pk_add_f32 v[44:45], v[44:45], v[232:233]
    v_pk_add_f32 v[236:237], v[236:237], v[240:241]
    v_pk_add_f32 v[46:47], v[46:47], v[234:235]
    v_pk_add_f32 v[238:239], v[238:239], v[242:243]
    v_pk_add_f32 v[44:45], v[44:45], v[236:237]
    v_pk_add_f32 v[46:47], v[46:47], v[238:239]
    v_cvt_pk_bf16_f32 v118, v44, v45
    v_cvt_pk_bf16_f32 v119, v46, v47
    v_dot2c_f32_bf16 v26, s27, v118
    v_dot2c_f32_bf16 v27, v118, v118
    v_dot2c_f32_bf16 v26, s27, v119
    v_dot2c_f32_bf16 v27, v119, v119
    v_permlane16_swap_b32 v116, v118
    v_permlane16_swap_b32 v117, v119
    buffer_store_dwordx4 v[116:119], v9, s[4:7], s30 offen offset:2048 sc1
    s_waitcnt lgkmcnt(0)
    v_pk_add_f32 v[48:49], v[48:49], v[244:245]
    v_pk_add_f32 v[248:249], v[248:249], v[252:253]
    v_pk_add_f32 v[50:51], v[50:51], v[246:247]
    v_pk_add_f32 v[250:251], v[250:251], v[254:255]
    v_pk_add_f32 v[48:49], v[48:49], v[248:249]
    v_pk_add_f32 v[50:51], v[50:51], v[250:251]
    v_cvt_pk_bf16_f32 v120, v48, v49
    v_cvt_pk_bf16_f32 v121, v50, v51
    v_dot2c_f32_bf16 v26, s27, v120
    v_dot2c_f32_bf16 v27, v120, v120
    v_dot2c_f32_bf16 v26, s27, v121
    v_dot2c_f32_bf16 v27, v121, v121
    v_mov_b32 v122, v120
    v_mov_b32 v123, v121
    s_nop 0
    v_permlane16_swap_b32 v120, v122
    v_permlane16_swap_b32 v121, v123
    s_mov_b32 exec_lo, 0xffff
    s_mov_b32 exec_hi, 0xffff
    buffer_store_dwordx4 v[120:123], v9, s[4:7], s29 offen offset:0 sc1
    s_mov_b64 exec, -1
    v_mov_b32 v28, v26
    v_mov_b32 v29, v27
    s_nop 0
    v_permlane16_swap_b32 v26, v28
    v_permlane16_swap_b32 v27, v29
    v_add_f32 v26, v26, v28
    v_add_f32 v27, v27, v29
    v_mov_b32 v28, v26
    v_mov_b32 v29, v27
    s_nop 0
    v_permlane32_swap_b32 v26, v28
    v_permlane32_swap_b32 v27, v29
    v_add_f32 v26, v26, v28
    v_add_f32 v27, v27, v29
    s_mov_b64 exec, 0xffff
    buffer_store_dwordx2 v[26:27], v24, s[4:7], s31 offen sc1
    s_mov_b64 exec, -1
    v_cvt_f32_u32 v56, v2
    v_mul_f32 v56, 0x3d000000, v56
    v_cvt_f32_u32 v57, v3
    v_mul_f32 v57, 4.0, v57
    v_mul_f32 v57, v57, v56
    v_fmamk_f32 v58, v56, 0x0, v57
    v_fmamk_f32 v59, v56, 0x3f800000, v57
    v_cos_f32 v60, v58
    v_cos_f32 v61, v59
    v_sin_f32 v62, v58
    v_sin_f32 v63, v59
    v_cvt_pk_bf16_f32 v32, v60, v61
    v_cvt_pk_bf16_f32 v40, v62, v63
    v_xor_b32 v48, 0x80008000, v32
    v_fmamk_f32 v58, v56, 0x40000000, v57
    v_fmamk_f32 v59, v56, 0x40400000, v57
    v_cos_f32 v60, v58
    v_cos_f32 v61, v59
    v_sin_f32 v62, v58
    v_sin_f32 v63, v59
    v_cvt_pk_bf16_f32 v33, v60, v61
    v_cvt_pk_bf16_f32 v41, v62, v63
    v_xor_b32 v49, 0x80008000, v33
    v_fmamk_f32 v58, v56, 0x41000000, v57
    v_fmamk_f32 v59, v56, 0x41100000, v57
    v_cos_f32 v60, v58
    v_cos_f32 v61, v59
    v_sin_f32 v62, v58
    v_sin_f32 v63, v59
    v_cvt_pk_bf16_f32 v34, v60, v61
    v_cvt_pk_bf16_f32 v42, v62, v63
    v_xor_b32 v50, 0x80008000, v34
    v_fmamk_f32 v58, v56, 0x41200000, v57
    v_fmamk_f32 v59, v56, 0x41300000, v57
    v_cos_f32 v60, v58
    v_cos_f32 v61, v59
    v_sin_f32 v62, v58
    v_sin_f32 v63, v59
    v_cvt_pk_bf16_f32 v35, v60, v61
    v_cvt_pk_bf16_f32 v43, v62, v63
    v_xor_b32 v51, 0x80008000, v35
    v_fmamk_f32 v58, v56, 0x41800000, v57
    v_fmamk_f32 v59, v56, 0x41880000, v57
    v_cos_f32 v60, v58
    v_cos_f32 v61, v59
    v_sin_f32 v62, v58
    v_sin_f32 v63, v59
    v_cvt_pk_bf16_f32 v36, v60, v61
    v_cvt_pk_bf16_f32 v44, v62, v63
    v_xor_b32 v52, 0x80008000, v36
    v_fmamk_f32 v58, v56, 0x41900000, v57
    v_fmamk_f32 v59, v56, 0x41980000, v57
    v_cos_f32 v60, v58
    v_cos_f32 v61, v59
    v_sin_f32 v62, v58
    v_sin_f32 v63, v59
    v_cvt_pk_bf16_f32 v37, v60, v61
    v_cvt_pk_bf16_f32 v45, v62, v63
    v_xor_b32 v53, 0x80008000, v37
    v_fmamk_f32 v58, v56, 0x41c00000, v57
    v_fmamk_f32 v59, v56, 0x41c80000, v57
    v_cos_f32 v60, v58
    v_cos_f32 v61, v59
    v_sin_f32 v62, v58
    v_sin_f32 v63, v59
    v_cvt_pk_bf16_f32 v38, v60, v61
    v_cvt_pk_bf16_f32 v46, v62, v63
    v_xor_b32 v54, 0x80008000, v38
    v_fmamk_f32 v58, v56, 0x41d00000, v57
    v_fmamk_f32 v59, v56, 0x41d80000, v57
    v_cos_f32 v60, v58
    v_cos_f32 v61, v59
    v_sin_f32 v62, v58
    v_sin_f32 v63, v59
    v_cvt_pk_bf16_f32 v39, v60, v61
    v_cvt_pk_bf16_f32 v47, v62, v63
    v_xor_b32 v55, 0x80008000, v39
    s_waitcnt vmcnt(0)
    s_barrier
    s_cmp_lg_u32 s3, 0
    s_cbranch_scc1 Lw_prompt_98
    s_add_u32 s21, s64, 35652608
    s_mov_b64 exec, 1
    buffer_atomic_add v31, v30, s[4:7], s21 offen sc1
    s_mov_b64 exec, -1
Lw_prompt_98:
    s_cmp_ge_u32 s17, 10
    s_cbranch_scc1 Lnop1_prompt_99
    s_mul_i32 s22, s20, 40960
    s_add_u32 s22, s22, 32505856
    s_lshl_b32 s28, s20, 11
    s_add_u32 s28, s28, 37224448
    v_lshlrev_b32 v24, 3, v1
    v_add_u32 v5, 0x10000, v4
    s_add_u32 m0, s57, 98304
    s_add_u32 s65, s58, 0
    buffer_load_dwordx4 v4, s[4:7], s65 offen sc1 lds
    buffer_load_dwordx4 v4, s[4:7], s65 offen offset:1024 sc1 lds
    buffer_load_dwordx4 v4, s[4:7], s65 offen offset:2048 sc1 lds
    buffer_load_dwordx4 v4, s[4:7], s65 offen offset:3072 sc1 lds
    s_cmp_lg_u32 s3, 3
    s_cbranch_scc1 Lw_prompt_102
    s_add_u32 s21, s64, 35652608
    v_lshlrev_b32 v29, 7, v1
    s_mov_b64 exec, 1
    s_mov_b32 s66, 0
Lp_prompt_103:
    buffer_load_dword v0, v29, s[4:7], s21 offen sc1
    s_add_u32 s66, s66, 1
    s_waitcnt vmcnt(0)
    v_cmp_gt_u32 vcc, 16, v0
    s_cbranch_vccz Lq_prompt_101
    s_cmp_lt_u32 s66, 0x40000
    s_cbranch_scc0 Lq_prompt_101
    s_sleep 4
    s_branch Lp_prompt_103
Lq_prompt_101:
    s_mov_b64 exec, -1
Lw_prompt_102:
    s_barrier
    s_add_u32 s12, s22, 20480
    buffer_load_dwordx4 v[96:99], v4, s[4:7], s22 offen sc1
    buffer_load_dwordx4 v[100:103], v4, s[4:7], s12 offen sc1
    buffer_load_dwordx4 v[104:107], v4, s[4:7], s22 offen offset:1024 sc1
    buffer_load_dwordx4 v[108:111], v4, s[4:7], s12 offen offset:1024 sc1
    ds_read_b128 a[240:243], v4 offset:0
    ds_read_b128 a[244:247], v4 offset:1024
    ds_read_b128 a[248:251], v4 offset:2048
    ds_read_b128 a[252:255], v4 offset:3072
    buffer_load_dwordx2 v[224:225], v24, s[4:7], s28 offen offset:0 sc1
    buffer_load_dwordx2 v[226:227], v24, s[4:7], s28 offen offset:512 sc1
    buffer_load_dwordx2 v[228:229], v24, s[4:7], s28 offen offset:1024 sc1
    buffer_load_dwordx2 v[230:231], v24, s[4:7], s28 offen offset:1536 sc1
    buffer_load_dwordx4 v[112:115], v4, s[4:7], s22 offen offset:2048 sc1
    buffer_load_dwordx4 v[116:119], v4, s[4:7], s12 offen offset:2048 sc1
    buffer_load_dwordx4 v[120:123], v4, s[4:7], s22 offen offset:3072 sc1
    buffer_load_dwordx4 v[124:127], v4, s[4:7], s12 offen offset:3072 sc1
    s_add_u32 s23, s22, 4096
    buffer_load_dwordx4 v[128:131], v4, s[4:7], s23 offen sc1
    s_add_u32 s13, s12, 4096
    buffer_load_dwordx4 v[132:135], v4, s[4:7], s13 offen sc1
    buffer_load_dwordx4 v[136:139], v4, s[4:7], s23 offen offset:1024 sc1
    buffer_load_dwordx4 v[140:143], v4, s[4:7], s13 offen offset:1024 sc1
    buffer_load_dwordx4 v[144:147], v4, s[4:7], s23 offen offset:2048 sc1
    buffer_load_dwordx4 v[148:151], v4, s[4:7], s13 offen offset:2048 sc1
    ds_read_b128 v[56:59], v4 offset:4096
    s_waitcnt vmcnt(17)
    s_waitcnt lgkmcnt(3)
    v_mfma_f32_32x32x16_bf16 v[64:79], v[96:99], a[240:243], 0
    ds_read_b128 v[60:63], v4 offset:5120
    v_mfma_f32_32x32x16_bf16 v[80:95], v[96:99], a[244:247], 0
    buffer_load_dwordx4 v[152:155], v4, s[4:7], s23 offen offset:3072 sc1
    s_waitcnt vmcnt(17)
    v_mfma_f32_32x32x16_bf16 v[192:207], v[100:103], a[240:243], 0
    v_mfma_f32_32x32x16_bf16 v[208:223], v[100:103], a[244:247], 0
    buffer_load_dwordx4 v[156:159], v4, s[4:7], s13 offen offset:3072 sc1
    ds_read_b128 a[240:243], v4 offset:6144
    s_waitcnt vmcnt(17)
    s_waitcnt lgkmcnt(3)
    v_mfma_f32_32x32x16_bf16 v[64:79], v[104:107], a[248:251], v[64:79]
    ds_read_b128 a[244:247], v4 offset:7168
    v_mfma_f32_32x32x16_bf16 v[80:95], v[104:107], a[252:255], v[80:95]
    s_add_u32 s23, s22, 8192
    buffer_load_dwordx4 v[160:163], v4, s[4:7], s23 offen sc1
    s_waitcnt vmcnt(17)
    v_mfma_f32_32x32x16_bf16 v[192:207], v[108:111], a[248:251], v[192:207]
    v_mfma_f32_32x32x16_bf16 v[208:223], v[108:111], a[252:255], v[208:223]
    s_add_u32 s13, s12, 8192
    buffer_load_dwordx4 v[164:167], v4, s[4:7], s13 offen sc1
    ds_read_b128 a[248:251], v4 offset:8192
    s_waitcnt vmcnt(13)
    s_waitcnt lgkmcnt(3)
    v_mfma_f32_32x32x16_bf16 v[64:79], v[112:115], v[56:59], v[64:79]
    ds_read_b128 a[252:255], v4 offset:9216
    v_mfma_f32_32x32x16_bf16 v[80:95], v[112:115], v[60:63], v[80:95]
    buffer_load_dwordx4 v[168:171], v4, s[4:7], s23 offen offset:1024 sc1
    s_waitcnt vmcnt(13)
    v_mfma_f32_32x32x16_bf16 v[192:207], v[116:119], v[56:59], v[192:207]
    v_add_f32 v224, v224, v226
    v_add_f32 v225, v225, v227
    v_mfma_f32_32x32x16_bf16 v[208:223], v[116:119], v[60:63], v[208:223]
    buffer_load_dwordx4 v[172:175], v4, s[4:7], s13 offen offset:1024 sc1
    v_add_f32 v224, v224, v228
    ds_read_b128 v[56:59], v4 offset:10240
    s_waitcnt vmcnt(13)
    s_waitcnt lgkmcnt(3)
    v_mfma_f32_32x32x16_bf16 v[64:79], v[120:123], a[240:243], v[64:79]
    v_add_f32 v225, v225, v229
    v_add_f32 v224, v224, v230
    ds_read_b128 v[60:63], v4 offset:11264
    v_mfma_f32_32x32x16_bf16 v[80:95], v[120:123], a[244:247], v[80:95]
    buffer_load_dwordx4 v[176:179], v4, s[4:7], s23 offen offset:2048 sc1
    v_add_f32 v225, v225, v231
    s_waitcnt vmcnt(13)
    v_mfma_f32_32x32x16_bf16 v[192:207], v[124:127], a[240:243], v[192:207]
    v_mov_b32 v226, v224
    v_mov_b32 v227, v224
    v_mfma_f32_32x32x16_bf16 v[208:223], v[124:127], a[244:247], v[208:223]
    buffer_load_dwordx4 v[180:183], v4, s[4:7], s13 offen offset:2048 sc1
    s_nop 0
    ds_read_b128 a[240:243], v4 offset:12288
    s_waitcnt vmcnt(13)
    s_waitcnt lgkmcnt(3)
    v_mfma_f32_32x32x16_bf16 v[64:79], v[128:131], a[248:251], v[64:79]
    v_permlane32_swap_b32 v226, v227
    v_add_f32 v224, v226, v227
    ds_read_b128 a[244:247], v4 offset:13312
    v_mfma_f32_32x32x16_bf16 v[80:95], v[128:131], a[252:255], v[80:95]
    buffer_load_dwordx4 v[184:187], v4, s[4:7], s23 offen offset:3072 sc1
    v_mov_b32 v226, v225
    s_waitcnt vmcnt(13)
    v_mfma_f32_32x32x16_bf16 v[192:207], v[132:135], a[248:251], v[192:207]
    v_mov_b32 v227, v225
    s_nop 0
    v_mfma_f32_32x32x16_bf16 v[208:223], v[132:135], a[252:255], v[208:223]
    buffer_load_dwordx4 v[188:191], v4, s[4:7], s13 offen offset:3072 sc1
    v_permlane32_swap_b32 v226, v227
    ds_read_b128 a[248:251], v4 offset:14336
    s_waitcnt vmcnt(13)
    s_waitcnt lgkmcnt(3)
    v_mfma_f32_32x32x16_bf16 v[64:79], v[136:139], v[56:59], v[64:79]
    v_add_f32 v225, v226, v227
    v_mul_f32 v224, 0xbacccccd, v224
    ds_read_b128 a[252:255], v4 offset:15360
    v_mfma_f32_32x32x16_bf16 v[80:95], v[136:139], v[60:63], v[80:95]
    s_add_u32 s23, s22, 12288
    buffer_load_dwordx4 v[96:99], v4, s[4:7], s23 offen sc1
    v_mul_f32 v225, 0x3acccccd, v225
    s_waitcnt vmcnt(13)
    v_mfma_f32_32x32x16_bf16 v[192:207], v[140:143], v[56:59], v[192:207]
    v_fma_f32 v225, -v224, v224, v225
    v_max_f32 v225, 0, v225
    v_mfma_f32_32x32x16_bf16 v[208:223], v[140:143], v[60:63], v[208:223]
    s_add_u32 s13, s12, 12288
    buffer_load_dwordx4 v[100:103], v4, s[4:7], s13 offen sc1
    v_add_f32 v225, 0x3727c5ac, v225
    ds_read_b128 v[56:59], v4 offset:16384
    s_waitcnt vmcnt(13)
    s_waitcnt lgkmcnt(3)
    v_mfma_f32_32x32x16_bf16 v[64:79], v[144:147], a[240:243], v[64:79]
    v_rsq_f32 v227, v225
    s_lshl_b32 s25, s3, 7
    ds_read_b128 v[60:63], v4 offset:17408
    v_mfma_f32_32x32x16_bf16 v[80:95], v[144:147], a[244:247], v[80:95]
    buffer_load_dwordx4 v[104:107], v4, s[4:7], s23 offen offset:1024 sc1
    s_add_u32 s25, s25, 147456
    s_waitcnt vmcnt(13)
    v_mfma_f32_32x32x16_bf16 v[192:207], v[148:151], a[240:243], v[192:207]
    v_lshl_add_u32 v28, v2, 2, s25
    ds_write_b32 v28, v227
    v_mfma_f32_32x32x16_bf16 v[208:223], v[148:151], a[244:247], v[208:223]
    buffer_load_dwordx4 v[108:111], v4, s[4:7], s13 offen offset:1024 sc1
    v_lshl_add_u32 v28, v3, 4, s25
    ds_read_b128 a[240:243], v4 offset:18432
    s_waitcnt vmcnt(13)
    s_waitcnt lgkmcnt(4)
    v_mfma_f32_32x32x16_bf16 v[64:79], v[152:155], a[248:251], v[64:79]
    ds_read_b128 v[8:11], v28 offset:0
    ds_read_b128 v[12:15], v28 offset:32
    ds_read_b128 a[244:247], v4 offset:19456
    v_mfma_f32_32x32x16_bf16 v[80:95], v[152:155], a[252:255], v[80:95]
    buffer_load_dwordx4 v[112:115], v4, s[4:7], s23 offen offset:2048 sc1
    ds_read_b128 v[16:19], v28 offset:64
    s_waitcnt vmcnt(13)
    v_mfma_f32_32x32x16_bf16 v[192:207], v[156:159], a[248:251], v[192:207]
    ds_read_b128 v[20:23], v28 offset:96
    s_lshl_b32 s24, s3, 12
    v_mfma_f32_32x32x16_bf16 v[208:223], v[156:159], a[252:255], v[208:223]
    buffer_load_dwordx4 v[116:119], v4, s[4:7], s13 offen offset:2048 sc1
    s_add_u32 s24, s24, 81920
    ds_read_b128 a[248:251], v4 offset:20480
    s_waitcnt vmcnt(13)
    s_waitcnt lgkmcnt(8)
    v_mfma_f32_32x32x16_bf16 v[64:79], v[160:163], v[56:59], v[64:79]
    v_lshl_add_u32 v26, v2, 2, s24
    v_lshl_add_u32 v26, v3, 9, v26
    ds_read_b128 a[252:255], v4 offset:21504
    v_mfma_f32_32x32x16_bf16 v[80:95], v[160:163], v[60:63], v[80:95]
    buffer_load_dwordx4 v[120:123], v4, s[4:7], s23 offen offset:3072 sc1
    s_lshl_b32 s24, s3, 10
    s_waitcnt vmcnt(13)
    v_mfma_f32_32x32x16_bf16 v[192:207], v[164:167], v[56:59], v[192:207]
    s_add_u32 s24, s24, 81920
    v_lshl_add_u32 v27, v1, 2, s24
    v_mfma_f32_32x32x16_bf16 v[208:223], v[164:167], v[60:63], v[208:223]
    buffer_load_dwordx4 v[124:127], v4, s[4:7], s13 offen offset:3072 sc1
    s_mul_i32 s27, s16, 5120
    ds_read_b128 v[56:59], v4 offset:22528
    s_waitcnt vmcnt(13)
    s_waitcnt lgkmcnt(5)
    v_mfma_f32_32x32x16_bf16 v[64:79], v[168:171], a[240:243], v[64:79]
    s_lshl_b32 s24, s17, 9
    s_add_u32 s27, s27, s24
    ds_read_b128 v[60:63], v4 offset:23552
    v_mfma_f32_32x32x16_bf16 v[80:95], v[168:171], a[244:247], v[80:95]
    s_add_u32 s23, s22, 16384
    buffer_load_dwordx4 v[128:131], v4, s[4:7], s23 offen sc1
    s_mul_i32 s24, s3, 655360
    s_waitcnt vmcnt(13)
    v_mfma_f32_32x32x16_bf16 v[192:207], v[172:175], a[240:243], v[192:207]
    s_add_u32 s27, s27, s24
    s_add_u32 s27, s27, 10485760
    v_mfma_f32_32x32x16_bf16 v[208:223], v[172:175], a[244:247], v[208:223]
    s_add_u32 s13, s12, 16384
    buffer_load_dwordx4 v[132:135], v4, s[4:7], s13 offen sc1
    v_mul_u32_u24 v29, 81920, v3
    ds_read_b128 a[240:243], v4 offset:24576
    s_waitcnt vmcnt(13)
    s_waitcnt lgkmcnt(3)
    v_mfma_f32_32x32x16_bf16 v[64:79], v[176:179], a[248:251], v[64:79]
    v_lshl_add_u32 v29, v2, 4, v29
    s_lshl_b32 s29, s17, 4
    ds_read_b128 a[244:247], v4 offset:25600
    v_mfma_f32_32x32x16_bf16 v[80:95], v[176:179], a[252:255], v[80:95]
    buffer_load_dwordx4 v[136:139], v4, s[4:7], s23 offen offset:1024 sc1
    s_add_u32 s29, s29, s16
    s_waitcnt vmcnt(13)
    v_mfma_f32_32x32x16_bf16 v[192:207], v[180:183], a[248:251], v[192:207]
    s_lshl_b32 s29, s29, 7
    v_mfma_f32_32x32x16_bf16 v[208:223], v[180:183], a[252:255], v[208:223]
    buffer_load_dwordx4 v[140:143], v4, s[4:7], s13 offen offset:1024 sc1
    ds_read_b128 a[248:251], v4 offset:26624
    s_waitcnt vmcnt(13)
    s_waitcnt lgkmcnt(3)
    v_mfma_f32_32x32x16_bf16 v[64:79], v[184:187], v[56:59], v[64:79]
    ds_read_b128 a[252:255], v4 offset:27648
    v_mfma_f32_32x32x16_bf16 v[80:95], v[184:187], v[60:63], v[80:95]
    buffer_load_dwordx4 v[144:147], v4, s[4:7], s23 offen offset:2048 sc1
    s_waitcnt vmcnt(13)
    v_mfma_f32_32x32x16_bf16 v[192:207], v[188:191], v[56:59], v[192:207]
    v_mfma_f32_32x32x16_bf16 v[208:223], v[188:191], v[60:63], v[208:223]
    buffer_load_dwordx4 v[148:151], v4, s[4:7], s13 offen offset:2048 sc1
    ds_read_b128 v[56:59], v4 offset:28672
    s_waitcnt vmcnt(13)
    s_waitcnt lgkmcnt(3)
    v_mfma_f32_32x32x16_bf16 v[64:79], v[96:99], a[240:243], v[64:79]
    ds_read_b128 v[60:63], v4 offset:29696
    v_mfma_f32_32x32x16_bf16 v[80:95], v[96:99], a[244:247], v[80:95]
    buffer_load_dwordx4 v[152:155], v4, s[4:7], s23 offen offset:3072 sc1
    s_waitcnt vmcnt(13)
    v_mfma_f32_32x32x16_bf16 v[192:207], v[100:103], a[240:243], v[192:207]
    v_mfma_f32_32x32x16_bf16 v[208:223], v[100:103], a[244:247], v[208:223]
    buffer_load_dwordx4 v[156:159], v4, s[4:7], s13 offen offset:3072 sc1
    ds_read_b128 a[240:243], v4 offset:30720
    s_waitcnt vmcnt(13)
    s_waitcnt lgkmcnt(3)
    v_mfma_f32_32x32x16_bf16 v[64:79], v[104:107], a[248:251], v[64:79]
    ds_read_b128 a[244:247], v4 offset:31744
    v_mfma_f32_32x32x16_bf16 v[80:95], v[104:107], a[252:255], v[80:95]
    s_waitcnt vmcnt(12)
    v_mfma_f32_32x32x16_bf16 v[192:207], v[108:111], a[248:251], v[192:207]
    v_mfma_f32_32x32x16_bf16 v[208:223], v[108:111], a[252:255], v[208:223]
    ds_read_b128 a[248:251], v4 offset:32768
    s_waitcnt vmcnt(11)
    s_waitcnt lgkmcnt(3)
    v_mfma_f32_32x32x16_bf16 v[64:79], v[112:115], v[56:59], v[64:79]
    ds_read_b128 a[252:255], v4 offset:33792
    v_mfma_f32_32x32x16_bf16 v[80:95], v[112:115], v[60:63], v[80:95]
    s_waitcnt vmcnt(10)
    v_mfma_f32_32x32x16_bf16 v[192:207], v[116:119], v[56:59], v[192:207]
    v_mfma_f32_32x32x16_bf16 v[208:223], v[116:119], v[60:63], v[208:223]
    ds_read_b128 v[56:59], v4 offset:34816
    s_waitcnt vmcnt(9)
    s_waitcnt lgkmcnt(3)
    v_mfma_f32_32x32x16_bf16 v[64:79], v[120:123], a[240:243], v[64:79]
    ds_read_b128 v[60:63], v4 offset:35840
    v_mfma_f32_32x32x16_bf16 v[80:95], v[120:123], a[244:247], v[80:95]
    s_waitcnt vmcnt(8)
    v_mfma_f32_32x32x16_bf16 v[192:207], v[124:127], a[240:243], v[192:207]
    v_mfma_f32_32x32x16_bf16 v[208:223], v[124:127], a[244:247], v[208:223]
    ds_read_b128 a[240:243], v4 offset:36864
    s_waitcnt vmcnt(7)
    s_waitcnt lgkmcnt(3)
    v_mfma_f32_32x32x16_bf16 v[64:79], v[128:131], a[248:251], v[64:79]
    ds_read_b128 a[244:247], v4 offset:37888
    v_mfma_f32_32x32x16_bf16 v[80:95], v[128:131], a[252:255], v[80:95]
    s_waitcnt vmcnt(6)
    v_mfma_f32_32x32x16_bf16 v[192:207], v[132:135], a[248:251], v[192:207]
    v_mfma_f32_32x32x16_bf16 v[208:223], v[132:135], a[252:255], v[208:223]
    ds_read_b128 a[248:251], v4 offset:38912
    s_waitcnt vmcnt(5)
    s_waitcnt lgkmcnt(3)
    v_mfma_f32_32x32x16_bf16 v[64:79], v[136:139], v[56:59], v[64:79]
    ds_read_b128 a[252:255], v4 offset:39936
    v_mfma_f32_32x32x16_bf16 v[80:95], v[136:139], v[60:63], v[80:95]
    s_waitcnt vmcnt(4)
    v_mfma_f32_32x32x16_bf16 v[192:207], v[140:143], v[56:59], v[192:207]
    v_mfma_f32_32x32x16_bf16 v[208:223], v[140:143], v[60:63], v[208:223]
    s_waitcnt vmcnt(3)
    s_waitcnt lgkmcnt(2)
    v_mfma_f32_32x32x16_bf16 v[64:79], v[144:147], a[240:243], v[64:79]
    v_mfma_f32_32x32x16_bf16 v[80:95], v[144:147], a[244:247], v[80:95]
    s_waitcnt vmcnt(2)
    v_mfma_f32_32x32x16_bf16 v[192:207], v[148:151], a[240:243], v[192:207]
    v_mfma_f32_32x32x16_bf16 v[208:223], v[148:151], a[244:247], v[208:223]
    s_waitcnt vmcnt(1)
    s_waitcnt lgkmcnt(0)
    v_mfma_f32_32x32x16_bf16 v[64:79], v[152:155], a[248:251], v[64:79]
    v_mfma_f32_32x32x16_bf16 v[80:95], v[152:155], a[252:255], v[80:95]
    s_waitcnt vmcnt(0)
    v_mfma_f32_32x32x16_bf16 v[192:207], v[156:159], a[248:251], v[192:207]
    v_mfma_f32_32x32x16_bf16 v[208:223], v[156:159], a[252:255], v[208:223]
    v_and_b32 v24, 1, v2
    v_lshlrev_b32 v24, 31, v24
    v_or_b32 v24, 1.0, v24
    s_nop 7
    v_pk_fma_f32 v[64:65], v[192:193], v[24:25], v[64:65] op_sel_hi:[1,0,1]
    v_pk_fma_f32 v[66:67], v[194:195], v[24:25], v[66:67] op_sel_hi:[1,0,1]
    v_pk_fma_f32 v[68:69], v[196:197], v[24:25], v[68:69] op_sel_hi:[1,0,1]
    v_pk_fma_f32 v[70:71], v[198:199], v[24:25], v[70:71] op_sel_hi:[1,0,1]
    v_pk_fma_f32 v[72:73], v[200:201], v[24:25], v[72:73] op_sel_hi:[1,0,1]
    v_pk_fma_f32 v[74:75], v[202:203], v[24:25], v[74:75] op_sel_hi:[1,0,1]
    v_pk_fma_f32 v[76:77], v[204:205], v[24:25], v[76:77] op_sel_hi:[1,0,1]
    v_pk_fma_f32 v[78:79], v[206:207], v[24:25], v[78:79] op_sel_hi:[1,0,1]
    v_pk_fma_f32 v[80:81], v[208:209], v[24:25], v[80:81] op_sel_hi:[1,0,1]
    v_pk_fma_f32 v[82:83], v[210:211], v[24:25], v[82:83] op_sel_hi:[1,0,1]
    v_pk_fma_f32 v[84:85], v[212:213], v[24:25], v[84:85] op_sel_hi:[1,0,1]
    v_pk_fma_f32 v[86:87], v[214:215], v[24:25], v[86:87] op_sel_hi:[1,0,1]
    v_pk_fma_f32 v[88:89], v[216:217], v[24:25], v[88:89] op_sel_hi:[1,0,1]
    v_pk_fma_f32 v[90:91], v[218:219], v[24:25], v[90:91] op_sel_hi:[1,0,1]
    v_pk_fma_f32 v[92:93], v[220:221], v[24:25], v[92:93] op_sel_hi:[1,0,1]
    v_pk_fma_f32 v[94:95], v[222:223], v[24:25], v[94:95] op_sel_hi:[1,0,1]
    s_mov_b32 s15, s29
    v_pk_mul_f32 v[64:65], v[64:65], v[8:9]
    v_pk_mul_f32 v[66:67], v[66:67], v[10:11]
    v_pk_mul_f32 v[68:69], v[68:69], v[12:13]
    v_pk_mul_f32 v[70:71], v[70:71], v[14:15]
    v_pk_mul_f32 v[72:73], v[72:73], v[16:17]
    v_pk_mul_f32 v[74:75], v[74:75], v[18:19]
    v_pk_mul_f32 v[76:77], v[76:77], v[20:21]
    v_pk_mul_f32 v[78:79], v[78:79], v[22:23]
    v_pk_mul_f32 v[80:81], v[80:81], v[8:9]
    v_pk_mul_f32 v[82:83], v[82:83], v[10:11]
    v_pk_mul_f32 v[84:85], v[84:85], v[12:13]
    v_pk_mul_f32 v[86:87], v[86:87], v[14:15]
    v_pk_mul_f32 v[88:89], v[88:89], v[16:17]
    v_pk_mul_f32 v[90:91], v[90:91], v[18:19]
    v_pk_mul_f32 v[92:93], v[92:93], v[20:21]
    v_pk_mul_f32 v[94:95], v[94:95], v[22:23]
    v_cvt_pk_bf16_f32 v112, v64, v65
    v_cvt_pk_bf16_f32 v113, v66, v67
    v_cvt_pk_bf16_f32 v114, v68, v69
    v_cvt_pk_bf16_f32 v115, v70, v71
    v_cvt_pk_bf16_f32 v116, v72, v73
    v_cvt_pk_bf16_f32 v117, v74, v75
    v_cvt_pk_bf16_f32 v118, v76, v77
    v_cvt_pk_bf16_f32 v119, v78, v79
    v_mfma_f32_32x32x16_bf16 v[128:143], v[32:35], v[112:115], 0
    v_mfma_f32_32x32x16_bf16 v[144:159], v[40:43], v[112:115], 0
    v_mfma_f32_32x32x16_bf16 v[128:143], v[36:39], v[116:119], v[128:143]
    v_mfma_f32_32x32x16_bf16 v[144:159], v[44:47], v[116:119], v[144:159]
    v_cvt_pk_bf16_f32 v120, v80, v81
    v_cvt_pk_bf16_f32 v121, v82, v83
    v_cvt_pk_bf16_f32 v122, v84, v85
    v_cvt_pk_bf16_f32 v123, v86, v87
    v_cvt_pk_bf16_f32 v124, v88, v89
    v_cvt_pk_bf16_f32 v125, v90, v91
    v_cvt_pk_bf16_f32 v126, v92, v93
    v_cvt_pk_bf16_f32 v127, v94, v95
    v_mfma_f32_32x32x16_bf16 v[128:143], v[40:43], v[120:123], v[128:143]
    v_mfma_f32_32x32x16_bf16 v[144:159], v[48:51], v[120:123], v[144:159]
    v_mfma_f32_32x32x16_bf16 v[128:143], v[44:47], v[124:127], v[128:143]
    v_mfma_f32_32x32x16_bf16 v[144:159], v[52:55], v[124:127], v[144:159]
    s_nop 11
    v_cvt_pk_bf16_f32 v160, v128, v144
    ds_write_b32 v26, v160 offset:0
    v_cvt_pk_bf16_f32 v161, v129, v145
    ds_write_b32 v26, v161 offset:128
    v_cvt_pk_bf16_f32 v162, v130, v146
    ds_write_b32 v26, v162 offset:256
    v_cvt_pk_bf16_f32 v163, v131, v147
    ds_write_b32 v26, v163 offset:384
    v_cvt_pk_bf16_f32 v164, v132, v148
    ds_write_b32 v26, v164 offset:1024
    v_cvt_pk_bf16_f32 v165, v133, v149
    ds_write_b32 v26, v165 offset:1152
    v_cvt_pk_bf16_f32 v166, v134, v150
    ds_write_b32 v26, v166 offset:1280
    v_cvt_pk_bf16_f32 v167, v135, v151
    ds_write_b32 v26, v167 offset:1408
    v_cvt_pk_bf16_f32 v168, v136, v152
    ds_write_b32 v26, v168 offset:2048
    v_cvt_pk_bf16_f32 v169, v137, v153
    ds_write_b32 v26, v169 offset:2176
    v_cvt_pk_bf16_f32 v170, v138, v154
    ds_write_b32 v26, v170 offset:2304
    v_cvt_pk_bf16_f32 v171, v139, v155
    ds_write_b32 v26, v171 offset:2432
    v_cvt_pk_bf16_f32 v172, v140, v156
    ds_write_b32 v26, v172 offset:3072
    v_cvt_pk_bf16_f32 v173, v141, v157
    ds_write_b32 v26, v173 offset:3200
    v_cvt_pk_bf16_f32 v174, v142, v158
    ds_write_b32 v26, v174 offset:3328
    v_cvt_pk_bf16_f32 v175, v143, v159
    ds_write_b32 v26, v175 offset:3456
    s_waitcnt lgkmcnt(0)
    s_barrier
    ds_read2st64_b32 v[176:177], v27 offset0:0 offset1:16
    ds_read2st64_b32 v[178:179], v27 offset0:32 offset1:48
    ds_read2st64_b32 v[180:181], v27 offset0:1 offset1:17
    ds_read2st64_b32 v[182:183], v27 offset0:33 offset1:49
    ds_read2st64_b32 v[184:185], v27 offset0:2 offset1:18
    ds_read2st64_b32 v[186:187], v27 offset0:34 offset1:50
    ds_read2st64_b32 v[188:189], v27 offset0:3 offset1:19
    ds_read2st64_b32 v[190:191], v27 offset0:35 offset1:51
    s_waitcnt lgkmcnt(6)
    s_add_u32 s21, s27, 0
    buffer_store_dwordx4 v[176:179], v29, s[4:7], s21 offen sc1
    s_waitcnt lgkmcnt(4)
    s_add_u32 s21, s27, 163840
    buffer_store_dwordx4 v[180:183], v29, s[4:7], s21 offen sc1
    s_waitcnt lgkmcnt(2)
    s_add_u32 s21, s27, 327680
    buffer_store_dwordx4 v[184:187], v29, s[4:7], s21 offen sc1
    s_waitcnt lgkmcnt(0)
    s_add_u32 s21, s27, 491520
    buffer_store_dwordx4 v[188:191], v29, s[4:7], s21 offen sc1
    s_add_u32 m0, s57, 0
    s_add_u32 s65, s58, 49152
    buffer_load_dwordx4 v4, s[4:7], s65 offen sc1 lds
    buffer_load_dwordx4 v4, s[4:7], s65 offen offset:1024 sc1 lds
    buffer_load_dwordx4 v4, s[4:7], s65 offen offset:2048 sc1 lds
    buffer_load_dwordx4 v4, s[4:7], s65 offen offset:3072 sc1 lds
    s_add_u32 m0, s57, 16384
    s_add_u32 s65, s58, 65536
    buffer_load_dwordx4 v4, s[4:7], s65 offen sc1 lds
    buffer_load_dwordx4 v4, s[4:7], s65 offen offset:1024 sc1 lds
    buffer_load_dwordx4 v4, s[4:7], s65 offen offset:2048 sc1 lds
    buffer_load_dwordx4 v4, s[4:7], s65 offen offset:3072 sc1 lds
    s_waitcnt vmcnt(8)
    s_barrier
    s_cmp_lg_u32 s3, 0
    s_cbranch_scc1 Lw_prompt_104
    s_add_u32 s21, s15, 37769216
    s_mov_b64 exec, 1
    buffer_store_dword v31, v30, s[4:7], s21 offen sc1
    s_mov_b64 exec, -1
Lw_prompt_104:
    s_add_u32 m0, s57, 114688
    s_add_u32 s65, s58, 16384
    buffer_load_dwordx4 v4, s[4:7], s65 offen sc1 lds
    buffer_load_dwordx4 v4, s[4:7], s65 offen offset:1024 sc1 lds
    buffer_load_dwordx4 v4, s[4:7], s65 offen offset:2048 sc1 lds
    buffer_load_dwordx4 v4, s[4:7], s65 offen offset:3072 sc1 lds
    s_add_u32 m0, s57, 131072
    s_add_u32 s65, s58, 32768
    buffer_load_dwordx4 v4, s[4:7], s65 offen sc1 lds
    buffer_load_dwordx4 v4, s[4:7], s65 offen offset:1024 sc1 lds
    buffer_load_dwordx4 v4, s[4:7], s65 offen offset:2048 sc1 lds
    buffer_load_dwordx4 v4, s[4:7], s65 offen offset:3072 sc1 lds
    s_add_u32 m0, s57, 32768
    s_add_u32 s65, s58, 81920
    buffer_load_dwordx4 v4, s[4:7], s65 offen sc1 lds
    buffer_load_dwordx4 v4, s[4:7], s65 offen offset:1024 sc1 lds
    buffer_load_dwordx4 v4, s[4:7], s65 offen offset:2048 sc1 lds
    buffer_load_dwordx4 v4, s[4:7], s65 offen offset:3072 sc1 lds
    s_add_u32 m0, s57, 81920
    s_add_u32 s65, s58, 131072
    buffer_load_dwordx4 v4, s[4:7], s65 offen sc1 lds
    buffer_load_dwordx4 v4, s[4:7], s65 offen offset:1024 sc1 lds
    buffer_load_dwordx4 v4, s[4:7], s65 offen offset:2048 sc1 lds
    buffer_load_dwordx4 v4, s[4:7], s65 offen offset:3072 sc1 lds
    s_branch Lp1j_prompt_100
Lnop1_prompt_99:
    s_add_u32 m0, s57, 98304
    s_add_u32 s65, s58, 0
    buffer_load_dwordx4 v4, s[4:7], s65 offen sc1 lds
    buffer_load_dwordx4 v4, s[4:7], s65 offen offset:1024 sc1 lds
    buffer_load_dwordx4 v4, s[4:7], s65 offen offset:2048 sc1 lds
    buffer_load_dwordx4 v4, s[4:7], s65 offen offset:3072 sc1 lds
    s_add_u32 m0, s57, 114688
    s_add_u32 s65, s58, 16384
    buffer_load_dwordx4 v4, s[4:7], s65 offen sc1 lds
    buffer_load_dwordx4 v4, s[4:7], s65 offen offset:1024 sc1 lds
    buffer_load_dwordx4 v4, s[4:7], s65 offen offset:2048 sc1 lds
    buffer_load_dwordx4 v4, s[4:7], s65 offen offset:3072 sc1 lds
    s_add_u32 m0, s57, 131072
    s_add_u32 s65, s58, 32768
    buffer_load_dwordx4 v4, s[4:7], s65 offen sc1 lds
    buffer_load_dwordx4 v4, s[4:7], s65 offen offset:1024 sc1 lds
    buffer_load_dwordx4 v4, s[4:7], s65 offen offset:2048 sc1 lds
    buffer_load_dwordx4 v4, s[4:7], s65 offen offset:3072 sc1 lds
    s_add_u32 m0, s57, 0
    s_add_u32 s65, s58, 49152
    buffer_load_dwordx4 v4, s[4:7], s65 offen sc1 lds
    buffer_load_dwordx4 v4, s[4:7], s65 offen offset:1024 sc1 lds
    buffer_load_dwordx4 v4, s[4:7], s65 offen offset:2048 sc1 lds
    buffer_load_dwordx4 v4, s[4:7], s65 offen offset:3072 sc1 lds
    s_add_u32 m0, s57, 16384
    s_add_u32 s65, s58, 65536
    buffer_load_dwordx4 v4, s[4:7], s65 offen sc1 lds
    buffer_load_dwordx4 v4, s[4:7], s65 offen offset:1024 sc1 lds
    buffer_load_dwordx4 v4, s[4:7], s65 offen offset:2048 sc1 lds
    buffer_load_dwordx4 v4, s[4:7], s65 offen offset:3072 sc1 lds
    s_add_u32 m0, s57, 32768
    s_add_u32 s65, s58, 81920
    buffer_load_dwordx4 v4, s[4:7], s65 offen sc1 lds
    buffer_load_dwordx4 v4, s[4:7], s65 offen offset:1024 sc1 lds
    buffer_load_dwordx4 v4, s[4:7], s65 offen offset:2048 sc1 lds
    buffer_load_dwordx4 v4, s[4:7], s65 offen offset:3072 sc1 lds
    s_add_u32 m0, s57, 81920
    s_add_u32 s65, s58, 131072
    buffer_load_dwordx4 v4, s[4:7], s65 offen sc1 lds
    buffer_load_dwordx4 v4, s[4:7], s65 offen offset:1024 sc1 lds
    buffer_load_dwordx4 v4, s[4:7], s65 offen offset:2048 sc1 lds
    buffer_load_dwordx4 v4, s[4:7], s65 offen offset:3072 sc1 lds
Lp1j_prompt_100:
    s_sub_u32 s23, s17, 10
    s_lshl_b32 s23, s23, 1
    s_add_u32 s23, s23, s3
    s_sub_u32 s23, 39, s23
    s_cmp_ge_u32 s3, 2
    s_cselect_b32 s23, 40, s23
    s_cmp_eq_u32 s17, 15
    s_cselect_b32 s23, 40, s23
    s_sub_u32 s24, 19, s17
    s_cmp_eq_u32 s3, 1
    s_cselect_b32 s22, s24, s17
    s_add_u32 s24, s17, 20
    s_cmp_eq_u32 s3, 2
    s_cselect_b32 s22, s24, s22
    s_cmp_eq_u32 s3, 3
    s_cselect_b32 s22, 40, s22
    s_cmp_ge_u32 s17, 10
    s_cselect_b32 s22, s23, s22
    s_cmp_ge_u32 s22, 40
    s_cbranch_scc1 Lp2l_prompt_106
    s_cmp_ge_u32 s22, 20
    s_cselect_b32 s23, s19, s18
    s_cselect_b32 s24, 20, 0
    s_sub_u32 s24, s22, s24
    s_lshl_b32 s27, s23, 13
    s_add_u32 s27, s27, 6291456
    s_add_u32 s28, s27, 262144
    buffer_load_dwordx4 v[64:67], v4, s[4:7], s27 offen sc1
    buffer_load_dwordx4 v[96:99], v4, s[4:7], s28 offen sc1
    buffer_load_dwordx4 v[68:71], v4, s[4:7], s27 offen offset:1024 sc1
    buffer_load_dwordx4 v[100:103], v4, s[4:7], s28 offen offset:1024 sc1
    buffer_load_dwordx4 v[72:75], v4, s[4:7], s27 offen offset:2048 sc1
    buffer_load_dwordx4 v[104:107], v4, s[4:7], s28 offen offset:2048 sc1
    buffer_load_dwordx4 v[76:79], v4, s[4:7], s27 offen offset:3072 sc1
    buffer_load_dwordx4 v[108:111], v4, s[4:7], s28 offen offset:3072 sc1
    s_add_u32 s21, s27, 4096
    buffer_load_dwordx4 v[80:83], v4, s[4:7], s21 offen sc1
    s_add_u32 s29, s28, 4096
    buffer_load_dwordx4 v[112:115], v4, s[4:7], s29 offen sc1
    buffer_load_dwordx4 v[84:87], v4, s[4:7], s21 offen offset:1024 sc1
    buffer_load_dwordx4 v[116:119], v4, s[4:7], s29 offen offset:1024 sc1
    buffer_load_dwordx4 v[88:91], v4, s[4:7], s21 offen offset:2048 sc1
    buffer_load_dwordx4 v[120:123], v4, s[4:7], s29 offen offset:2048 sc1
    buffer_load_dwordx4 v[92:95], v4, s[4:7], s21 offen offset:3072 sc1
    buffer_load_dwordx4 v[124:127], v4, s[4:7], s29 offen offset:3072 sc1
    s_sub_u32 s25, 32, s23
    s_and_b32 s25, s25, 31
    s_cmp_ge_u32 s24, 10
    s_cselect_b32 s25, s25, s23
    s_cselect_b32 s26, 0x80000000, 0
    s_cselect_b64 s[60:61], -1, 0
    s_lshl_b32 s30, s24, 5
    v_add_u32 v5, s30, v2
    v_sub_u32 v6, 640, v5
    v_cmp_eq_u32 vcc, 320, v6
    s_nop 1
    v_cndmask_b32 v6, v6, 0, vcc
    v_cndmask_b32 v6, v5, v6, s[60:61]
    v_lshlrev_b32 v6, 4, v6
    v_mul_u32_u24 v7, 5120, v3
    v_add_u32 v6, v6, v7
    v_cmp_eq_u32 vcc, 0, v5
    v_mov_b32 v7, 0x7ff00000
    s_nop 0
    v_cndmask_b32 v6, v6, v7, vcc
    s_mul_i32 s25, s25, 81920
    s_add_u32 s25, s25, 10485760
    s_mul_i32 s62, s23, 40960
    s_lshl_b32 s31, s24, 10
    s_add_u32 s62, s62, s31
    v_bfe_u32 v10, v1, 4, 1
    v_mul_u32_u24 v10, 20480, v10
    v_and_b32 v11, 15, v1
    v_lshl_add_u32 v10, v11, 4, v10
    v_lshl_add_u32 v10, v3, 8, v10
    s_add_u32 s62, s62, 13631488
    s_add_u32 s63, s62, 1310720
    s_mul_i32 s28, s23, 5120
    s_lshl_b32 s27, s24, 8
    s_add_u32 s28, s28, s27
    s_add_u32 s28, s28, 36569088
    v_mul_u32_u24 v7, 163840, v3
    v_lshl_add_u32 v7, v2, 3, v7
    s_mov_b32 s27, 0x3f803f80
Lp2l_prompt_106:
    s_cmp_lg_u32 s3, 3
    s_cbranch_scc1 Lw_prompt_108
    s_sub_u32 s21, s17, 10
    s_lshl_b32 s21, s21, 1
    s_cmp_lt_u32 s17, 10
    s_cselect_b32 s21, s17, s21
    s_lshl_b32 s21, s21, 4
    v_add_u32 v29, s21, v1
    v_subrev_u32 v28, 160, v29
    v_min_u32 v29, v29, v28
    v_lshlrev_b32 v29, 7, v29
    s_mov_b32 s21, 37769216
    s_mov_b32 exec_hi, 0xffff
    s_mov_b32 s66, 0
Lp_prompt_109:
    buffer_load_dword v0, v29, s[4:7], s21 offen sc1
    s_add_u32 s66, s66, 1
    s_waitcnt vmcnt(0)
    v_cmp_gt_u32 vcc, 1, v0
    s_cbranch_vccz Lq_prompt_107
    s_cmp_lt_u32 s66, 0x40000
    s_cbranch_scc0 Lq_prompt_107
    s_sleep 4
    s_branch Lp_prompt_109
Lq_prompt_107:
    s_mov_b64 exec, -1
Lw_prompt_108:
    s_barrier
    s_cmp_lt_u32 s22, 40
    s_cbranch_scc1 Lw4_prompt_110
    s_branch Lp2r_prompt_105
Lw4_prompt_110:
    s_add_u32 s30, s25, 0
    buffer_load_dwordx4 v[32:35], v6, s[4:7], s30 offen sc1
    s_add_u32 s30, s25, 10240
    buffer_load_dwordx4 v[36:39], v6, s[4:7], s30 offen sc1
    s_add_u32 s30, s25, 20480
    buffer_load_dwordx4 v[40:43], v6, s[4:7], s30 offen sc1
    s_add_u32 s30, s25, 30720
    buffer_load_dwordx4 v[44:47], v6, s[4:7], s30 offen sc1
    s_add_u32 s30, s25, 40960
    buffer_load_dwordx4 v[48:51], v6, s[4:7], s30 offen sc1
    s_add_u32 s30, s25, 51200
    buffer_load_dwordx4 v[52:55], v6, s[4:7], s30 offen sc1
    s_add_u32 s30, s25, 61440
    buffer_load_dwordx4 v[56:59], v6, s[4:7], s30 offen sc1
    s_add_u32 s30, s25, 71680
    buffer_load_dwordx4 v[60:63], v6, s[4:7], s30 offen sc1
    s_mul_i32 s30, s23, 40960
    s_lshl_b32 s31, s24, 11
    s_add_u32 s30, s30, s31
    s_add_u32 s30, s30, 32505856
    s_add_u32 s31, s30, 1310720
    buffer_load_dwordx4 v[128:131], v4, s[4:7], s30 offen offset:0 sc1
    buffer_load_dwordx4 v[132:135], v4, s[4:7], s30 offen offset:1024 sc1
    buffer_load_dwordx4 v[136:139], v4, s[4:7], s31 offen offset:0 sc1
    buffer_load_dwordx4 v[140:143], v4, s[4:7], s31 offen offset:1024 sc1
    v_mov_b32 v12, 0
    v_mov_b32 v13, 0
    v_mov_b32 v14, 0
    v_mov_b32 v15, 0
    s_waitcnt vmcnt(11)
    v_xor_b32 v32, s26, v32
    v_xor_b32 v33, s26, v33
    v_xor_b32 v34, s26, v34
    v_xor_b32 v35, s26, v35
    s_nop 1
    v_mfma_f32_32x32x16_bf16 v[160:175], v[32:35], v[64:67], 0
    v_mfma_f32_32x32x16_bf16 v[176:191], v[32:35], v[96:99], 0
    s_waitcnt vmcnt(10)
    v_xor_b32 v36, s26, v36
    v_xor_b32 v37, s26, v37
    v_xor_b32 v38, s26, v38
    v_xor_b32 v39, s26, v39
    s_nop 1
    v_mfma_f32_32x32x16_bf16 v[160:175], v[36:39], v[68:71], v[160:175]
    v_mfma_f32_32x32x16_bf16 v[176:191], v[36:39], v[100:103], v[176:191]
    s_waitcnt vmcnt(9)
    v_xor_b32 v40, s26, v40
    v_xor_b32 v41, s26, v41
    v_xor_b32 v42, s26, v42
    v_xor_b32 v43, s26, v43
    s_nop 1
    v_mfma_f32_32x32x16_bf16 v[160:175], v[40:43], v[72:75], v[160:175]
    v_mfma_f32_32x32x16_bf16 v[176:191], v[40:43], v[104:107], v[176:191]
    s_waitcnt vmcnt(8)
    v_xor_b32 v44, s26, v44
    v_xor_b32 v45, s26, v45
    v_xor_b32 v46, s26, v46
    v_xor_b32 v47, s26, v47
    s_nop 1
    v_mfma_f32_32x32x16_bf16 v[160:175], v[44:47], v[76:79], v[160:175]
    v_mfma_f32_32x32x16_bf16 v[176:191], v[44:47], v[108:111], v[176:191]
    s_waitcnt vmcnt(7)
    v_xor_b32 v48, s26, v48
    v_xor_b32 v49, s26, v49
    v_xor_b32 v50, s26, v50
    v_xor_b32 v51, s26, v51
    s_nop 1
    v_mfma_f32_32x32x16_bf16 v[160:175], v[48:51], v[80:83], v[160:175]
    v_mfma_f32_32x32x16_bf16 v[176:191], v[48:51], v[112:115], v[176:191]
    s_waitcnt vmcnt(6)
    v_xor_b32 v52, s26, v52
    v_xor_b32 v53, s26, v53
    v_xor_b32 v54, s26, v54
    v_xor_b32 v55, s26, v55
    s_nop 1
    v_mfma_f32_32x32x16_bf16 v[160:175], v[52:55], v[84:87], v[160:175]
    v_mfma_f32_32x32x16_bf16 v[176:191], v[52:55], v[116:119], v[176:191]
    s_waitcnt vmcnt(0)
    v_permlane32_swap_b32 v128, v130
    v_permlane32_swap_b32 v129, v131
    v_permlane32_swap_b32 v132, v134
    v_permlane32_swap_b32 v133, v135
    v_permlane32_swap_b32 v136, v138
    v_permlane32_swap_b32 v137, v139
    v_permlane32_swap_b32 v140, v142
    v_permlane32_swap_b32 v141, v143
    v_lshlrev_b32 v192, 16, v128
    v_and_b32 v193, 0xffff0000, v128
    v_lshlrev_b32 v194, 16, v129
    v_and_b32 v195, 0xffff0000, v129
    v_lshlrev_b32 v196, 16, v130
    v_and_b32 v197, 0xffff0000, v130
    v_lshlrev_b32 v198, 16, v131
    v_and_b32 v199, 0xffff0000, v131
    v_lshlrev_b32 v200, 16, v132
    v_and_b32 v201, 0xffff0000, v132
    v_lshlrev_b32 v202, 16, v133
    v_and_b32 v203, 0xffff0000, v133
    v_lshlrev_b32 v204, 16, v134
    v_and_b32 v205, 0xffff0000, v134
    v_lshlrev_b32 v206, 16, v135
    v_and_b32 v207, 0xffff0000, v135
    v_lshlrev_b32 v208, 16, v136
    v_and_b32 v209, 0xffff0000, v136
    v_lshlrev_b32 v210, 16, v137
    v_and_b32 v211, 0xffff0000, v137
    v_lshlrev_b32 v212, 16, v138
    v_and_b32 v213, 0xffff0000, v138
    v_lshlrev_b32 v214, 16, v139
    v_and_b32 v215, 0xffff0000, v139
    v_lshlrev_b32 v216, 16, v140
    v_and_b32 v217, 0xffff0000, v140
    v_lshlrev_b32 v218, 16, v141
    v_and_b32 v219, 0xffff0000, v141
    v_lshlrev_b32 v220, 16, v142
    v_and_b32 v221, 0xffff0000, v142
    v_lshlrev_b32 v222, 16, v143
    v_and_b32 v223, 0xffff0000, v143
    v_xor_b32 v56, s26, v56
    v_xor_b32 v57, s26, v57
    v_xor_b32 v58, s26, v58
    v_xor_b32 v59, s26, v59
    s_nop 1
    v_mfma_f32_32x32x16_bf16 v[160:175], v[56:59], v[88:91], v[160:175]
    v_mfma_f32_32x32x16_bf16 v[176:191], v[56:59], v[120:123], v[176:191]
    v_xor_b32 v60, s26, v60
    v_xor_b32 v61, s26, v61
    v_xor_b32 v62, s26, v62
    v_xor_b32 v63, s26, v63
    s_nop 1
    v_mfma_f32_32x32x16_bf16 v[160:175], v[60:63], v[92:95], v[160:175]
    v_mfma_f32_32x32x16_bf16 v[176:191], v[60:63], v[124:127], v[176:191]
    s_nop 10
    v_pk_add_f32 v[192:193], v[192:193], v[160:161]
    v_pk_add_f32 v[194:195], v[194:195], v[162:163]
    v_pk_add_f32 v[196:197], v[196:197], v[164:165]
    v_pk_add_f32 v[198:199], v[198:199], v[166:167]
    v_cvt_pk_bf16_f32 v128, v192, v193
    v_cvt_pk_bf16_f32 v129, v194, v195
    v_cvt_pk_bf16_f32 v130, v196, v197
    v_cvt_pk_bf16_f32 v131, v198, v199
    buffer_store_dwordx4 v[128:131], v10, s[4:7], s62 offen offset:0 sc1
    v_pk_add_f32 v[200:201], v[200:201], v[168:169]
    v_pk_add_f32 v[202:203], v[202:203], v[170:171]
    v_pk_add_f32 v[204:205], v[204:205], v[172:173]
    v_pk_add_f32 v[206:207], v[206:207], v[174:175]
    v_cvt_pk_bf16_f32 v132, v200, v201
    v_cvt_pk_bf16_f32 v133, v202, v203
    v_cvt_pk_bf16_f32 v134, v204, v205
    v_cvt_pk_bf16_f32 v135, v206, v207
    buffer_store_dwordx4 v[132:135], v10, s[4:7], s62 offen offset:512 sc1
    v_pk_add_f32 v[208:209], v[208:209], v[176:177]
    v_pk_add_f32 v[210:211], v[210:211], v[178:179]
    v_pk_add_f32 v[212:213], v[212:213], v[180:181]
    v_pk_add_f32 v[214:215], v[214:215], v[182:183]
    v_cvt_pk_bf16_f32 v136, v208, v209
    v_cvt_pk_bf16_f32 v137, v210, v211
    v_cvt_pk_bf16_f32 v138, v212, v213
    v_cvt_pk_bf16_f32 v139, v214, v215
    buffer_store_dwordx4 v[136:139], v10, s[4:7], s63 offen offset:0 sc1
    v_pk_add_f32 v[216:217], v[216:217], v[184:185]
    v_pk_add_f32 v[218:219], v[218:219], v[186:187]
    v_pk_add_f32 v[220:221], v[220:221], v[188:189]
    v_pk_add_f32 v[222:223], v[222:223], v[190:191]
    v_cvt_pk_bf16_f32 v140, v216, v217
    v_cvt_pk_bf16_f32 v141, v218, v219
    v_cvt_pk_bf16_f32 v142, v220, v221
    v_cvt_pk_bf16_f32 v143, v222, v223
    buffer_store_dwordx4 v[140:143], v10, s[4:7], s63 offen offset:512 sc1
    v_dot2c_f32_bf16 v12, s27, v128
    v_dot2c_f32_bf16 v13, v128, v128
    v_dot2c_f32_bf16 v12, s27, v129
    v_dot2c_f32_bf16 v13, v129, v129
    v_dot2c_f32_bf16 v12, s27, v130
    v_dot2c_f32_bf16 v13, v130, v130
    v_dot2c_f32_bf16 v12, s27, v131
    v_dot2c_f32_bf16 v13, v131, v131
    v_dot2c_f32_bf16 v12, s27, v132
    v_dot2c_f32_bf16 v13, v132, v132
    v_dot2c_f32_bf16 v12, s27, v133
    v_dot2c_f32_bf16 v13, v133, v133
    v_dot2c_f32_bf16 v12, s27, v134
    v_dot2c_f32_bf16 v13, v134, v134
    v_dot2c_f32_bf16 v12, s27, v135
    v_dot2c_f32_bf16 v13, v135, v135
    v_dot2c_f32_bf16 v14, s27, v136
    v_dot2c_f32_bf16 v15, v136, v136
    v_dot2c_f32_bf16 v14, s27, v137
    v_dot2c_f32_bf16 v15, v137, v137
    v_dot2c_f32_bf16 v14, s27, v138
    v_dot2c_f32_bf16 v15, v138, v138
    v_dot2c_f32_bf16 v14, s27, v139
    v_dot2c_f32_bf16 v15, v139, v139
    v_dot2c_f32_bf16 v14, s27, v140
    v_dot2c_f32_bf16 v15, v140, v140
    v_dot2c_f32_bf16 v14, s27, v141
    v_dot2c_f32_bf16 v15, v141, v141
    v_dot2c_f32_bf16 v14, s27, v142
    v_dot2c_f32_bf16 v15, v142, v142
    v_dot2c_f32_bf16 v14, s27, v143
    v_dot2c_f32_bf16 v15, v143, v143
    s_nop 1
    v_permlane32_swap_b32 v12, v14
    v_permlane32_swap_b32 v13, v15
    v_add_f32 v12, v12, v14
    v_add_f32 v13, v13, v15
    buffer_store_dwordx2 v[12:13], v7, s[4:7], s28 offen sc1
Lp2r_prompt_105:
    s_waitcnt vmcnt(0)
Lp2r_prompt_105b:
    s_barrier
    s_cmp_lg_u32 s3, 0
    s_cbranch_scc1 Lw_prompt_111
    s_add_u32 s21, s64, 35651712
    s_mov_b64 exec, 1
    buffer_atomic_add v31, v30, s[4:7], s21 offen sc1
    s_mov_b64 exec, -1
Lw_prompt_111:
    s_cmp_lg_u32 s3, 3
    s_cbranch_scc1 Lw_prompt_113
    s_add_u32 s21, s64, 35651712
    v_lshlrev_b32 v29, 7, v1
    s_mov_b64 exec, 1
    s_mov_b32 s66, 0
Lp_prompt_114:
    buffer_load_dword v0, v29, s[4:7], s21 offen sc1
    s_add_u32 s66, s66, 1
    s_waitcnt vmcnt(0)
    v_cmp_gt_u32 vcc, 16, v0
    s_cbranch_vccz Lq_prompt_112
    s_cmp_lt_u32 s66, 0x40000
    s_cbranch_scc0 Lq_prompt_112
    s_sleep 4
    s_branch Lp_prompt_114
Lq_prompt_112:
    s_mov_b64 exec, -1
Lw_prompt_113:
    s_barrier
    s_mul_i32 s22, s20, 40960
    s_add_u32 s22, s22, 13631488
    s_add_u32 s23, s22, 20480
    buffer_load_dwordx4 v[96:99], v4, s[4:7], s22 offen sc1
    buffer_load_dwordx4 v[100:103], v4, s[4:7], s23 offen sc1
    buffer_load_dwordx4 v[104:107], v4, s[4:7], s22 offen offset:1024 sc1
    buffer_load_dwordx4 v[108:111], v4, s[4:7], s23 offen offset:1024 sc1
    v_add_u32 v5, 0x10000, v4
    v_add_u32 v6, 0x20000, v4
    ds_read_b128 a[240:243], v5 offset:32768
    ds_read_b128 a[244:247], v5 offset:33792
    ds_read_b128 a[248:251], v5 offset:34816
    ds_read_b128 a[252:255], v5 offset:35840
    buffer_load_dwordx4 v[112:115], v4, s[4:7], s22 offen offset:2048 sc1
    buffer_load_dwordx4 v[116:119], v4, s[4:7], s23 offen offset:2048 sc1
    buffer_load_dwordx4 v[120:123], v4, s[4:7], s22 offen offset:3072 sc1
    buffer_load_dwordx4 v[124:127], v4, s[4:7], s23 offen offset:3072 sc1
    s_add_u32 s12, s22, 4096
    buffer_load_dwordx4 v[128:131], v4, s[4:7], s12 offen sc1
    s_add_u32 s13, s23, 4096
    buffer_load_dwordx4 v[132:135], v4, s[4:7], s13 offen sc1
    buffer_load_dwordx4 v[136:139], v4, s[4:7], s12 offen offset:1024 sc1
    buffer_load_dwordx4 v[140:143], v4, s[4:7], s13 offen offset:1024 sc1
    s_mul_i32 s28, s20, 5120
    s_add_u32 s28, s28, 36569088
    v_lshrrev_b32 v28, 4, v1
    v_and_b32 v29, 15, v1
    v_lshlrev_b32 v29, 3, v29
    v_lshl_add_u32 v29, v28, 8, v29
    s_waitcnt vmcnt(10)
    s_waitcnt lgkmcnt(2)
    v_mfma_f32_16x16x32_bf16 v[32:35], a[240:243], v[96:99], 0
    ds_read_b128 v[8:11], v5 offset:36864
    s_mul_i32 s27, s20, 98304
    s_mul_i32 s25, s17, 3072
    v_mfma_f32_16x16x32_bf16 v[40:43], a[240:243], v[100:103], 0
    buffer_load_dwordx4 v[144:147], v4, s[4:7], s12 offen offset:2048 sc1
    s_add_u32 s27, s27, s25
    v_mfma_f32_16x16x32_bf16 v[36:39], a[244:247], v[96:99], 0
    ds_read_b128 v[12:15], v5 offset:37888
    s_add_u32 s27, s27, 19922944
    s_add_u32 s15, s27, 49152
    v_mfma_f32_16x16x32_bf16 v[44:47], a[244:247], v[100:103], 0
    s_and_b32 s25, s17, 1
    s_cmp_eq_u32 s25, 0
    s_cselect_b32 s24, s18, s19
    s_waitcnt lgkmcnt(2)
    v_mfma_f32_16x16x32_bf16 v[48:51], a[248:251], v[96:99], 0
    ds_read_b128 a[240:243], v5 offset:38912
    s_mul_i32 s26, s24, 98304
    s_mul_i32 s25, s3, 12288
    v_mfma_f32_16x16x32_bf16 v[56:59], a[248:251], v[100:103], 0
    buffer_load_dwordx4 v[148:151], v4, s[4:7], s13 offen offset:2048 sc1
    s_add_u32 s26, s26, s25
    v_mfma_f32_16x16x32_bf16 v[52:55], a[252:255], v[96:99], 0
    ds_read_b128 a[244:247], v5 offset:39936
    s_add_u32 s26, s26, 19922944
    s_xor_b32 s60, s3, 0
    v_mfma_f32_16x16x32_bf16 v[60:63], a[252:255], v[100:103], 0
    s_lshr_b32 s25, s60, 1
    s_lshl_b32 s25, s25, 6
    s_waitcnt lgkmcnt(2)
    v_mfma_f32_16x16x32_bf16 v[64:67], v[8:11], v[96:99], 0
    ds_read_b128 a[248:251], v5 offset:40960
    s_and_b32 s60, s60, 1
    s_add_u32 s60, s60, s25
    v_mfma_f32_16x16x32_bf16 v[72:75], v[8:11], v[100:103], 0
    buffer_load_dwordx4 v[152:155], v4, s[4:7], s12 offen offset:3072 sc1
    s_mul_i32 s60, s60, 49152
    v_mfma_f32_16x16x32_bf16 v[68:71], v[12:15], v[96:99], 0
    ds_read_b128 a[252:255], v5 offset:41984
    s_add_u32 s60, s60, s26
    s_xor_b32 s61, s3, 1
    v_mfma_f32_16x16x32_bf16 v[76:79], v[12:15], v[100:103], 0
    s_lshr_b32 s25, s61, 1
    s_lshl_b32 s25, s25, 6
    s_waitcnt lgkmcnt(2)
    v_mfma_f32_16x16x32_bf16 v[80:83], a[240:243], v[96:99], 0
    ds_read_b128 v[8:11], v5 offset:43008
    s_and_b32 s61, s61, 1
    s_add_u32 s61, s61, s25
    v_mfma_f32_16x16x32_bf16 v[88:91], a[240:243], v[100:103], 0
    buffer_load_dwordx4 v[156:159], v4, s[4:7], s13 offen offset:3072 sc1
    s_mul_i32 s61, s61, 49152
    v_mfma_f32_16x16x32_bf16 v[84:87], a[244:247], v[96:99], 0
    ds_read_b128 v[12:15], v5 offset:44032
    s_add_u32 s61, s61, s26
    s_xor_b32 s62, s3, 2
    v_mfma_f32_16x16x32_bf16 v[92:95], a[244:247], v[100:103], 0
    s_lshr_b32 s25, s62, 1
    s_lshl_b32 s25, s25, 6
    s_waitcnt vmcnt(12)
    s_waitcnt lgkmcnt(2)
    v_mfma_f32_16x16x32_bf16 v[32:35], a[248:251], v[104:107], v[32:35]
    ds_read_b128 a[240:243], v5 offset:45056
    s_and_b32 s62, s62, 1
    s_add_u32 s62, s62, s25
    v_mfma_f32_16x16x32_bf16 v[40:43], a[248:251], v[108:111], v[40:43]
    buffer_load_dwordx2 v[236:237], v29, s[4:7], s28 offen sc1
    s_mul_i32 s62, s62, 49152
    s_add_u32 s62, s62, s26
    v_mfma_f32_16x16x32_bf16 v[36:39], a[252:255], v[104:107], v[36:39]
    ds_read_b128 a[244:247], v5 offset:46080
    s_xor_b32 s63, s3, 3
    s_lshr_b32 s25, s63, 1
    v_mfma_f32_16x16x32_bf16 v[44:47], a[252:255], v[108:111], v[44:47]
    s_lshl_b32 s25, s25, 6
    s_and_b32 s63, s63, 1
    s_waitcnt lgkmcnt(2)
    v_mfma_f32_16x16x32_bf16 v[48:51], v[8:11], v[104:107], v[48:51]
    ds_read_b128 a[248:251], v5 offset:47104
    s_add_u32 s63, s63, s25
    s_mul_i32 s63, s63, 49152
    v_mfma_f32_16x16x32_bf16 v[56:59], v[8:11], v[108:111], v[56:59]
    buffer_load_dwordx2 v[238:239], v29, s[4:7], s28 offen offset:1024 sc1
    s_add_u32 s63, s63, s26
    v_mfma_f32_16x16x32_bf16 v[52:55], v[12:15], v[104:107], v[52:55]
    ds_read_b128 a[252:255], v5 offset:48128
    v_mfma_f32_16x16x32_bf16 v[60:63], v[12:15], v[108:111], v[60:63]
    s_waitcnt lgkmcnt(2)
    v_mfma_f32_16x16x32_bf16 v[64:67], a[240:243], v[104:107], v[64:67]
    ds_read_b128 v[8:11], v5 offset:49152
    v_mfma_f32_16x16x32_bf16 v[72:75], a[240:243], v[108:111], v[72:75]
    buffer_load_dwordx2 v[240:241], v29, s[4:7], s28 offen offset:2048 sc1
    v_mfma_f32_16x16x32_bf16 v[68:71], a[244:247], v[104:107], v[68:71]
    ds_read_b128 v[12:15], v5 offset:50176
    v_mfma_f32_16x16x32_bf16 v[76:79], a[244:247], v[108:111], v[76:79]
    s_waitcnt lgkmcnt(2)
    v_mfma_f32_16x16x32_bf16 v[80:83], a[248:251], v[104:107], v[80:83]
    ds_read_b128 a[240:243], v5 offset:51200
    v_mfma_f32_16x16x32_bf16 v[88:91], a[248:251], v[108:111], v[88:91]
    buffer_load_dwordx2 v[242:243], v29, s[4:7], s28 offen offset:3072 sc1
    v_mfma_f32_16x16x32_bf16 v[84:87], a[252:255], v[104:107], v[84:87]
    ds_read_b128 a[244:247], v5 offset:52224
    v_mfma_f32_16x16x32_bf16 v[92:95], a[252:255], v[108:111], v[92:95]
    s_waitcnt vmcnt(14)
    s_waitcnt lgkmcnt(2)
    v_mfma_f32_16x16x32_bf16 v[32:35], v[8:11], v[112:115], v[32:35]
    ds_read_b128 a[248:251], v5 offset:53248
    v_mfma_f32_16x16x32_bf16 v[40:43], v[8:11], v[116:119], v[40:43]
    s_add_u32 s29, s28, 4096
    buffer_load_dwordx2 v[244:245], v29, s[4:7], s29 offen sc1
    v_mfma_f32_16x16x32_bf16 v[36:39], v[12:15], v[112:115], v[36:39]
    ds_read_b128 a[252:255], v5 offset:54272
    v_mfma_f32_16x16x32_bf16 v[44:47], v[12:15], v[116:119], v[44:47]
    s_waitcnt lgkmcnt(2)
    v_mfma_f32_16x16x32_bf16 v[48:51], a[240:243], v[112:115], v[48:51]
    ds_read_b128 v[8:11], v5 offset:55296
    v_mfma_f32_16x16x32_bf16 v[56:59], a[240:243], v[116:119], v[56:59]
    buffer_load_dwordx2 v[246:247], v29, s[4:7], s28 offen offset:128 sc1
    v_mfma_f32_16x16x32_bf16 v[52:55], a[244:247], v[112:115], v[52:55]
    ds_read_b128 v[12:15], v5 offset:56320
    v_mfma_f32_16x16x32_bf16 v[60:63], a[244:247], v[116:119], v[60:63]
    s_waitcnt lgkmcnt(2)
    v_mfma_f32_16x16x32_bf16 v[64:67], a[248:251], v[112:115], v[64:67]
    ds_read_b128 a[240:243], v5 offset:57344
    v_mfma_f32_16x16x32_bf16 v[72:75], a[248:251], v[116:119], v[72:75]
    buffer_load_dwordx2 v[248:249], v29, s[4:7], s28 offen offset:1152 sc1
    v_mfma_f32_16x16x32_bf16 v[68:71], a[252:255], v[112:115], v[68:71]
    ds_read_b128 a[244:247], v5 offset:58368
    v_mfma_f32_16x16x32_bf16 v[76:79], a[252:255], v[116:119], v[76:79]
    s_waitcnt lgkmcnt(2)
    v_mfma_f32_16x16x32_bf16 v[80:83], v[8:11], v[112:115], v[80:83]
    ds_read_b128 a[248:251], v5 offset:59392
    v_mfma_f32_16x16x32_bf16 v[88:91], v[8:11], v[116:119], v[88:91]
    buffer_load_dwordx2 v[250:251], v29, s[4:7], s28 offen offset:2176 sc1
    v_mfma_f32_16x16x32_bf16 v[84:87], v[12:15], v[112:115], v[84:87]
    ds_read_b128 a[252:255], v5 offset:60416
    v_mfma_f32_16x16x32_bf16 v[92:95], v[12:15], v[116:119], v[92:95]
    s_waitcnt vmcnt(16)
    s_waitcnt lgkmcnt(2)
    v_mfma_f32_16x16x32_bf16 v[32:35], a[240:243], v[120:123], v[32:35]
    ds_read_b128 v[8:11], v5 offset:61440
    v_mfma_f32_16x16x32_bf16 v[40:43], a[240:243], v[124:127], v[40:43]
    buffer_load_dwordx2 v[252:253], v29, s[4:7], s28 offen offset:3200 sc1
    v_mfma_f32_16x16x32_bf16 v[36:39], a[244:247], v[120:123], v[36:39]
    ds_read_b128 v[12:15], v5 offset:62464
    v_mfma_f32_16x16x32_bf16 v[44:47], a[244:247], v[124:127], v[44:47]
    s_waitcnt lgkmcnt(2)
    v_mfma_f32_16x16x32_bf16 v[48:51], a[248:251], v[120:123], v[48:51]
    ds_read_b128 a[240:243], v5 offset:63488
    v_mfma_f32_16x16x32_bf16 v[56:59], a[248:251], v[124:127], v[56:59]
    buffer_load_dwordx2 v[254:255], v29, s[4:7], s29 offen offset:128 sc1
    v_mfma_f32_16x16x32_bf16 v[52:55], a[252:255], v[120:123], v[52:55]
    ds_read_b128 a[244:247], v5 offset:64512
    v_mfma_f32_16x16x32_bf16 v[60:63], a[252:255], v[124:127], v[60:63]
    s_waitcnt lgkmcnt(2)
    v_mfma_f32_16x16x32_bf16 v[64:67], v[8:11], v[120:123], v[64:67]
    ds_read_b128 a[248:251], v6 offset:0
    v_mfma_f32_16x16x32_bf16 v[72:75], v[8:11], v[124:127], v[72:75]
    s_add_u32 s12, s22, 8192
    buffer_load_dwordx4 v[160:163], v4, s[4:7], s12 offen sc1
    v_mfma_f32_16x16x32_bf16 v[68:71], v[12:15], v[120:123], v[68:71]
    ds_read_b128 a[252:255], v6 offset:1024
    v_mfma_f32_16x16x32_bf16 v[76:79], v[12:15], v[124:127], v[76:79]
    s_waitcnt lgkmcnt(2)
    v_mfma_f32_16x16x32_bf16 v[80:83], a[240:243], v[120:123], v[80:83]
    ds_read_b128 v[8:11], v6 offset:2048
    v_mfma_f32_16x16x32_bf16 v[88:91], a[240:243], v[124:127], v[88:91]
    s_add_u32 s13, s23, 8192
    buffer_load_dwordx4 v[164:167], v4, s[4:7], s13 offen sc1
    v_mfma_f32_16x16x32_bf16 v[84:87], a[244:247], v[120:123], v[84:87]
    ds_read_b128 v[12:15], v6 offset:3072
    v_mfma_f32_16x16x32_bf16 v[92:95], a[244:247], v[124:127], v[92:95]
    s_waitcnt vmcnt(18)
    s_waitcnt lgkmcnt(2)
    v_mfma_f32_16x16x32_bf16 v[32:35], a[248:251], v[128:131], v[32:35]
    ds_read_b128 a[240:243], v6 offset:4096
    v_mfma_f32_16x16x32_bf16 v[40:43], a[248:251], v[132:135], v[40:43]
    buffer_load_dwordx4 v[168:171], v4, s[4:7], s12 offen offset:1024 sc1
    v_mfma_f32_16x16x32_bf16 v[36:39], a[252:255], v[128:131], v[36:39]
    ds_read_b128 a[244:247], v6 offset:5120
    v_mfma_f32_16x16x32_bf16 v[44:47], a[252:255], v[132:135], v[44:47]
    s_waitcnt lgkmcnt(2)
    v_mfma_f32_16x16x32_bf16 v[48:51], v[8:11], v[128:131], v[48:51]
    ds_read_b128 a[248:251], v6 offset:6144
    v_mfma_f32_16x16x32_bf16 v[56:59], v[8:11], v[132:135], v[56:59]
    buffer_load_dwordx4 v[172:175], v4, s[4:7], s13 offen offset:1024 sc1
    v_mfma_f32_16x16x32_bf16 v[52:55], v[12:15], v[128:131], v[52:55]
    ds_read_b128 a[252:255], v6 offset:7168
    v_mfma_f32_16x16x32_bf16 v[60:63], v[12:15], v[132:135], v[60:63]
    s_waitcnt lgkmcnt(2)
    v_mfma_f32_16x16x32_bf16 v[64:67], a[240:243], v[128:131], v[64:67]
    ds_read_b128 v[8:11], v6 offset:8192
    v_mfma_f32_16x16x32_bf16 v[72:75], a[240:243], v[132:135], v[72:75]
    buffer_load_dwordx4 v[176:179], v4, s[4:7], s12 offen offset:2048 sc1
    v_mfma_f32_16x16x32_bf16 v[68:71], a[244:247], v[128:131], v[68:71]
    ds_read_b128 v[12:15], v6 offset:9216
    v_mfma_f32_16x16x32_bf16 v[76:79], a[244:247], v[132:135], v[76:79]
    s_waitcnt lgkmcnt(2)
    v_mfma_f32_16x16x32_bf16 v[80:83], a[248:251], v[128:131], v[80:83]
    ds_read_b128 a[240:243], v6 offset:10240
    v_mfma_f32_16x16x32_bf16 v[88:91], a[248:251], v[132:135], v[88:91]
    buffer_load_dwordx4 v[180:183], v4, s[4:7], s13 offen offset:2048 sc1
    v_mfma_f32_16x16x32_bf16 v[84:87], a[252:255], v[128:131], v[84:87]
    ds_read_b128 a[244:247], v6 offset:11264
    v_mfma_f32_16x16x32_bf16 v[92:95], a[252:255], v[132:135], v[92:95]
    s_waitcnt vmcnt(20)
    s_waitcnt lgkmcnt(2)
    v_mfma_f32_16x16x32_bf16 v[32:35], v[8:11], v[136:139], v[32:35]
    ds_read_b128 a[248:251], v6 offset:12288
    v_mfma_f32_16x16x32_bf16 v[40:43], v[8:11], v[140:143], v[40:43]
    buffer_load_dwordx4 v[184:187], v4, s[4:7], s12 offen offset:3072 sc1
    v_mfma_f32_16x16x32_bf16 v[36:39], v[12:15], v[136:139], v[36:39]
    ds_read_b128 a[252:255], v6 offset:13312
    v_mfma_f32_16x16x32_bf16 v[44:47], v[12:15], v[140:143], v[44:47]
    s_waitcnt lgkmcnt(2)
    v_mfma_f32_16x16x32_bf16 v[48:51], a[240:243], v[136:139], v[48:51]
    ds_read_b128 v[8:11], v6 offset:14336
    v_mfma_f32_16x16x32_bf16 v[56:59], a[240:243], v[140:143], v[56:59]
    buffer_load_dwordx4 v[188:191], v4, s[4:7], s13 offen offset:3072 sc1
    v_mfma_f32_16x16x32_bf16 v[52:55], a[244:247], v[136:139], v[52:55]
    ds_read_b128 v[12:15], v6 offset:15360
    v_mfma_f32_16x16x32_bf16 v[60:63], a[244:247], v[140:143], v[60:63]
    s_waitcnt lgkmcnt(2)
    v_mfma_f32_16x16x32_bf16 v[64:67], a[248:251], v[136:139], v[64:67]
    ds_read_b128 a[240:243], v4 offset:0
    v_mfma_f32_16x16x32_bf16 v[72:75], a[248:251], v[140:143], v[72:75]
    s_add_u32 s12, s22, 12288
    buffer_load_dwordx4 v[192:195], v4, s[4:7], s12 offen sc1
    v_mfma_f32_16x16x32_bf16 v[68:71], a[252:255], v[136:139], v[68:71]
    ds_read_b128 a[244:247], v4 offset:1024
    v_mfma_f32_16x16x32_bf16 v[76:79], a[252:255], v[140:143], v[76:79]
    s_waitcnt lgkmcnt(2)
    v_mfma_f32_16x16x32_bf16 v[80:83], v[8:11], v[136:139], v[80:83]
    ds_read_b128 a[248:251], v4 offset:2048
    v_mfma_f32_16x16x32_bf16 v[88:91], v[8:11], v[140:143], v[88:91]
    s_add_u32 s13, s23, 12288
    buffer_load_dwordx4 v[196:199], v4, s[4:7], s13 offen sc1
    v_mfma_f32_16x16x32_bf16 v[84:87], v[12:15], v[136:139], v[84:87]
    ds_read_b128 a[252:255], v4 offset:3072
    v_mfma_f32_16x16x32_bf16 v[92:95], v[12:15], v[140:143], v[92:95]
    s_waitcnt vmcnt(22)
    s_waitcnt lgkmcnt(2)
    v_mfma_f32_16x16x32_bf16 v[32:35], a[240:243], v[144:147], v[32:35]
    ds_read_b128 v[8:11], v4 offset:4096
    v_mfma_f32_16x16x32_bf16 v[40:43], a[240:243], v[148:151], v[40:43]
    buffer_load_dwordx4 v[200:203], v4, s[4:7], s12 offen offset:1024 sc1
    v_mfma_f32_16x16x32_bf16 v[36:39], a[244:247], v[144:147], v[36:39]
    ds_read_b128 v[12:15], v4 offset:5120
    v_mfma_f32_16x16x32_bf16 v[44:47], a[244:247], v[148:151], v[44:47]
    s_waitcnt lgkmcnt(2)
    v_mfma_f32_16x16x32_bf16 v[48:51], a[248:251], v[144:147], v[48:51]
    ds_read_b128 a[240:243], v4 offset:6144
    v_mfma_f32_16x16x32_bf16 v[56:59], a[248:251], v[148:151], v[56:59]
    buffer_load_dwordx4 v[204:207], v4, s[4:7], s13 offen offset:1024 sc1
    v_mfma_f32_16x16x32_bf16 v[52:55], a[252:255], v[144:147], v[52:55]
    ds_read_b128 a[244:247], v4 offset:7168
    v_mfma_f32_16x16x32_bf16 v[60:63], a[252:255], v[148:151], v[60:63]
    s_waitcnt lgkmcnt(2)
    v_mfma_f32_16x16x32_bf16 v[64:67], v[8:11], v[144:147], v[64:67]
    ds_read_b128 a[248:251], v4 offset:8192
    v_mfma_f32_16x16x32_bf16 v[72:75], v[8:11], v[148:151], v[72:75]
    buffer_load_dwordx4 v[208:211], v4, s[4:7], s12 offen offset:2048 sc1
    v_mfma_f32_16x16x32_bf16 v[68:71], v[12:15], v[144:147], v[68:71]
    ds_read_b128 a[252:255], v4 offset:9216
    v_mfma_f32_16x16x32_bf16 v[76:79], v[12:15], v[148:151], v[76:79]
    s_waitcnt lgkmcnt(2)
    v_mfma_f32_16x16x32_bf16 v[80:83], a[240:243], v[144:147], v[80:83]
    ds_read_b128 v[8:11], v4 offset:10240
    v_mfma_f32_16x16x32_bf16 v[88:91], a[240:243], v[148:151], v[88:91]
    buffer_load_dwordx4 v[212:215], v4, s[4:7], s13 offen offset:2048 sc1
    v_mfma_f32_16x16x32_bf16 v[84:87], a[244:247], v[144:147], v[84:87]
    ds_read_b128 v[12:15], v4 offset:11264
    v_mfma_f32_16x16x32_bf16 v[92:95], a[244:247], v[148:151], v[92:95]
    s_waitcnt vmcnt(24)
    s_waitcnt lgkmcnt(2)
    v_mfma_f32_16x16x32_bf16 v[32:35], a[248:251], v[152:155], v[32:35]
    ds_read_b128 a[240:243], v4 offset:12288
    v_mfma_f32_16x16x32_bf16 v[40:43], a[248:251], v[156:159], v[40:43]
    buffer_load_dwordx4 v[216:219], v4, s[4:7], s12 offen offset:3072 sc1
    v_mfma_f32_16x16x32_bf16 v[36:39], a[252:255], v[152:155], v[36:39]
    ds_read_b128 a[244:247], v4 offset:13312
    v_mfma_f32_16x16x32_bf16 v[44:47], a[252:255], v[156:159], v[44:47]
    s_waitcnt lgkmcnt(2)
    v_mfma_f32_16x16x32_bf16 v[48:51], v[8:11], v[152:155], v[48:51]
    ds_read_b128 a[248:251], v4 offset:14336
    v_mfma_f32_16x16x32_bf16 v[56:59], v[8:11], v[156:159], v[56:59]
    buffer_load_dwordx4 v[220:223], v4, s[4:7], s13 offen offset:3072 sc1
    v_mfma_f32_16x16x32_bf16 v[52:55], v[12:15], v[152:155], v[52:55]
    ds_read_b128 a[252:255], v4 offset:15360
    v_mfma_f32_16x16x32_bf16 v[60:63], v[12:15], v[156:159], v[60:63]
    s_waitcnt lgkmcnt(2)
    v_mfma_f32_16x16x32_bf16 v[64:67], a[240:243], v[152:155], v[64:67]
    ds_read_b128 v[8:11], v4 offset:16384
    s_waitcnt vmcnt(16)
    v_add_f32 v16, v236, v238
    v_mfma_f32_16x16x32_bf16 v[72:75], a[240:243], v[156:159], v[72:75]
    s_add_u32 s12, s22, 16384
    buffer_load_dwordx4 v[224:227], v4, s[4:7], s12 offen sc1
    v_add_f32 v17, v237, v239
    v_mfma_f32_16x16x32_bf16 v[68:71], a[244:247], v[152:155], v[68:71]
    ds_read_b128 v[12:15], v4 offset:17408
    v_add_f32 v16, v16, v240
    v_add_f32 v17, v17, v241
    v_mfma_f32_16x16x32_bf16 v[76:79], a[244:247], v[156:159], v[76:79]
    v_add_f32 v16, v16, v242
    v_add_f32 v17, v17, v243
    s_waitcnt lgkmcnt(2)
    v_mfma_f32_16x16x32_bf16 v[80:83], a[248:251], v[152:155], v[80:83]
    ds_read_b128 a[240:243], v4 offset:18432
    v_add_f32 v16, v16, v244
    v_add_f32 v17, v17, v245
    v_mfma_f32_16x16x32_bf16 v[88:91], a[248:251], v[156:159], v[88:91]
    s_add_u32 s13, s23, 16384
    buffer_load_dwordx4 v[228:231], v4, s[4:7], s13 offen sc1
    v_add_f32 v20, v246, v248
    v_mfma_f32_16x16x32_bf16 v[84:87], a[252:255], v[152:155], v[84:87]
    ds_read_b128 a[244:247], v4 offset:19456
    v_add_f32 v21, v247, v249
    v_add_f32 v20, v20, v250
    v_mfma_f32_16x16x32_bf16 v[92:95], a[252:255], v[156:159], v[92:95]
    v_add_f32 v21, v21, v251
    v_add_f32 v20, v20, v252
    s_waitcnt vmcnt(16)
    s_waitcnt lgkmcnt(2)
    v_mfma_f32_16x16x32_bf16 v[32:35], v[8:11], v[160:163], v[32:35]
    ds_read_b128 a[248:251], v4 offset:20480
    v_add_f32 v21, v21, v253
    v_add_f32 v20, v20, v254
    v_mfma_f32_16x16x32_bf16 v[40:43], v[8:11], v[164:167], v[40:43]
    buffer_load_dwordx4 v[232:235], v4, s[4:7], s12 offen offset:1024 sc1
    v_add_f32 v21, v21, v255
    v_mfma_f32_16x16x32_bf16 v[36:39], v[12:15], v[160:163], v[36:39]
    ds_read_b128 a[252:255], v4 offset:21504
    v_mov_b32 v18, v16
    v_mov_b32 v19, v16
    v_mfma_f32_16x16x32_bf16 v[44:47], v[12:15], v[164:167], v[44:47]
    s_nop 0
    v_permlane16_swap_b32 v18, v19
    s_waitcnt lgkmcnt(2)
    v_mfma_f32_16x16x32_bf16 v[48:51], a[240:243], v[160:163], v[48:51]
    ds_read_b128 v[8:11], v4 offset:22528
    v_add_f32 v16, v18, v19
    v_mov_b32 v18, v16
    v_mfma_f32_16x16x32_bf16 v[56:59], a[240:243], v[164:167], v[56:59]
    buffer_load_dwordx4 v[236:239], v4, s[4:7], s13 offen offset:1024 sc1
    v_mov_b32 v19, v16
    v_mfma_f32_16x16x32_bf16 v[52:55], a[244:247], v[160:163], v[52:55]
    ds_read_b128 v[12:15], v4 offset:23552
    s_nop 0
    v_permlane32_swap_b32 v18, v19
    v_mfma_f32_16x16x32_bf16 v[60:63], a[244:247], v[164:167], v[60:63]
    v_add_f32 v16, v18, v19
    v_mov_b32 v18, v17
    s_waitcnt lgkmcnt(2)
    v_mfma_f32_16x16x32_bf16 v[64:67], a[248:251], v[160:163], v[64:67]
    ds_read_b128 a[240:243], v4 offset:24576
    v_mov_b32 v19, v17
    s_nop 0
    v_mfma_f32_16x16x32_bf16 v[72:75], a[248:251], v[164:167], v[72:75]
    buffer_load_dwordx4 v[240:243], v4, s[4:7], s12 offen offset:2048 sc1
    v_permlane16_swap_b32 v18, v19
    v_mfma_f32_16x16x32_bf16 v[68:71], a[252:255], v[160:163], v[68:71]
    ds_read_b128 a[244:247], v4 offset:25600
    v_add_f32 v17, v18, v19
    v_mov_b32 v18, v17
    v_mfma_f32_16x16x32_bf16 v[76:79], a[252:255], v[164:167], v[76:79]
    v_mov_b32 v19, v17
    s_nop 0
    s_waitcnt lgkmcnt(2)
    v_mfma_f32_16x16x32_bf16 v[80:83], v[8:11], v[160:163], v[80:83]
    ds_read_b128 a[248:251], v4 offset:26624
    v_permlane32_swap_b32 v18, v19
    v_add_f32 v17, v18, v19
    v_mfma_f32_16x16x32_bf16 v[88:91], v[8:11], v[164:167], v[88:91]
    buffer_load_dwordx4 v[244:247], v4, s[4:7], s13 offen offset:2048 sc1
    v_mul_f32 v16, 0xbacccccd, v16
    v_mfma_f32_16x16x32_bf16 v[84:87], v[12:15], v[160:163], v[84:87]
    ds_read_b128 a[252:255], v4 offset:27648
    v_mul_f32 v17, 0x3acccccd, v17
    v_fma_f32 v17, -v16, v16, v17
    v_mfma_f32_16x16x32_bf16 v[92:95], v[12:15], v[164:167], v[92:95]
    v_max_f32 v17, 0, v17
    v_add_f32 v17, 0x3727c5ac, v17
    s_waitcnt vmcnt(18)
    s_waitcnt lgkmcnt(2)
    v_mfma_f32_16x16x32_bf16 v[32:35], a[240:243], v[168:171], v[32:35]
    ds_read_b128 v[8:11], v4 offset:28672
    v_rsq_f32 v24, v17
    v_mfma_f32_16x16x32_bf16 v[40:43], a[240:243], v[172:175], v[40:43]
    buffer_load_dwordx4 v[248:251], v4, s[4:7], s12 offen offset:3072 sc1
    v_mfma_f32_16x16x32_bf16 v[36:39], a[244:247], v[168:171], v[36:39]
    ds_read_b128 v[12:15], v4 offset:29696
    v_sqrt_f32 v26, v17
    v_mfma_f32_16x16x32_bf16 v[44:47], a[244:247], v[172:175], v[44:47]
    v_cvt_pk_bf16_f32 v17, v16, v16
    v_mul_f32 v24, 0xbfb8aa3b, v24
    s_waitcnt lgkmcnt(2)
    v_mfma_f32_16x16x32_bf16 v[48:51], a[248:251], v[168:171], v[48:51]
    ds_read_b128 a[240:243], v4 offset:30720
    v_and_b32 v18, 0xffff0000, v17
    v_sub_f32 v18, v16, v18
    v_mfma_f32_16x16x32_bf16 v[56:59], a[248:251], v[172:175], v[56:59]
    buffer_load_dwordx4 v[252:255], v4, s[4:7], s13 offen offset:3072 sc1
    v_cvt_pk_bf16_f32 v16, v16, v18
    v_mfma_f32_16x16x32_bf16 v[52:55], a[252:255], v[168:171], v[52:55]
    ds_read_b128 a[244:247], v4 offset:31744
    v_and_b32 v17, 0xffff, v17
    v_mov_b32 v18, 0
    v_mfma_f32_16x16x32_bf16 v[60:63], a[252:255], v[172:175], v[60:63]
    v_mov_b32 v19, 0
    v_mov_b32 v22, v20
    s_waitcnt lgkmcnt(2)
    v_mfma_f32_16x16x32_bf16 v[64:67], v[8:11], v[168:171], v[64:67]
    ds_read_b128 a[248:251], v4 offset:32768
    v_mov_b32 v23, v20
    s_nop 0
    v_mfma_f32_16x16x32_bf16 v[72:75], v[8:11], v[172:175], v[72:75]
    v_permlane16_swap_b32 v22, v23
    v_add_f32 v20, v22, v23
    v_mov_b32 v22, v20
    v_mfma_f32_16x16x32_bf16 v[68:71], v[12:15], v[168:171], v[68:71]
    ds_read_b128 a[252:255], v4 offset:33792
    v_mov_b32 v23, v20
    s_nop 0
    v_mfma_f32_16x16x32_bf16 v[76:79], v[12:15], v[172:175], v[76:79]
    v_permlane32_swap_b32 v22, v23
    v_add_f32 v20, v22, v23
    s_waitcnt lgkmcnt(2)
    v_mfma_f32_16x16x32_bf16 v[80:83], a[240:243], v[168:171], v[80:83]
    ds_read_b128 v[8:11], v4 offset:34816
    v_mov_b32 v22, v21
    v_mov_b32 v23, v21
    v_mfma_f32_16x16x32_bf16 v[88:91], a[240:243], v[172:175], v[88:91]
    s_nop 0
    v_permlane16_swap_b32 v22, v23
    v_add_f32 v21, v22, v23
    v_mfma_f32_16x16x32_bf16 v[84:87], a[244:247], v[168:171], v[84:87]
    ds_read_b128 v[12:15], v4 offset:35840
    v_mov_b32 v22, v21
    v_mov_b32 v23, v21
    v_mfma_f32_16x16x32_bf16 v[92:95], a[244:247], v[172:175], v[92:95]
    s_nop 0
    v_permlane32_swap_b32 v22, v23
    s_waitcnt vmcnt(18)
    s_waitcnt lgkmcnt(2)
    v_mfma_f32_16x16x32_bf16 v[32:35], a[248:251], v[176:179], v[32:35]
    ds_read_b128 a[240:243], v4 offset:36864
    v_add_f32 v21, v22, v23
    v_mul_f32 v20, 0xbacccccd, v20
    v_mfma_f32_16x16x32_bf16 v[40:43], a[248:251], v[180:183], v[40:43]
    v_mul_f32 v21, 0x3acccccd, v21
    v_fma_f32 v21, -v20, v20, v21
    v_max_f32 v21, 0, v21
    v_mfma_f32_16x16x32_bf16 v[36:39], a[252:255], v[176:179], v[36:39]
    ds_read_b128 a[244:247], v4 offset:37888
    v_add_f32 v21, 0x3727c5ac, v21
    v_mfma_f32_16x16x32_bf16 v[44:47], a[252:255], v[180:183], v[44:47]
    v_rsq_f32 v25, v21
    s_waitcnt lgkmcnt(2)
    v_mfma_f32_16x16x32_bf16 v[48:51], v[8:11], v[176:179], v[48:51]
    ds_read_b128 a[248:251], v4 offset:38912
    v_sqrt_f32 v27, v21
    v_mfma_f32_16x16x32_bf16 v[56:59], v[8:11], v[180:183], v[56:59]
    v_cvt_pk_bf16_f32 v21, v20, v20
    v_mul_f32 v25, 0xbfb8aa3b, v25
    v_and_b32 v22, 0xffff0000, v21
    v_mfma_f32_16x16x32_bf16 v[52:55], v[12:15], v[176:179], v[52:55]
    ds_read_b128 a[252:255], v4 offset:39936
    v_sub_f32 v22, v20, v22
    v_cvt_pk_bf16_f32 v20, v20, v22
    v_mfma_f32_16x16x32_bf16 v[60:63], v[12:15], v[180:183], v[60:63]
    v_and_b32 v21, 0xffff, v21
    v_mov_b32 v22, 0
    s_barrier
    s_waitcnt vmcnt(16)
    s_waitcnt lgkmcnt(2)
    v_mfma_f32_16x16x32_bf16 v[32:35], a[240:243], v[184:187], v[32:35]
    ds_read_b128 v[8:11], v4 offset:40960
    v_mov_b32 v23, 0
    v_mfma_f32_16x16x32_bf16 v[40:43], a[240:243], v[188:191], v[40:43]
    s_add_u32 m0, s57, 98304
    s_add_u32 s65, s58, 147456
    buffer_load_dwordx4 v4, s[4:7], s65 offen sc1 lds
    v_mfma_f32_16x16x32_bf16 v[36:39], a[244:247], v[184:187], v[36:39]
    ds_read_b128 v[12:15], v4 offset:41984
    v_mfma_f32_16x16x32_bf16 v[44:47], a[244:247], v[188:191], v[44:47]
    s_waitcnt lgkmcnt(2)
    v_mfma_f32_16x16x32_bf16 v[48:51], a[248:251], v[184:187], v[48:51]
    ds_read_b128 a[240:243], v4 offset:43008
    v_mfma_f32_16x16x32_bf16 v[56:59], a[248:251], v[188:191], v[56:59]
    buffer_load_dwordx4 v4, s[4:7], s65 offen offset:1024 sc1 lds
    v_mfma_f32_16x16x32_bf16 v[52:55], a[252:255], v[184:187], v[52:55]
    ds_read_b128 a[244:247], v4 offset:44032
    v_mfma_f32_16x16x32_bf16 v[60:63], a[252:255], v[188:191], v[60:63]
    s_waitcnt vmcnt(16)
    s_waitcnt lgkmcnt(2)
    v_mfma_f32_16x16x32_bf16 v[32:35], v[8:11], v[192:195], v[32:35]
    ds_read_b128 a[248:251], v4 offset:45056
    v_mfma_f32_16x16x32_bf16 v[40:43], v[8:11], v[196:199], v[40:43]
    buffer_load_dwordx4 v4, s[4:7], s65 offen offset:2048 sc1 lds
    v_mfma_f32_16x16x32_bf16 v[36:39], v[12:15], v[192:195], v[36:39]
    ds_read_b128 a[252:255], v4 offset:46080
    v_mfma_f32_16x16x32_bf16 v[44:47], v[12:15], v[196:199], v[44:47]
    s_waitcnt lgkmcnt(2)
    v_mfma_f32_16x16x32_bf16 v[48:51], a[240:243], v[192:195], v[48:51]
    ds_read_b128 v[8:11], v4 offset:47104
    v_mfma_f32_16x16x32_bf16 v[56:59], a[240:243], v[196:199], v[56:59]
    buffer_load_dwordx4 v4, s[4:7], s65 offen offset:3072 sc1 lds
    v_mfma_f32_16x16x32_bf16 v[52:55], a[244:247], v[192:195], v[52:55]
    ds_read_b128 v[12:15], v4 offset:48128
    v_mfma_f32_16x16x32_bf16 v[60:63], a[244:247], v[196:199], v[60:63]
    s_waitcnt vmcnt(16)
    s_waitcnt lgkmcnt(2)
    v_mfma_f32_16x16x32_bf16 v[32:35], a[248:251], v[200:203], v[32:35]
    ds_read_b128 a[240:243], v4 offset:49152
    v_mfma_f32_16x16x32_bf16 v[40:43], a[248:251], v[204:207], v[40:43]
    s_add_u32 m0, s57, 114688
    s_add_u32 s65, s58, 163840
    buffer_load_dwordx4 v4, s[4:7], s65 offen sc1 lds
    v_mfma_f32_16x16x32_bf16 v[36:39], a[252:255], v[200:203], v[36:39]
    ds_read_b128 a[244:247], v4 offset:50176
    v_mfma_f32_16x16x32_bf16 v[44:47], a[252:255], v[204:207], v[44:47]
    s_waitcnt lgkmcnt(2)
    v_mfma_f32_16x16x32_bf16 v[48:51], v[8:11], v[200:203], v[48:51]
    ds_read_b128 a[248:251], v4 offset:51200
    v_mfma_f32_16x16x32_bf16 v[56:59], v[8:11], v[204:207], v[56:59]
    buffer_load_dwordx4 v4, s[4:7], s65 offen offset:1024 sc1 lds
    v_mfma_f32_16x16x32_bf16 v[52:55], v[12:15], v[200:203], v[52:55]
    ds_read_b128 a[252:255], v4 offset:52224
    v_mfma_f32_16x16x32_bf16 v[60:63], v[12:15], v[204:207], v[60:63]
    s_waitcnt vmcnt(16)
    s_waitcnt lgkmcnt(2)
    v_mfma_f32_16x16x32_bf16 v[32:35], a[240:243], v[208:211], v[32:35]
    ds_read_b128 v[8:11], v4 offset:53248
    v_mfma_f32_16x16x32_bf16 v[40:43], a[240:243], v[212:215], v[40:43]
    buffer_load_dwordx4 v4, s[4:7], s65 offen offset:2048 sc1 lds
    v_mfma_f32_16x16x32_bf16 v[36:39], a[244:247], v[208:211], v[36:39]
    ds_read_b128 v[12:15], v4 offset:54272
    v_mfma_f32_16x16x32_bf16 v[44:47], a[244:247], v[212:215], v[44:47]
    s_waitcnt lgkmcnt(2)
    v_mfma_f32_16x16x32_bf16 v[48:51], a[248:251], v[208:211], v[48:51]
    ds_read_b128 a[240:243], v4 offset:55296
    v_mfma_f32_16x16x32_bf16 v[56:59], a[248:251], v[212:215], v[56:59]
    buffer_load_dwordx4 v4, s[4:7], s65 offen offset:3072 sc1 lds
    v_mfma_f32_16x16x32_bf16 v[52:55], a[252:255], v[208:211], v[52:55]
    ds_read_b128 a[244:247], v4 offset:56320
    v_mfma_f32_16x16x32_bf16 v[60:63], a[252:255], v[212:215], v[60:63]
    s_waitcnt vmcnt(16)
    s_waitcnt lgkmcnt(2)
    v_mfma_f32_16x16x32_bf16 v[32:35], v[8:11], v[216:219], v[32:35]
    ds_read_b128 a[248:251], v4 offset:57344
    v_mfma_f32_16x16x32_bf16 v[40:43], v[8:11], v[220:223], v[40:43]
    s_add_u32 m0, s57, 131072
    s_add_u32 s65, s58, 180224
    buffer_load_dwordx4 v4, s[4:7], s65 offen sc1 lds
    v_mfma_f32_16x16x32_bf16 v[36:39], v[12:15], v[216:219], v[36:39]
    ds_read_b128 a[252:255], v4 offset:58368
    v_mfma_f32_16x16x32_bf16 v[44:47], v[12:15], v[220:223], v[44:47]
    s_waitcnt lgkmcnt(2)
    v_mfma_f32_16x16x32_bf16 v[48:51], a[240:243], v[216:219], v[48:51]
    ds_read_b128 v[8:11], v4 offset:59392
    v_mfma_f32_16x16x32_bf16 v[56:59], a[240:243], v[220:223], v[56:59]
    buffer_load_dwordx4 v4, s[4:7], s65 offen offset:1024 sc1 lds
    v_mfma_f32_16x16x32_bf16 v[52:55], a[244:247], v[216:219], v[52:55]
    ds_read_b128 v[12:15], v4 offset:60416
    v_mfma_f32_16x16x32_bf16 v[60:63], a[244:247], v[220:223], v[60:63]
    s_waitcnt vmcnt(16)
    s_waitcnt lgkmcnt(2)
    v_mfma_f32_16x16x32_bf16 v[32:35], a[248:251], v[224:227], v[32:35]
    ds_read_b128 a[240:243], v4 offset:61440
    v_mfma_f32_16x16x32_bf16 v[40:43], a[248:251], v[228:231], v[40:43]
    buffer_load_dwordx4 v4, s[4:7], s65 offen offset:2048 sc1 lds
    v_mfma_f32_16x16x32_bf16 v[36:39], a[252:255], v[224:227], v[36:39]
    ds_read_b128 a[244:247], v4 offset:62464
    v_mfma_f32_16x16x32_bf16 v[44:47], a[252:255], v[228:231], v[44:47]
    s_waitcnt lgkmcnt(2)
    v_mfma_f32_16x16x32_bf16 v[48:51], v[8:11], v[224:227], v[48:51]
    ds_read_b128 a[248:251], v4 offset:63488
    v_mfma_f32_16x16x32_bf16 v[56:59], v[8:11], v[228:231], v[56:59]
    buffer_load_dwordx4 v4, s[4:7], s65 offen offset:3072 sc1 lds
    v_mfma_f32_16x16x32_bf16 v[52:55], v[12:15], v[224:227], v[52:55]
    ds_read_b128 a[252:255], v4 offset:64512
    v_mfma_f32_16x16x32_bf16 v[60:63], v[12:15], v[228:231], v[60:63]
    s_waitcnt vmcnt(16)
    s_waitcnt lgkmcnt(2)
    v_mfma_f32_16x16x32_bf16 v[32:35], a[240:243], v[232:235], v[32:35]
    ds_read_b128 v[8:11], v5 offset:0
    v_mfma_f32_16x16x32_bf16 v[40:43], a[240:243], v[236:239], v[40:43]
    s_add_u32 m0, s57, 0
    s_add_u32 s65, s58, 196608
    buffer_load_dwordx4 v4, s[4:7], s65 offen sc1 lds
    v_mfma_f32_16x16x32_bf16 v[36:39], a[244:247], v[232:235], v[36:39]
    ds_read_b128 v[12:15], v5 offset:1024
    v_mfma_f32_16x16x32_bf16 v[44:47], a[244:247], v[236:239], v[44:47]
    s_waitcnt lgkmcnt(2)
    v_mfma_f32_16x16x32_bf16 v[48:51], a[248:251], v[232:235], v[48:51]
    ds_read_b128 a[240:243], v5 offset:2048
    v_mfma_f32_16x16x32_bf16 v[56:59], a[248:251], v[236:239], v[56:59]
    buffer_load_dwordx4 v4, s[4:7], s65 offen offset:1024 sc1 lds
    v_mfma_f32_16x16x32_bf16 v[52:55], a[252:255], v[232:235], v[52:55]
    ds_read_b128 a[244:247], v5 offset:3072
    v_mfma_f32_16x16x32_bf16 v[60:63], a[252:255], v[236:239], v[60:63]
    s_waitcnt vmcnt(16)
    s_waitcnt lgkmcnt(2)
    v_mfma_f32_16x16x32_bf16 v[32:35], v[8:11], v[240:243], v[32:35]
    ds_read_b128 a[248:251], v5 offset:4096
    v_mfma_f32_16x16x32_bf16 v[40:43], v[8:11], v[244:247], v[40:43]
    buffer_load_dwordx4 v4, s[4:7], s65 offen offset:2048 sc1 lds
    v_mfma_f32_16x16x32_bf16 v[36:39], v[12:15], v[240:243], v[36:39]
    ds_read_b128 a[252:255], v5 offset:5120
    v_mfma_f32_16x16x32_bf16 v[44:47], v[12:15], v[244:247], v[44:47]
    s_waitcnt lgkmcnt(2)
    v_mfma_f32_16x16x32_bf16 v[48:51], a[240:243], v[240:243], v[48:51]
    ds_read_b128 v[8:11], v5 offset:6144
    v_mfma_f32_16x16x32_bf16 v[56:59], a[240:243], v[244:247], v[56:59]
    buffer_load_dwordx4 v4, s[4:7], s65 offen offset:3072 sc1 lds
    v_mfma_f32_16x16x32_bf16 v[52:55], a[244:247], v[240:243], v[52:55]
    ds_read_b128 v[12:15], v5 offset:7168
    v_mfma_f32_16x16x32_bf16 v[60:63], a[244:247], v[244:247], v[60:63]
    s_waitcnt vmcnt(16)
    s_waitcnt lgkmcnt(2)
    v_mfma_f32_16x16x32_bf16 v[32:35], a[248:251], v[248:251], v[32:35]
    ds_read_b128 a[240:243], v5 offset:8192
    v_mfma_f32_16x16x32_bf16 v[40:43], a[248:251], v[252:255], v[40:43]
    s_add_u32 m0, s57, 16384
    s_add_u32 s65, s58, 212992
    buffer_load_dwordx4 v4, s[4:7], s65 offen sc1 lds
    v_mfma_f32_16x16x32_bf16 v[36:39], a[252:255], v[248:251], v[36:39]
    ds_read_b128 a[244:247], v5 offset:9216
    v_mfma_f32_16x16x32_bf16 v[44:47], a[252:255], v[252:255], v[44:47]
    s_waitcnt lgkmcnt(2)
    v_mfma_f32_16x16x32_bf16 v[48:51], v[8:11], v[248:251], v[48:51]
    ds_read_b128 a[248:251], v5 offset:10240
    v_mfma_f32_16x16x32_bf16 v[56:59], v[8:11], v[252:255], v[56:59]
    buffer_load_dwordx4 v4, s[4:7], s65 offen offset:1024 sc1 lds
    v_mfma_f32_16x16x32_bf16 v[52:55], v[12:15], v[248:251], v[52:55]
    ds_read_b128 a[252:255], v5 offset:11264
    v_mfma_f32_16x16x32_bf16 v[60:63], v[12:15], v[252:255], v[60:63]
    s_waitcnt lgkmcnt(2)
    v_mfma_f32_16x16x32_bf16 v[32:35], a[240:243], v[16:19], v[32:35]
    ds_read_b128 v[8:11], v5 offset:12288
    v_mfma_f32_16x16x32_bf16 v[40:43], a[240:243], v[20:23], v[40:43]
    buffer_load_dwordx4 v4, s[4:7], s65 offen offset:2048 sc1 lds
    v_mfma_f32_16x16x32_bf16 v[36:39], a[244:247], v[16:19], v[36:39]
    ds_read_b128 v[12:15], v5 offset:13312
    v_mfma_f32_16x16x32_bf16 v[44:47], a[244:247], v[20:23], v[44:47]
    s_waitcnt lgkmcnt(2)
    v_mfma_f32_16x16x32_bf16 v[48:51], a[248:251], v[16:19], v[48:51]
    ds_read_b128 a[240:243], v5 offset:14336
    v_mfma_f32_16x16x32_bf16 v[56:59], a[248:251], v[20:23], v[56:59]
    buffer_load_dwordx4 v4, s[4:7], s65 offen offset:3072 sc1 lds
    v_mfma_f32_16x16x32_bf16 v[52:55], a[252:255], v[16:19], v[52:55]
    ds_read_b128 a[244:247], v5 offset:15360
    v_mfma_f32_16x16x32_bf16 v[60:63], a[252:255], v[20:23], v[60:63]
    s_waitcnt lgkmcnt(2)
    v_mfma_f32_16x16x32_bf16 v[64:67], v[8:11], v[176:179], v[64:67]
    ds_read_b128 a[248:251], v5 offset:16384
    v_mfma_f32_16x16x32_bf16 v[72:75], v[8:11], v[180:183], v[72:75]
    v_mfma_f32_16x16x32_bf16 v[68:71], v[12:15], v[176:179], v[68:71]
    ds_read_b128 a[252:255], v5 offset:17408
    v_mfma_f32_16x16x32_bf16 v[76:79], v[12:15], v[180:183], v[76:79]
    s_waitcnt lgkmcnt(2)
    v_mfma_f32_16x16x32_bf16 v[80:83], a[240:243], v[176:179], v[80:83]
    ds_read_b128 v[8:11], v5 offset:18432
    v_mul_f32 v32, v32, v24
    v_mul_f32 v33, v33, v24
    v_mfma_f32_16x16x32_bf16 v[88:91], a[240:243], v[180:183], v[88:91]
    v_mul_f32 v34, v34, v24
    v_exp_f32 v32, v32
    v_mfma_f32_16x16x32_bf16 v[84:87], a[244:247], v[176:179], v[84:87]
    ds_read_b128 v[12:15], v5 offset:19456
    v_mul_f32 v35, v35, v24
    v_mfma_f32_16x16x32_bf16 v[92:95], a[244:247], v[180:183], v[92:95]
    v_exp_f32 v33, v33
    s_waitcnt lgkmcnt(2)
    v_mfma_f32_16x16x32_bf16 v[64:67], a[248:251], v[184:187], v[64:67]
    ds_read_b128 a[240:243], v5 offset:20480
    v_mul_f32 v36, v36, v24
    v_mfma_f32_16x16x32_bf16 v[72:75], a[248:251], v[188:191], v[72:75]
    v_exp_f32 v34, v34
    v_fma_f32 v32, v32, v26, v26
    v_mfma_f32_16x16x32_bf16 v[68:71], a[252:255], v[184:187], v[68:71]
    ds_read_b128 a[244:247], v5 offset:21504
    v_mul_f32 v37, v37, v24
    v_mfma_f32_16x16x32_bf16 v[76:79], a[252:255], v[188:191], v[76:79]
    v_exp_f32 v35, v35
    s_waitcnt lgkmcnt(2)
    v_mfma_f32_16x16x32_bf16 v[80:83], v[8:11], v[184:187], v[80:83]
    ds_read_b128 a[248:251], v5 offset:22528
    v_fma_f32 v33, v33, v26, v26
    v_mul_f32 v38, v38, v24
    v_mfma_f32_16x16x32_bf16 v[88:91], v[8:11], v[188:191], v[88:91]
    v_exp_f32 v36, v36
    v_fma_f32 v34, v34, v26, v26
    v_mfma_f32_16x16x32_bf16 v[84:87], v[12:15], v[184:187], v[84:87]
    ds_read_b128 a[252:255], v5 offset:23552
    v_rcp_f32 v32, v32
    v_mfma_f32_16x16x32_bf16 v[92:95], v[12:15], v[188:191], v[92:95]
    v_mul_f32 v39, v39, v24
    s_waitcnt lgkmcnt(2)
    v_mfma_f32_16x16x32_bf16 v[64:67], a[240:243], v[192:195], v[64:67]
    ds_read_b128 v[8:11], v5 offset:24576
    v_exp_f32 v37, v37
    v_mfma_f32_16x16x32_bf16 v[72:75], a[240:243], v[196:199], v[72:75]
    v_fma_f32 v35, v35, v26, v26
    v_rcp_f32 v33, v33
    v_mfma_f32_16x16x32_bf16 v[68:71], a[244:247], v[192:195], v[68:71]
    ds_read_b128 v[12:15], v5 offset:25600
    v_mul_f32 v40, v40, v25
    v_mfma_f32_16x16x32_bf16 v[76:79], a[244:247], v[196:199], v[76:79]
    v_exp_f32 v38, v38
    s_waitcnt lgkmcnt(2)
    v_mfma_f32_16x16x32_bf16 v[80:83], a[248:251], v[192:195], v[80:83]
    ds_read_b128 a[240:243], v5 offset:26624
    v_fma_f32 v36, v36, v26, v26
    v_mfma_f32_16x16x32_bf16 v[88:91], a[248:251], v[196:199], v[88:91]
    v_rcp_f32 v34, v34
    v_mul_f32 v48, v48, v32
    v_mfma_f32_16x16x32_bf16 v[84:87], a[252:255], v[192:195], v[84:87]
    ds_read_b128 a[244:247], v5 offset:27648
    v_mul_f32 v41, v41, v25
    v_mfma_f32_16x16x32_bf16 v[92:95], a[252:255], v[196:199], v[92:95]
    v_exp_f32 v39, v39
    s_waitcnt lgkmcnt(2)
    v_mfma_f32_16x16x32_bf16 v[64:67], v[8:11], v[200:203], v[64:67]
    ds_read_b128 a[248:251], v5 offset:28672
    v_fma_f32 v37, v37, v26, v26
    v_mfma_f32_16x16x32_bf16 v[72:75], v[8:11], v[204:207], v[72:75]
    v_rcp_f32 v35, v35
    v_mul_f32 v49, v49, v33
    v_mfma_f32_16x16x32_bf16 v[68:71], v[12:15], v[200:203], v[68:71]
    ds_read_b128 a[252:255], v5 offset:29696
    v_mul_f32 v42, v42, v25
    v_mfma_f32_16x16x32_bf16 v[76:79], v[12:15], v[204:207], v[76:79]
    v_exp_f32 v40, v40
    s_waitcnt lgkmcnt(2)
    v_mfma_f32_16x16x32_bf16 v[80:83], a[240:243], v[200:203], v[80:83]
    ds_read_b128 v[8:11], v5 offset:30720
    v_fma_f32 v38, v38, v26, v26
    v_mfma_f32_16x16x32_bf16 v[88:91], a[240:243], v[204:207], v[88:91]
    v_rcp_f32 v36, v36
    v_mul_f32 v50, v50, v34
    v_mfma_f32_16x16x32_bf16 v[84:87], a[244:247], v[200:203], v[84:87]
    ds_read_b128 v[12:15], v5 offset:31744
    v_mul_f32 v43, v43, v25
    v_mfma_f32_16x16x32_bf16 v[92:95], a[244:247], v[204:207], v[92:95]
    v_exp_f32 v41, v41
    s_waitcnt vmcnt(4)
    s_barrier
    s_waitcnt lgkmcnt(2)
    v_mfma_f32_16x16x32_bf16 v[64:67], a[248:251], v[208:211], v[64:67]
    ds_read_b128 a[240:243], v5 offset:32768
    v_fma_f32 v39, v39, v26, v26
    v_mfma_f32_16x16x32_bf16 v[72:75], a[248:251], v[212:215], v[72:75]
    s_add_u32 m0, s57, 32768
    s_add_u32 s65, s58, 229376
    buffer_load_dwordx4 v4, s[4:7], s65 offen sc1 lds
    v_mfma_f32_16x16x32_bf16 v[68:71], a[252:255], v[208:211], v[68:71]
    ds_read_b128 a[244:247], v5 offset:33792
    v_rcp_f32 v37, v37
    v_mfma_f32_16x16x32_bf16 v[76:79], a[252:255], v[212:215], v[76:79]
    v_mul_f32 v51, v51, v35
    v_cvt_pk_bf16_f32 v32, v48, v49
    s_waitcnt lgkmcnt(2)
    v_mfma_f32_16x16x32_bf16 v[80:83], v[8:11], v[208:211], v[80:83]
    ds_read_b128 a[248:251], v5 offset:34816
    v_mul_f32 v44, v44, v25
    v_mfma_f32_16x16x32_bf16 v[88:91], v[8:11], v[212:215], v[88:91]
    buffer_load_dwordx4 v4, s[4:7], s65 offen offset:1024 sc1 lds
    v_exp_f32 v42, v42
    v_mfma_f32_16x16x32_bf16 v[84:87], v[12:15], v[208:211], v[84:87]
    ds_read_b128 a[252:255], v5 offset:35840
    v_fma_f32 v40, v40, v27, v27
    v_mfma_f32_16x16x32_bf16 v[92:95], v[12:15], v[212:215], v[92:95]
    v_rcp_f32 v38, v38
    s_waitcnt lgkmcnt(2)
    v_mfma_f32_16x16x32_bf16 v[64:67], a[240:243], v[216:219], v[64:67]
    ds_read_b128 v[8:11], v5 offset:36864
    v_mul_f32 v52, v52, v36
    v_mul_f32 v45, v45, v25
    v_mfma_f32_16x16x32_bf16 v[72:75], a[240:243], v[220:223], v[72:75]
    buffer_load_dwordx4 v4, s[4:7], s65 offen offset:2048 sc1 lds
    v_exp_f32 v43, v43
    v_mfma_f32_16x16x32_bf16 v[68:71], a[244:247], v[216:219], v[68:71]
    ds_read_b128 v[12:15], v5 offset:37888
    v_fma_f32 v41, v41, v27, v27
    v_mfma_f32_16x16x32_bf16 v[76:79], a[244:247], v[220:223], v[76:79]
    v_rcp_f32 v39, v39
    s_waitcnt lgkmcnt(2)
    v_mfma_f32_16x16x32_bf16 v[80:83], a[248:251], v[216:219], v[80:83]
    ds_read_b128 a[240:243], v5 offset:38912
    v_mul_f32 v53, v53, v37
    v_cvt_pk_bf16_f32 v33, v50, v51
    v_mfma_f32_16x16x32_bf16 v[88:91], a[248:251], v[220:223], v[88:91]
    buffer_load_dwordx4 v4, s[4:7], s65 offen offset:3072 sc1 lds
    v_mul_f32 v46, v46, v25
    v_mfma_f32_16x16x32_bf16 v[84:87], a[252:255], v[216:219], v[84:87]
    ds_read_b128 a[244:247], v5 offset:39936
    v_exp_f32 v44, v44
    v_mfma_f32_16x16x32_bf16 v[92:95], a[252:255], v[220:223], v[92:95]
    v_fma_f32 v42, v42, v27, v27
    s_waitcnt lgkmcnt(2)
    v_mfma_f32_16x16x32_bf16 v[64:67], v[8:11], v[224:227], v[64:67]
    ds_read_b128 a[248:251], v5 offset:40960
    v_rcp_f32 v40, v40
    v_mfma_f32_16x16x32_bf16 v[72:75], v[8:11], v[228:231], v[72:75]
    s_add_u32 m0, s57, 49152
    s_add_u32 s65, s58, 245760
    buffer_load_dwordx4 v4, s[4:7], s65 offen sc1 lds
    v_mfma_f32_16x16x32_bf16 v[68:71], v[12:15], v[224:227], v[68:71]
    ds_read_b128 a[252:255], v5 offset:41984
    v_mul_f32 v54, v54, v38
    v_mul_f32 v47, v47, v25
    v_mfma_f32_16x16x32_bf16 v[76:79], v[12:15], v[228:231], v[76:79]
    v_exp_f32 v45, v45
    s_waitcnt lgkmcnt(2)
    v_mfma_f32_16x16x32_bf16 v[80:83], a[240:243], v[224:227], v[80:83]
    ds_read_b128 v[8:11], v5 offset:43008
    v_fma_f32 v43, v43, v27, v27
    v_mfma_f32_16x16x32_bf16 v[88:91], a[240:243], v[228:231], v[88:91]
    buffer_load_dwordx4 v4, s[4:7], s65 offen offset:1024 sc1 lds
    v_rcp_f32 v41, v41
    v_mfma_f32_16x16x32_bf16 v[84:87], a[244:247], v[224:227], v[84:87]
    ds_read_b128 v[12:15], v5 offset:44032
    v_mul_f32 v55, v55, v39
    v_cvt_pk_bf16_f32 v34, v52, v53
    v_mfma_f32_16x16x32_bf16 v[92:95], a[244:247], v[228:231], v[92:95]
    v_exp_f32 v46, v46
    s_waitcnt lgkmcnt(2)
    v_mfma_f32_16x16x32_bf16 v[64:67], a[248:251], v[232:235], v[64:67]
    ds_read_b128 a[240:243], v5 offset:45056
    v_fma_f32 v44, v44, v27, v27
    v_mfma_f32_16x16x32_bf16 v[72:75], a[248:251], v[236:239], v[72:75]
    buffer_load_dwordx4 v4, s[4:7], s65 offen offset:2048 sc1 lds
    v_rcp_f32 v42, v42
    v_mfma_f32_16x16x32_bf16 v[68:71], a[252:255], v[232:235], v[68:71]
    ds_read_b128 a[244:247], v5 offset:46080
    v_mul_f32 v56, v56, v40
    v_mfma_f32_16x16x32_bf16 v[76:79], a[252:255], v[236:239], v[76:79]
    v_exp_f32 v47, v47
    s_waitcnt lgkmcnt(2)
    v_mfma_f32_16x16x32_bf16 v[80:83], v[8:11], v[232:235], v[80:83]
    ds_read_b128 a[248:251], v5 offset:47104
    v_fma_f32 v45, v45, v27, v27
    v_mfma_f32_16x16x32_bf16 v[88:91], v[8:11], v[236:239], v[88:91]
    buffer_load_dwordx4 v4, s[4:7], s65 offen offset:3072 sc1 lds
    v_rcp_f32 v43, v43
    v_mfma_f32_16x16x32_bf16 v[84:87], v[12:15], v[232:235], v[84:87]
    ds_read_b128 a[252:255], v5 offset:48128
    v_mul_f32 v57, v57, v41
    v_cvt_pk_bf16_f32 v35, v54, v55
    v_mfma_f32_16x16x32_bf16 v[92:95], v[12:15], v[236:239], v[92:95]
    buffer_store_dwordx4 v[32:35], v4, s[4:7], s27 offen offset:0 sc1
    v_fma_f32 v46, v46, v27, v27
    s_waitcnt lgkmcnt(2)
    v_mfma_f32_16x16x32_bf16 v[64:67], a[240:243], v[240:243], v[64:67]
    ds_read_b128 v[8:11], v5 offset:49152
    v_rcp_f32 v44, v44
    v_mfma_f32_16x16x32_bf16 v[72:75], a[240:243], v[244:247], v[72:75]
    v_mul_f32 v58, v58, v42
    v_fma_f32 v47, v47, v27, v27
    v_mfma_f32_16x16x32_bf16 v[68:71], a[244:247], v[240:243], v[68:71]
    ds_read_b128 v[12:15], v5 offset:50176
    v_rcp_f32 v45, v45
    v_mfma_f32_16x16x32_bf16 v[76:79], a[244:247], v[244:247], v[76:79]
    v_mul_f32 v59, v59, v43
    v_cvt_pk_bf16_f32 v36, v56, v57
    s_waitcnt lgkmcnt(2)
    v_mfma_f32_16x16x32_bf16 v[80:83], a[248:251], v[240:243], v[80:83]
    ds_read_b128 a[240:243], v5 offset:51200
    v_rcp_f32 v46, v46
    v_mfma_f32_16x16x32_bf16 v[88:91], a[248:251], v[244:247], v[88:91]
    v_mul_f32 v60, v60, v44
    v_rcp_f32 v47, v47
    v_mfma_f32_16x16x32_bf16 v[84:87], a[252:255], v[240:243], v[84:87]
    ds_read_b128 a[244:247], v5 offset:52224
    v_mul_f32 v61, v61, v45
    v_cvt_pk_bf16_f32 v37, v58, v59
    v_mfma_f32_16x16x32_bf16 v[92:95], a[252:255], v[244:247], v[92:95]
    v_mul_f32 v62, v62, v46
    v_mul_f32 v63, v63, v47
    s_waitcnt lgkmcnt(2)
    v_mfma_f32_16x16x32_bf16 v[64:67], v[8:11], v[248:251], v[64:67]
    ds_read_b128 a[248:251], v5 offset:53248
    v_cvt_pk_bf16_f32 v38, v60, v61
    v_cvt_pk_bf16_f32 v39, v62, v63
    v_mfma_f32_16x16x32_bf16 v[72:75], v[8:11], v[252:255], v[72:75]
    buffer_store_dwordx4 v[36:39], v4, s[4:7], s15 offen offset:0 sc1
    v_mfma_f32_16x16x32_bf16 v[68:71], v[12:15], v[248:251], v[68:71]
    ds_read_b128 a[252:255], v5 offset:54272
    v_mfma_f32_16x16x32_bf16 v[76:79], v[12:15], v[252:255], v[76:79]
    s_waitcnt lgkmcnt(2)
    v_mfma_f32_16x16x32_bf16 v[80:83], a[240:243], v[248:251], v[80:83]
    ds_read_b128 v[8:11], v5 offset:55296
    v_mfma_f32_16x16x32_bf16 v[88:91], a[240:243], v[252:255], v[88:91]
    v_mfma_f32_16x16x32_bf16 v[84:87], a[244:247], v[248:251], v[84:87]
    ds_read_b128 v[12:15], v5 offset:56320
    v_mfma_f32_16x16x32_bf16 v[92:95], a[244:247], v[252:255], v[92:95]
    s_waitcnt lgkmcnt(2)
    v_mfma_f32_16x16x32_bf16 v[64:67], a[248:251], v[16:19], v[64:67]
    ds_read_b128 a[240:243], v5 offset:57344
    v_mfma_f32_16x16x32_bf16 v[72:75], a[248:251], v[20:23], v[72:75]
    v_mfma_f32_16x16x32_bf16 v[68:71], a[252:255], v[16:19], v[68:71]
    ds_read_b128 a[244:247], v5 offset:58368
    v_mfma_f32_16x16x32_bf16 v[76:79], a[252:255], v[20:23], v[76:79]
    s_waitcnt lgkmcnt(2)
    v_mfma_f32_16x16x32_bf16 v[80:83], v[8:11], v[16:19], v[80:83]
    ds_read_b128 a[248:251], v5 offset:59392
    v_mfma_f32_16x16x32_bf16 v[88:91], v[8:11], v[20:23], v[88:91]
    v_mfma_f32_16x16x32_bf16 v[84:87], v[12:15], v[16:19], v[84:87]
    ds_read_b128 a[252:255], v5 offset:60416
    v_mfma_f32_16x16x32_bf16 v[92:95], v[12:15], v[20:23], v[92:95]
    s_waitcnt lgkmcnt(2)
    v_mfma_f32_16x16x32_bf16 v[32:35], a[240:243], v[96:99], 0
    ds_read_b128 v[8:11], v5 offset:61440
    v_mfma_f32_16x16x32_bf16 v[40:43], a[240:243], v[100:103], 0
    v_mfma_f32_16x16x32_bf16 v[36:39], a[244:247], v[96:99], 0
    ds_read_b128 v[12:15], v5 offset:62464
    v_mfma_f32_16x16x32_bf16 v[44:47], a[244:247], v[100:103], 0
    s_waitcnt lgkmcnt(2)
    v_mfma_f32_16x16x32_bf16 v[48:51], a[248:251], v[96:99], 0
    ds_read_b128 a[240:243], v5 offset:63488
    v_mul_f32 v64, v64, v24
    v_mul_f32 v65, v65, v24
    v_mfma_f32_16x16x32_bf16 v[56:59], a[248:251], v[100:103], 0
    v_mul_f32 v66, v66, v24
    v_exp_f32 v64, v64
    v_mfma_f32_16x16x32_bf16 v[52:55], a[252:255], v[96:99], 0
    ds_read_b128 a[244:247], v5 offset:64512
    v_mul_f32 v67, v67, v24
    v_mfma_f32_16x16x32_bf16 v[60:63], a[252:255], v[100:103], 0
    v_exp_f32 v65, v65
    s_waitcnt lgkmcnt(2)
    v_mfma_f32_16x16x32_bf16 v[32:35], v[8:11], v[104:107], v[32:35]
    ds_read_b128 a[248:251], v6 offset:0
    v_mul_f32 v68, v68, v24
    v_mfma_f32_16x16x32_bf16 v[40:43], v[8:11], v[108:111], v[40:43]
    v_exp_f32 v66, v66
    v_fma_f32 v64, v64, v26, v26
    v_mfma_f32_16x16x32_bf16 v[36:39], v[12:15], v[104:107], v[36:39]
    ds_read_b128 a[252:255], v6 offset:1024
    v_mul_f32 v69, v69, v24
    v_mfma_f32_16x16x32_bf16 v[44:47], v[12:15], v[108:111], v[44:47]
    v_exp_f32 v67, v67
    s_waitcnt lgkmcnt(2)
    v_mfma_f32_16x16x32_bf16 v[48:51], a[240:243], v[104:107], v[48:51]
    ds_read_b128 v[8:11], v6 offset:2048
    v_fma_f32 v65, v65, v26, v26
    v_mul_f32 v70, v70, v24
    v_mfma_f32_16x16x32_bf16 v[56:59], a[240:243], v[108:111], v[56:59]
    v_exp_f32 v68, v68
    v_fma_f32 v66, v66, v26, v26
    v_mfma_f32_16x16x32_bf16 v[52:55], a[244:247], v[104:107], v[52:55]
    ds_read_b128 v[12:15], v6 offset:3072
    v_rcp_f32 v64, v64
    v_mfma_f32_16x16x32_bf16 v[60:63], a[244:247], v[108:111], v[60:63]
    v_mul_f32 v71, v71, v24
    s_waitcnt lgkmcnt(2)
    v_mfma_f32_16x16x32_bf16 v[32:35], a[248:251], v[112:115], v[32:35]
    ds_read_b128 a[240:243], v6 offset:4096
    v_exp_f32 v69, v69
    v_mfma_f32_16x16x32_bf16 v[40:43], a[248:251], v[116:119], v[40:43]
    v_fma_f32 v67, v67, v26, v26
    v_rcp_f32 v65, v65
    v_mfma_f32_16x16x32_bf16 v[36:39], a[252:255], v[112:115], v[36:39]
    ds_read_b128 a[244:247], v6 offset:5120
    v_mul_f32 v72, v72, v25
    v_mfma_f32_16x16x32_bf16 v[44:47], a[252:255], v[116:119], v[44:47]
    v_exp_f32 v70, v70
    s_waitcnt lgkmcnt(2)
    v_mfma_f32_16x16x32_bf16 v[48:51], v[8:11], v[112:115], v[48:51]
    ds_read_b128 a[248:251], v6 offset:6144
    v_fma_f32 v68, v68, v26, v26
    v_mfma_f32_16x16x32_bf16 v[56:59], v[8:11], v[116:119], v[56:59]
    v_rcp_f32 v66, v66
    v_mul_f32 v80, v80, v64
    v_mfma_f32_16x16x32_bf16 v[52:55], v[12:15], v[112:115], v[52:55]
    ds_read_b128 a[252:255], v6 offset:7168
    v_mul_f32 v73, v73, v25
    v_mfma_f32_16x16x32_bf16 v[60:63], v[12:15], v[116:119], v[60:63]
    v_exp_f32 v71, v71
    s_waitcnt lgkmcnt(2)
    v_mfma_f32_16x16x32_bf16 v[32:35], a[240:243], v[120:123], v[32:35]
    ds_read_b128 v[8:11], v6 offset:8192
    v_fma_f32 v69, v69, v26, v26
    v_mfma_f32_16x16x32_bf16 v[40:43], a[240:243], v[124:127], v[40:43]
    v_rcp_f32 v67, v67
    v_mul_f32 v81, v81, v65
    v_mfma_f32_16x16x32_bf16 v[36:39], a[244:247], v[120:123], v[36:39]
    ds_read_b128 v[12:15], v6 offset:9216
    v_mul_f32 v74, v74, v25
    v_mfma_f32_16x16x32_bf16 v[44:47], a[244:247], v[124:127], v[44:47]
    v_exp_f32 v72, v72
    s_waitcnt lgkmcnt(2)
    v_mfma_f32_16x16x32_bf16 v[48:51], a[248:251], v[120:123], v[48:51]
    ds_read_b128 a[240:243], v6 offset:10240
    v_fma_f32 v70, v70, v26, v26
    v_mfma_f32_16x16x32_bf16 v[56:59], a[248:251], v[124:127], v[56:59]
    v_rcp_f32 v68, v68
    v_mul_f32 v82, v82, v66
    v_mfma_f32_16x16x32_bf16 v[52:55], a[252:255], v[120:123], v[52:55]
    ds_read_b128 a[244:247], v6 offset:11264
    v_mul_f32 v75, v75, v25
    v_mfma_f32_16x16x32_bf16 v[60:63], a[252:255], v[124:127], v[60:63]
    v_exp_f32 v73, v73
    s_waitcnt lgkmcnt(2)
    v_mfma_f32_16x16x32_bf16 v[32:35], v[8:11], v[128:131], v[32:35]
    ds_read_b128 a[248:251], v6 offset:12288
    v_fma_f32 v71, v71, v26, v26
    v_mfma_f32_16x16x32_bf16 v[40:43], v[8:11], v[132:135], v[40:43]
    v_rcp_f32 v69, v69
    v_mul_f32 v83, v83, v67
    v_mfma_f32_16x16x32_bf16 v[36:39], v[12:15], v[128:131], v[36:39]
    ds_read_b128 a[252:255], v6 offset:13312
    v_cvt_pk_bf16_f32 v64, v80, v81
    v_mul_f32 v76, v76, v25
    v_mfma_f32_16x16x32_bf16 v[44:47], v[12:15], v[132:135], v[44:47]
    v_exp_f32 v74, v74
    s_waitcnt lgkmcnt(2)
    v_mfma_f32_16x16x32_bf16 v[48:51], a[240:243], v[128:131], v[48:51]
    ds_read_b128 v[8:11], v6 offset:14336
    v_fma_f32 v72, v72, v27, v27
    v_mfma_f32_16x16x32_bf16 v[56:59], a[240:243], v[132:135], v[56:59]
    v_rcp_f32 v70, v70
    v_mul_f32 v84, v84, v68
    v_mfma_f32_16x16x32_bf16 v[52:55], a[244:247], v[128:131], v[52:55]
    ds_read_b128 v[12:15], v6 offset:15360
    v_mul_f32 v77, v77, v25
    v_mfma_f32_16x16x32_bf16 v[60:63], a[244:247], v[132:135], v[60:63]
    v_exp_f32 v75, v75
    s_waitcnt vmcnt(0)
    s_barrier
    s_cmp_lg_u32 s3, 0
    s_cbranch_scc1 Lw_prompt_115
    s_add_u32 s21, s64, 35652224
    s_mov_b64 exec, 1
    buffer_atomic_add v31, v30, s[4:7], s21 offen sc1
    s_mov_b64 exec, -1
Lw_prompt_115:
    s_waitcnt lgkmcnt(2)
    v_mfma_f32_16x16x32_bf16 v[32:35], a[248:251], v[136:139], v[32:35]
    ds_read_b128 a[240:243], v4 offset:0
    v_fma_f32 v73, v73, v27, v27
    v_mfma_f32_16x16x32_bf16 v[40:43], a[248:251], v[140:143], v[40:43]
    v_rcp_f32 v71, v71
    v_mul_f32 v85, v85, v69
    v_mfma_f32_16x16x32_bf16 v[36:39], a[252:255], v[136:139], v[36:39]
    ds_read_b128 a[244:247], v4 offset:1024
    v_cvt_pk_bf16_f32 v65, v82, v83
    v_mul_f32 v78, v78, v25
    v_mfma_f32_16x16x32_bf16 v[44:47], a[252:255], v[140:143], v[44:47]
    v_exp_f32 v76, v76
    s_waitcnt lgkmcnt(2)
    v_mfma_f32_16x16x32_bf16 v[48:51], v[8:11], v[136:139], v[48:51]
    ds_read_b128 a[248:251], v4 offset:2048
    v_fma_f32 v74, v74, v27, v27
    v_mfma_f32_16x16x32_bf16 v[56:59], v[8:11], v[140:143], v[56:59]
    v_rcp_f32 v72, v72
    v_mul_f32 v86, v86, v70
    v_mfma_f32_16x16x32_bf16 v[52:55], v[12:15], v[136:139], v[52:55]
    ds_read_b128 a[252:255], v4 offset:3072
    v_mul_f32 v79, v79, v25
    v_mfma_f32_16x16x32_bf16 v[60:63], v[12:15], v[140:143], v[60:63]
    v_exp_f32 v77, v77
    s_waitcnt lgkmcnt(2)
    v_mfma_f32_16x16x32_bf16 v[32:35], a[240:243], v[144:147], v[32:35]
    ds_read_b128 v[8:11], v4 offset:4096
    v_fma_f32 v75, v75, v27, v27
    v_mfma_f32_16x16x32_bf16 v[40:43], a[240:243], v[148:151], v[40:43]
    v_rcp_f32 v73, v73
    v_mul_f32 v87, v87, v71
    v_mfma_f32_16x16x32_bf16 v[36:39], a[244:247], v[144:147], v[36:39]
    ds_read_b128 v[12:15], v4 offset:5120
    v_cvt_pk_bf16_f32 v66, v84, v85
    v_mfma_f32_16x16x32_bf16 v[44:47], a[244:247], v[148:151], v[44:47]
    v_exp_f32 v78, v78
    s_waitcnt lgkmcnt(2)
    v_mfma_f32_16x16x32_bf16 v[48:51], a[248:251], v[144:147], v[48:51]
    ds_read_b128 a[240:243], v4 offset:6144
    v_fma_f32 v76, v76, v27, v27
    v_mfma_f32_16x16x32_bf16 v[56:59], a[248:251], v[148:151], v[56:59]
    v_rcp_f32 v74, v74
    v_mul_f32 v88, v88, v72
    v_mfma_f32_16x16x32_bf16 v[52:55], a[252:255], v[144:147], v[52:55]
    ds_read_b128 a[244:247], v4 offset:7168
    v_exp_f32 v79, v79
    v_mfma_f32_16x16x32_bf16 v[60:63], a[252:255], v[148:151], v[60:63]
    v_fma_f32 v77, v77, v27, v27
    s_waitcnt lgkmcnt(2)
    v_mfma_f32_16x16x32_bf16 v[32:35], v[8:11], v[152:155], v[32:35]
    ds_read_b128 a[248:251], v4 offset:8192
    v_rcp_f32 v75, v75
    v_mfma_f32_16x16x32_bf16 v[40:43], v[8:11], v[156:159], v[40:43]
    v_mul_f32 v89, v89, v73
    v_cvt_pk_bf16_f32 v67, v86, v87
    buffer_store_dwordx4 v[64:67], v4, s[4:7], s27 offen offset:1024 sc1
    v_mfma_f32_16x16x32_bf16 v[36:39], v[12:15], v[152:155], v[36:39]
    ds_read_b128 a[252:255], v4 offset:9216
    v_fma_f32 v78, v78, v27, v27
    v_mfma_f32_16x16x32_bf16 v[44:47], v[12:15], v[156:159], v[44:47]
    v_rcp_f32 v76, v76
    s_waitcnt lgkmcnt(2)
    v_mfma_f32_16x16x32_bf16 v[48:51], a[240:243], v[152:155], v[48:51]
    ds_read_b128 v[8:11], v4 offset:10240
    v_mul_f32 v90, v90, v74
    v_fma_f32 v79, v79, v27, v27
    v_mfma_f32_16x16x32_bf16 v[56:59], a[240:243], v[156:159], v[56:59]
    v_rcp_f32 v77, v77
    v_mul_f32 v91, v91, v75
    v_mfma_f32_16x16x32_bf16 v[52:55], a[244:247], v[152:155], v[52:55]
    ds_read_b128 v[12:15], v4 offset:11264
    v_cvt_pk_bf16_f32 v68, v88, v89
    v_mfma_f32_16x16x32_bf16 v[60:63], a[244:247], v[156:159], v[60:63]
    v_rcp_f32 v78, v78
    s_waitcnt lgkmcnt(2)
    v_mfma_f32_16x16x32_bf16 v[32:35], a[248:251], v[160:163], v[32:35]
    ds_read_b128 a[240:243], v4 offset:12288
    v_mul_f32 v92, v92, v76
    v_mfma_f32_16x16x32_bf16 v[40:43], a[248:251], v[164:167], v[40:43]
    v_rcp_f32 v79, v79
    v_mul_f32 v93, v93, v77
    v_mfma_f32_16x16x32_bf16 v[36:39], a[252:255], v[160:163], v[36:39]
    ds_read_b128 a[244:247], v4 offset:13312
    v_cvt_pk_bf16_f32 v69, v90, v91
    v_mul_f32 v94, v94, v78
    v_mfma_f32_16x16x32_bf16 v[44:47], a[252:255], v[164:167], v[44:47]
    v_mul_f32 v95, v95, v79
    v_cvt_pk_bf16_f32 v70, v92, v93
    s_waitcnt lgkmcnt(2)
    v_mfma_f32_16x16x32_bf16 v[48:51], v[8:11], v[160:163], v[48:51]
    ds_read_b128 a[248:251], v4 offset:14336
    v_cvt_pk_bf16_f32 v71, v94, v95
    buffer_store_dwordx4 v[68:71], v4, s[4:7], s15 offen offset:1024 sc1
    v_mfma_f32_16x16x32_bf16 v[56:59], v[8:11], v[164:167], v[56:59]
    v_mfma_f32_16x16x32_bf16 v[52:55], v[12:15], v[160:163], v[52:55]
    ds_read_b128 a[252:255], v4 offset:15360
    v_mfma_f32_16x16x32_bf16 v[60:63], v[12:15], v[164:167], v[60:63]
    s_waitcnt lgkmcnt(2)
    v_mfma_f32_16x16x32_bf16 v[32:35], a[240:243], v[168:171], v[32:35]
    ds_read_b128 v[8:11], v4 offset:16384
    v_mfma_f32_16x16x32_bf16 v[40:43], a[240:243], v[172:175], v[40:43]
    v_mfma_f32_16x16x32_bf16 v[36:39], a[244:247], v[168:171], v[36:39]
    ds_read_b128 v[12:15], v4 offset:17408
    v_mfma_f32_16x16x32_bf16 v[44:47], a[244:247], v[172:175], v[44:47]
    s_waitcnt lgkmcnt(2)
    v_mfma_f32_16x16x32_bf16 v[48:51], a[248:251], v[168:171], v[48:51]
    ds_read_b128 a[240:243], v4 offset:18432
    v_mfma_f32_16x16x32_bf16 v[56:59], a[248:251], v[172:175], v[56:59]
    v_mfma_f32_16x16x32_bf16 v[52:55], a[252:255], v[168:171], v[52:55]
    ds_read_b128 a[244:247], v4 offset:19456
    v_mfma_f32_16x16x32_bf16 v[60:63], a[252:255], v[172:175], v[60:63]
    s_waitcnt lgkmcnt(2)
    v_mfma_f32_16x16x32_bf16 v[32:35], v[8:11], v[176:179], v[32:35]
    ds_read_b128 a[248:251], v4 offset:20480
    v_mfma_f32_16x16x32_bf16 v[40:43], v[8:11], v[180:183], v[40:43]
    v_mfma_f32_16x16x32_bf16 v[36:39], v[12:15], v[176:179], v[36:39]
    ds_read_b128 a[252:255], v4 offset:21504
    v_mfma_f32_16x16x32_bf16 v[44:47], v[12:15], v[180:183], v[44:47]
    s_waitcnt lgkmcnt(2)
    v_mfma_f32_16x16x32_bf16 v[48:51], a[240:243], v[176:179], v[48:51]
    ds_read_b128 v[8:11], v4 offset:22528
    v_mfma_f32_16x16x32_bf16 v[56:59], a[240:243], v[180:183], v[56:59]
    v_mfma_f32_16x16x32_bf16 v[52:55], a[244:247], v[176:179], v[52:55]
    ds_read_b128 v[12:15], v4 offset:23552
    v_mfma_f32_16x16x32_bf16 v[60:63], a[244:247], v[180:183], v[60:63]
    s_waitcnt lgkmcnt(2)
    v_mfma_f32_16x16x32_bf16 v[32:35], a[248:251], v[184:187], v[32:35]
    ds_read_b128 a[240:243], v4 offset:24576
    v_mfma_f32_16x16x32_bf16 v[40:43], a[248:251], v[188:191], v[40:43]
    v_mfma_f32_16x16x32_bf16 v[36:39], a[252:255], v[184:187], v[36:39]
    ds_read_b128 a[244:247], v4 offset:25600
    v_mfma_f32_16x16x32_bf16 v[44:47], a[252:255], v[188:191], v[44:47]
    s_waitcnt lgkmcnt(2)
    v_mfma_f32_16x16x32_bf16 v[48:51], v[8:11], v[184:187], v[48:51]
    ds_read_b128 a[248:251], v4 offset:26624
    v_mfma_f32_16x16x32_bf16 v[56:59], v[8:11], v[188:191], v[56:59]
    v_mfma_f32_16x16x32_bf16 v[52:55], v[12:15], v[184:187], v[52:55]
    ds_read_b128 a[252:255], v4 offset:27648
    v_mfma_f32_16x16x32_bf16 v[60:63], v[12:15], v[188:191], v[60:63]
    s_waitcnt lgkmcnt(2)
    v_mfma_f32_16x16x32_bf16 v[32:35], a[240:243], v[192:195], v[32:35]
    ds_read_b128 v[8:11], v4 offset:28672
    v_mfma_f32_16x16x32_bf16 v[40:43], a[240:243], v[196:199], v[40:43]
    v_mfma_f32_16x16x32_bf16 v[36:39], a[244:247], v[192:195], v[36:39]
    ds_read_b128 v[12:15], v4 offset:29696
    v_mfma_f32_16x16x32_bf16 v[44:47], a[244:247], v[196:199], v[44:47]
    s_waitcnt lgkmcnt(2)
    v_mfma_f32_16x16x32_bf16 v[48:51], a[248:251], v[192:195], v[48:51]
    ds_read_b128 a[240:243], v4 offset:30720
    v_mfma_f32_16x16x32_bf16 v[56:59], a[248:251], v[196:199], v[56:59]
    v_mfma_f32_16x16x32_bf16 v[52:55], a[252:255], v[192:195], v[52:55]
    ds_read_b128 a[244:247], v4 offset:31744
    v_mfma_f32_16x16x32_bf16 v[60:63], a[252:255], v[196:199], v[60:63]
    s_cmp_lg_u32 s3, 3
    s_cbranch_scc1 Lw_prompt_116
    v_mov_b32 v0, 0
    s_add_u32 s21, s64, 35652224
    buffer_load_dword v0, v30, s[4:7], s21 offen sc1
Lw_prompt_116:
    s_waitcnt lgkmcnt(2)
    v_mfma_f32_16x16x32_bf16 v[32:35], v[8:11], v[200:203], v[32:35]
    ds_read_b128 a[248:251], v4 offset:32768
    v_mfma_f32_16x16x32_bf16 v[40:43], v[8:11], v[204:207], v[40:43]
    v_mfma_f32_16x16x32_bf16 v[36:39], v[12:15], v[200:203], v[36:39]
    ds_read_b128 a[252:255], v4 offset:33792
    v_mfma_f32_16x16x32_bf16 v[44:47], v[12:15], v[204:207], v[44:47]
    s_waitcnt lgkmcnt(2)
    v_mfma_f32_16x16x32_bf16 v[48:51], a[240:243], v[200:203], v[48:51]
    ds_read_b128 v[8:11], v4 offset:34816
    v_mfma_f32_16x16x32_bf16 v[56:59], a[240:243], v[204:207], v[56:59]
    v_mfma_f32_16x16x32_bf16 v[52:55], a[244:247], v[200:203], v[52:55]
    ds_read_b128 v[12:15], v4 offset:35840
    v_mfma_f32_16x16x32_bf16 v[60:63], a[244:247], v[204:207], v[60:63]
    s_waitcnt lgkmcnt(2)
    v_mfma_f32_16x16x32_bf16 v[32:35], a[248:251], v[208:211], v[32:35]
    ds_read_b128 a[240:243], v4 offset:36864
    v_mfma_f32_16x16x32_bf16 v[40:43], a[248:251], v[212:215], v[40:43]
    v_mfma_f32_16x16x32_bf16 v[36:39], a[252:255], v[208:211], v[36:39]
    ds_read_b128 a[244:247], v4 offset:37888
    v_mfma_f32_16x16x32_bf16 v[44:47], a[252:255], v[212:215], v[44:47]
    s_waitcnt lgkmcnt(2)
    v_mfma_f32_16x16x32_bf16 v[48:51], v[8:11], v[208:211], v[48:51]
    ds_read_b128 a[248:251], v4 offset:38912
    v_mfma_f32_16x16x32_bf16 v[56:59], v[8:11], v[212:215], v[56:59]
    v_mfma_f32_16x16x32_bf16 v[52:55], v[12:15], v[208:211], v[52:55]
    ds_read_b128 a[252:255], v4 offset:39936
    v_mfma_f32_16x16x32_bf16 v[60:63], v[12:15], v[212:215], v[60:63]
    s_waitcnt lgkmcnt(2)
    v_mfma_f32_16x16x32_bf16 v[32:35], a[240:243], v[216:219], v[32:35]
    ds_read_b128 v[8:11], v4 offset:40960
    v_mfma_f32_16x16x32_bf16 v[40:43], a[240:243], v[220:223], v[40:43]
    v_mfma_f32_16x16x32_bf16 v[36:39], a[244:247], v[216:219], v[36:39]
    ds_read_b128 v[12:15], v4 offset:41984
    v_mfma_f32_16x16x32_bf16 v[44:47], a[244:247], v[220:223], v[44:47]
    s_cmp_lg_u32 s3, 3
    s_cbranch_scc1 Lw_prompt_118
    s_waitcnt vmcnt(0)
    v_cmp_gt_u32 vcc, 16, v0
    s_cbranch_vccz Lq_prompt_117
    s_add_u32 s21, s64, 35652224
    s_mov_b32 s66, 0
Lp_prompt_119:
    buffer_load_dword v0, v30, s[4:7], s21 offen sc1
    s_add_u32 s66, s66, 1
    s_waitcnt vmcnt(0)
    v_cmp_gt_u32 vcc, 16, v0
    s_cbranch_vccz Lq_prompt_117
    s_cmp_lt_u32 s66, 0x40000
    s_cbranch_scc0 Lq_prompt_117
    s_sleep 4
    s_branch Lp_prompt_119
Lq_prompt_117:
Lw_prompt_118:
    s_waitcnt vmcnt(0)
    s_barrier
    s_cmp_lg_u32 s3, 0
    s_cbranch_scc1 Lw_prompt_120
    s_add_u32 s21, s64, 35652352
    s_mov_b64 exec, 1
    buffer_atomic_add v31, v30, s[4:7], s21 offen sc1
    s_mov_b64 exec, -1
Lw_prompt_120:
    s_waitcnt lgkmcnt(2)
    v_mfma_f32_16x16x32_bf16 v[48:51], a[248:251], v[216:219], v[48:51]
    ds_read_b128 a[240:243], v4 offset:43008
    v_mfma_f32_16x16x32_bf16 v[56:59], a[248:251], v[220:223], v[56:59]
    s_add_u32 s21, s61, s40
    buffer_load_dwordx4 v[116:119], v4, s[4:7], s21 offen offset:0 sc1
    v_mfma_f32_16x16x32_bf16 v[52:55], a[252:255], v[216:219], v[52:55]
    ds_read_b128 a[244:247], v4 offset:44032
    v_mfma_f32_16x16x32_bf16 v[60:63], a[252:255], v[220:223], v[60:63]
    s_waitcnt lgkmcnt(2)
    v_mfma_f32_16x16x32_bf16 v[32:35], v[8:11], v[224:227], v[32:35]
    ds_read_b128 a[248:251], v4 offset:45056
    v_mfma_f32_16x16x32_bf16 v[40:43], v[8:11], v[228:231], v[40:43]
    s_add_u32 s21, s62, s40
    buffer_load_dwordx4 v[120:123], v4, s[4:7], s21 offen offset:0 sc1
    v_mfma_f32_16x16x32_bf16 v[36:39], v[12:15], v[224:227], v[36:39]
    ds_read_b128 a[252:255], v4 offset:46080
    v_mfma_f32_16x16x32_bf16 v[44:47], v[12:15], v[228:231], v[44:47]
    s_waitcnt lgkmcnt(2)
    v_mfma_f32_16x16x32_bf16 v[48:51], a[240:243], v[224:227], v[48:51]
    ds_read_b128 v[8:11], v4 offset:47104
    v_mfma_f32_16x16x32_bf16 v[56:59], a[240:243], v[228:231], v[56:59]
    s_add_u32 s21, s63, s40
    buffer_load_dwordx4 v[124:127], v4, s[4:7], s21 offen offset:0 sc1
    v_mfma_f32_16x16x32_bf16 v[52:55], a[244:247], v[224:227], v[52:55]
    ds_read_b128 v[12:15], v4 offset:48128
    v_mfma_f32_16x16x32_bf16 v[60:63], a[244:247], v[228:231], v[60:63]
    s_waitcnt lgkmcnt(2)
    v_mfma_f32_16x16x32_bf16 v[32:35], a[248:251], v[232:235], v[32:35]
    ds_read_b128 a[240:243], v4 offset:49152
    v_mfma_f32_16x16x32_bf16 v[40:43], a[248:251], v[236:239], v[40:43]
    s_add_u32 s21, s60, s40
    buffer_load_dwordx4 v[112:115], v4, s[4:7], s21 offen offset:0 sc1
    v_mfma_f32_16x16x32_bf16 v[36:39], a[252:255], v[232:235], v[36:39]
    ds_read_b128 a[244:247], v4 offset:50176
    v_mfma_f32_16x16x32_bf16 v[44:47], a[252:255], v[236:239], v[44:47]
    s_waitcnt lgkmcnt(2)
    v_mfma_f32_16x16x32_bf16 v[48:51], v[8:11], v[232:235], v[48:51]
    ds_read_b128 a[248:251], v4 offset:51200
    v_mfma_f32_16x16x32_bf16 v[56:59], v[8:11], v[236:239], v[56:59]
    s_add_u32 s21, s61, s41
    buffer_load_dwordx4 v[132:135], v4, s[4:7], s21 offen offset:0 sc1
    v_mfma_f32_16x16x32_bf16 v[52:55], v[12:15], v[232:235], v[52:55]
    ds_read_b128 a[252:255], v4 offset:52224
    v_mfma_f32_16x16x32_bf16 v[60:63], v[12:15], v[236:239], v[60:63]
    s_waitcnt lgkmcnt(2)
    v_mfma_f32_16x16x32_bf16 v[32:35], a[240:243], v[240:243], v[32:35]
    ds_read_b128 v[8:11], v4 offset:53248
    v_mfma_f32_16x16x32_bf16 v[40:43], a[240:243], v[244:247], v[40:43]
    s_add_u32 s21, s62, s41
    buffer_load_dwordx4 v[136:139], v4, s[4:7], s21 offen offset:0 sc1
    v_mfma_f32_16x16x32_bf16 v[36:39], a[244:247], v[240:243], v[36:39]
    ds_read_b128 v[12:15], v4 offset:54272
    v_mfma_f32_16x16x32_bf16 v[44:47], a[244:247], v[244:247], v[44:47]
    s_waitcnt lgkmcnt(2)
    v_mfma_f32_16x16x32_bf16 v[48:51], a[248:251], v[240:243], v[48:51]
    ds_read_b128 a[240:243], v4 offset:55296
    v_mfma_f32_16x16x32_bf16 v[56:59], a[248:251], v[244:247], v[56:59]
    s_add_u32 s21, s63, s41
    buffer_load_dwordx4 v[140:143], v4, s[4:7], s21 offen offset:0 sc1
    v_mfma_f32_16x16x32_bf16 v[52:55], a[252:255], v[240:243], v[52:55]
    ds_read_b128 a[244:247], v4 offset:56320
    v_mfma_f32_16x16x32_bf16 v[60:63], a[252:255], v[244:247], v[60:63]
    s_waitcnt lgkmcnt(2)
    v_mfma_f32_16x16x32_bf16 v[32:35], v[8:11], v[248:251], v[32:35]
    ds_read_b128 a[248:251], v4 offset:57344
    v_mfma_f32_16x16x32_bf16 v[40:43], v[8:11], v[252:255], v[40:43]
    s_add_u32 s21, s60, s41
    buffer_load_dwordx4 v[128:131], v4, s[4:7], s21 offen offset:0 sc1
    v_mfma_f32_16x16x32_bf16 v[36:39], v[12:15], v[248:251], v[36:39]
    ds_read_b128 a[252:255], v4 offset:58368
    v_mfma_f32_16x16x32_bf16 v[44:47], v[12:15], v[252:255], v[44:47]
    s_waitcnt lgkmcnt(2)
    v_mfma_f32_16x16x32_bf16 v[48:51], a[240:243], v[248:251], v[48:51]
    ds_read_b128 v[8:11], v4 offset:59392
    v_mfma_f32_16x16x32_bf16 v[56:59], a[240:243], v[252:255], v[56:59]
    s_add_u32 s21, s61, s42
    buffer_load_dwordx4 v[148:151], v4, s[4:7], s21 offen offset:0 sc1
    v_mfma_f32_16x16x32_bf16 v[52:55], a[244:247], v[248:251], v[52:55]
    ds_read_b128 v[12:15], v4 offset:60416
    v_mfma_f32_16x16x32_bf16 v[60:63], a[244:247], v[252:255], v[60:63]
    s_waitcnt lgkmcnt(2)
    v_mfma_f32_16x16x32_bf16 v[32:35], a[248:251], v[16:19], v[32:35]
    v_mfma_f32_16x16x32_bf16 v[40:43], a[248:251], v[20:23], v[40:43]
    s_add_u32 s21, s62, s42
    buffer_load_dwordx4 v[152:155], v4, s[4:7], s21 offen offset:0 sc1
    v_mfma_f32_16x16x32_bf16 v[36:39], a[252:255], v[16:19], v[36:39]
    v_mfma_f32_16x16x32_bf16 v[44:47], a[252:255], v[20:23], v[44:47]
    s_waitcnt lgkmcnt(0)
    v_mfma_f32_16x16x32_bf16 v[48:51], v[8:11], v[16:19], v[48:51]
    v_mfma_f32_16x16x32_bf16 v[56:59], v[8:11], v[20:23], v[56:59]
    s_add_u32 s21, s63, s42
    buffer_load_dwordx4 v[156:159], v4, s[4:7], s21 offen offset:0 sc1
    v_mfma_f32_16x16x32_bf16 v[52:55], v[12:15], v[16:19], v[52:55]
    v_mfma_f32_16x16x32_bf16 v[60:63], v[12:15], v[20:23], v[60:63]
    v_pk_mul_f32 v[32:33], v[32:33], v[24:25] op_sel_hi:[1,0]
    s_add_u32 s21, s60, s42
    buffer_load_dwordx4 v[144:147], v4, s[4:7], s21 offen offset:0 sc1
    v_pk_mul_f32 v[34:35], v[34:35], v[24:25] op_sel_hi:[1,0]
    v_exp_f32 v32, v32
    v_exp_f32 v33, v33
    v_pk_mul_f32 v[36:37], v[36:37], v[24:25] op_sel_hi:[1,0]
    v_exp_f32 v34, v34
    v_exp_f32 v35, v35
    s_add_u32 s21, s61, s43
    buffer_load_dwordx4 v[164:167], v4, s[4:7], s21 offen offset:0 sc1
    v_pk_fma_f32 v[32:33], v[32:33], v[26:27], v[26:27] op_sel_hi:[1,0,0]
    v_pk_mul_f32 v[38:39], v[38:39], v[24:25] op_sel_hi:[1,0]
    v_exp_f32 v36, v36
    v_exp_f32 v37, v37
    v_pk_fma_f32 v[34:35], v[34:35], v[26:27], v[26:27] op_sel_hi:[1,0,0]
    v_rcp_f32 v32, v32
    s_add_u32 s21, s62, s43
    buffer_load_dwordx4 v[168:171], v4, s[4:7], s21 offen offset:0 sc1
    v_rcp_f32 v33, v33
    v_pk_mul_f32 v[40:41], v[40:41], v[24:25] op_sel:[0,1]
    v_exp_f32 v38, v38
    v_exp_f32 v39, v39
    v_pk_fma_f32 v[36:37], v[36:37], v[26:27], v[26:27] op_sel_hi:[1,0,0]
    v_rcp_f32 v34, v34
    s_add_u32 s21, s63, s43
    buffer_load_dwordx4 v[172:175], v4, s[4:7], s21 offen offset:0 sc1
    v_rcp_f32 v35, v35
    v_pk_mul_f32 v[48:49], v[48:49], v[32:33]
    v_pk_mul_f32 v[42:43], v[42:43], v[24:25] op_sel:[0,1]
    v_exp_f32 v40, v40
    v_exp_f32 v41, v41
    v_pk_fma_f32 v[38:39], v[38:39], v[26:27], v[26:27] op_sel_hi:[1,0,0]
    s_add_u32 s21, s60, s43
    buffer_load_dwordx4 v[160:163], v4, s[4:7], s21 offen offset:0 sc1
    v_rcp_f32 v36, v36
    v_rcp_f32 v37, v37
    v_pk_mul_f32 v[50:51], v[50:51], v[34:35]
    v_cvt_pk_bf16_f32 v32, v48, v49
    v_pk_mul_f32 v[44:45], v[44:45], v[24:25] op_sel:[0,1]
    v_exp_f32 v42, v42
    v_exp_f32 v43, v43
    v_pk_fma_f32 v[40:41], v[40:41], v[26:27], v[26:27] op_sel:[0,1,1]
    v_rcp_f32 v38, v38
    v_rcp_f32 v39, v39
    v_pk_mul_f32 v[52:53], v[52:53], v[36:37]
    v_cvt_pk_bf16_f32 v33, v50, v51
    s_cmp_lg_u32 s3, 3
    s_cbranch_scc1 Lw_prompt_121
    v_mov_b32 v0, 0
    s_add_u32 s21, s64, 35652352
    buffer_load_dword v0, v30, s[4:7], s21 offen sc1
Lw_prompt_121:
    v_pk_mul_f32 v[46:47], v[46:47], v[24:25] op_sel:[0,1]
    v_exp_f32 v44, v44
    v_exp_f32 v45, v45
    v_pk_fma_f32 v[42:43], v[42:43], v[26:27], v[26:27] op_sel:[0,1,1]
    v_rcp_f32 v40, v40
    v_rcp_f32 v41, v41
    v_pk_mul_f32 v[54:55], v[54:55], v[38:39]
    v_cvt_pk_bf16_f32 v34, v52, v53
    v_exp_f32 v46, v46
    v_exp_f32 v47, v47
    v_pk_fma_f32 v[44:45], v[44:45], v[26:27], v[26:27] op_sel:[0,1,1]
    v_rcp_f32 v42, v42
    v_rcp_f32 v43, v43
    v_pk_mul_f32 v[56:57], v[56:57], v[40:41]
    v_cvt_pk_bf16_f32 v35, v54, v55
    buffer_store_dwordx4 v[32:35], v4, s[4:7], s27 offen offset:2048 sc1
    v_pk_fma_f32 v[46:47], v[46:47], v[26:27], v[26:27] op_sel:[0,1,1]
    v_rcp_f32 v44, v44
    v_rcp_f32 v45, v45
    v_pk_mul_f32 v[58:59], v[58:59], v[42:43]
    v_cvt_pk_bf16_f32 v36, v56, v57
    v_rcp_f32 v46, v46
    v_rcp_f32 v47, v47
    v_pk_mul_f32 v[60:61], v[60:61], v[44:45]
    v_cvt_pk_bf16_f32 v37, v58, v59
    v_pk_mul_f32 v[62:63], v[62:63], v[46:47]
    v_cvt_pk_bf16_f32 v38, v60, v61
    v_cvt_pk_bf16_f32 v39, v62, v63
    buffer_store_dwordx4 v[36:39], v4, s[4:7], s15 offen offset:2048 sc1
    s_waitcnt vmcnt(17)
    v_mfma_f32_16x16x32_bf16 v[52:55], a[0:3], v[116:119], 0
    s_lshr_b32 s23, s17, 1
    s_lshr_b32 s27, s3, 1
    v_mfma_f32_16x16x32_bf16 v[56:59], a[4:7], v[116:119], 0
    s_lshl_b32 s27, s27, 5
    s_add_u32 s27, s27, s24
    v_mfma_f32_16x16x32_bf16 v[60:63], a[8:11], v[116:119], 0
    s_and_b32 s28, s3, 1
    s_lshl_b32 s28, s28, 4
    v_mfma_f32_16x16x32_bf16 v[64:67], a[12:15], v[116:119], 0
    v_and_b32 v5, 15, v1
    v_add_u32 v5, s28, v5
    v_mfma_f32_16x16x32_bf16 v[68:71], a[16:19], v[116:119], 0
    v_bfe_u32 v6, v1, 4, 1
    v_lshlrev_b32 v7, 4, v5
    s_waitcnt vmcnt(16)
    v_mfma_f32_16x16x32_bf16 v[72:75], a[0:3], v[120:123], 0
    v_and_b32 v8, 15, v1
    v_lshlrev_b32 v8, 4, v8
    v_mfma_f32_16x16x32_bf16 v[76:79], a[4:7], v[120:123], 0
    v_lshl_add_u32 v8, v6, 8, v8
    v_lshl_add_u32 v8, v3, 3, v8
    v_mfma_f32_16x16x32_bf16 v[80:83], a[8:11], v[120:123], 0
    s_mul_i32 s29, s27, 40960
    s_mul_i32 s30, s28, 1280
    v_mfma_f32_16x16x32_bf16 v[84:87], a[12:15], v[120:123], 0
    s_add_u32 s30, s30, s29
    s_mul_i32 s31, s23, 2560
    v_mfma_f32_16x16x32_bf16 v[88:91], a[16:19], v[120:123], 0
    s_add_u32 s30, s30, s31
    s_add_u32 s30, s30, 13631488
    s_waitcnt vmcnt(15)
    v_mfma_f32_16x16x32_bf16 v[92:95], a[0:3], v[124:127], 0
    s_lshl_b32 s31, s31, 1
    s_add_u32 s29, s29, s31
    v_mfma_f32_16x16x32_bf16 v[96:99], a[4:7], v[124:127], 0
    buffer_load_dwordx2 v[14:15], v8, s[4:7], s30 offen offset:0 sc1
    buffer_load_dwordx2 v[16:17], v8, s[4:7], s30 offen offset:512 sc1
    v_mfma_f32_16x16x32_bf16 v[100:103], a[8:11], v[124:127], 0
    buffer_load_dwordx2 v[18:19], v8, s[4:7], s30 offen offset:1024 sc1
    buffer_load_dwordx2 v[20:21], v8, s[4:7], s30 offen offset:1536 sc1
    v_mfma_f32_16x16x32_bf16 v[104:107], a[12:15], v[124:127], 0
    buffer_load_dwordx2 v[22:23], v8, s[4:7], s30 offen offset:2048 sc1
    s_mov_b32 s8, s50
    v_mfma_f32_16x16x32_bf16 v[108:111], a[16:19], v[124:127], 0
    s_mov_b32 s9, s51
    s_mov_b32 s10, 2621440
    s_waitcnt vmcnt(19)
    v_mfma_f32_16x16x32_bf16 v[32:35], a[0:3], v[112:115], 0
    s_mov_b32 s11, 0x20000
    v_lshl_add_u32 v9, v5, 6, s27
    s_cmp_lg_u32 s3, 3
    s_cbranch_scc1 Lw_prompt_123
    s_waitcnt vmcnt(7)
    v_cmp_gt_u32 vcc, 16, v0
    s_cbranch_vccz Lq_prompt_122
    s_add_u32 s21, s64, 35652352
    s_mov_b32 s66, 0
Lp_prompt_124:
    buffer_load_dword v0, v30, s[4:7], s21 offen sc1
    s_add_u32 s66, s66, 1
    s_waitcnt vmcnt(0)
    v_cmp_gt_u32 vcc, 16, v0
    s_cbranch_vccz Lq_prompt_122
    s_cmp_lt_u32 s66, 0x40000
    s_cbranch_scc0 Lq_prompt_122
    s_sleep 4
    s_branch Lp_prompt_124
Lq_prompt_122:
Lw_prompt_123:
    s_barrier
    v_mfma_f32_16x16x32_bf16 v[36:39], a[4:7], v[112:115], 0
    s_add_u32 s21, s61, s40
    buffer_load_dwordx4 v[180:183], v4, s[4:7], s21 offen offset:1024 sc1
    v_mfma_f32_16x16x32_bf16 v[40:43], a[8:11], v[112:115], 0
    v_mul_u32_u24 v9, 1280, v9
    v_lshl_add_u32 v9, v6, 5, v9
    v_mfma_f32_16x16x32_bf16 v[44:47], a[12:15], v[112:115], 0
    v_lshl_add_u32 v9, v3, 4, v9
    s_mul_i32 s30, s23, 160
    v_mfma_f32_16x16x32_bf16 v[48:51], a[16:19], v[112:115], 0
    s_add_u32 s21, s62, s40
    buffer_load_dwordx4 v[184:187], v4, s[4:7], s21 offen offset:1024 sc1
    s_waitcnt vmcnt(20)
    v_mfma_f32_16x16x32_bf16 v[52:55], a[20:23], v[132:135], v[52:55]
    s_xor_b32 s27, s3, 1
    s_mul_i32 s27, s27, 15360
    v_mfma_f32_16x16x32_bf16 v[56:59], a[24:27], v[132:135], v[56:59]
    s_add_u32 s27, s27, 81920
    v_add_u32 v11, s27, v4
    v_mfma_f32_16x16x32_bf16 v[60:63], a[28:31], v[132:135], v[60:63]
    s_add_u32 s21, s63, s40
    buffer_load_dwordx4 v[188:191], v4, s[4:7], s21 offen offset:1024 sc1
    v_mfma_f32_16x16x32_bf16 v[64:67], a[32:35], v[132:135], v[64:67]
    s_xor_b32 s27, s3, 2
    s_mul_i32 s27, s27, 15360
    v_mfma_f32_16x16x32_bf16 v[68:71], a[36:39], v[132:135], v[68:71]
    s_add_u32 s27, s27, 81920
    v_add_u32 v12, s27, v4
    s_waitcnt vmcnt(20)
    v_mfma_f32_16x16x32_bf16 v[72:75], a[20:23], v[136:139], v[72:75]
    s_add_u32 s21, s60, s40
    buffer_load_dwordx4 v[176:179], v4, s[4:7], s21 offen offset:1024 sc1
    v_mfma_f32_16x16x32_bf16 v[76:79], a[24:27], v[136:139], v[76:79]
    s_xor_b32 s27, s3, 3
    s_mul_i32 s27, s27, 15360
    v_mfma_f32_16x16x32_bf16 v[80:83], a[28:31], v[136:139], v[80:83]
    s_add_u32 s27, s27, 81920
    v_add_u32 v13, s27, v4
    v_mfma_f32_16x16x32_bf16 v[84:87], a[32:35], v[136:139], v[84:87]
    s_add_u32 s21, s61, s41
    buffer_load_dwordx4 v[196:199], v4, s[4:7], s21 offen offset:1024 sc1
    v_mfma_f32_16x16x32_bf16 v[88:91], a[36:39], v[136:139], v[88:91]
    s_mul_i32 s27, s3, 15360
    s_add_u32 s27, s27, 81920
    s_waitcnt vmcnt(21)
    v_mfma_f32_16x16x32_bf16 v[92:95], a[20:23], v[140:143], v[92:95]
    v_add_u32 v10, s27, v4
    v_mfma_f32_16x16x32_bf16 v[96:99], a[24:27], v[140:143], v[96:99]
    s_add_u32 s21, s62, s41
    buffer_load_dwordx4 v[200:203], v4, s[4:7], s21 offen offset:1024 sc1
    v_mfma_f32_16x16x32_bf16 v[100:103], a[28:31], v[140:143], v[100:103]
    v_mfma_f32_16x16x32_bf16 v[104:107], a[32:35], v[140:143], v[104:107]
    v_mfma_f32_16x16x32_bf16 v[108:111], a[36:39], v[140:143], v[108:111]
    s_add_u32 s21, s63, s41
    buffer_load_dwordx4 v[204:207], v4, s[4:7], s21 offen offset:1024 sc1
    s_waitcnt vmcnt(22)
    v_mfma_f32_16x16x32_bf16 v[32:35], a[20:23], v[128:131], v[32:35]
    s_waitcnt vmcnt(12)
    s_barrier
    s_cmp_lg_u32 s3, 0
    s_cbranch_scc1 Lw_prompt_125
    s_add_u32 s21, s64, 35652480
    s_mov_b64 exec, 1
    buffer_atomic_add v31, v30, s[4:7], s21 offen sc1
    s_mov_b64 exec, -1
Lw_prompt_125:
    v_mfma_f32_16x16x32_bf16 v[36:39], a[24:27], v[128:131], v[36:39]
    v_mfma_f32_16x16x32_bf16 v[40:43], a[28:31], v[128:131], v[40:43]
    s_add_u32 s21, s60, s41
    buffer_load_dwordx4 v[192:195], v4, s[4:7], s21 offen offset:1024 sc1
    v_mfma_f32_16x16x32_bf16 v[44:47], a[32:35], v[128:131], v[44:47]
    v_mfma_f32_16x16x32_bf16 v[48:51], a[36:39], v[128:131], v[48:51]
    v_mfma_f32_16x16x32_bf16 v[52:55], a[40:43], v[148:151], v[52:55]
    s_add_u32 s21, s61, s42
    buffer_load_dwordx4 v[212:215], v4, s[4:7], s21 offen offset:1024 sc1
    v_mfma_f32_16x16x32_bf16 v[56:59], a[44:47], v[148:151], v[56:59]
    v_mfma_f32_16x16x32_bf16 v[60:63], a[48:51], v[148:151], v[60:63]
    v_mfma_f32_16x16x32_bf16 v[64:67], a[52:55], v[148:151], v[64:67]
    s_add_u32 s21, s62, s42
    buffer_load_dwordx4 v[216:219], v4, s[4:7], s21 offen offset:1024 sc1
    v_mfma_f32_16x16x32_bf16 v[68:71], a[56:59], v[148:151], v[68:71]
    v_mfma_f32_16x16x32_bf16 v[72:75], a[40:43], v[152:155], v[72:75]
    v_mfma_f32_16x16x32_bf16 v[76:79], a[44:47], v[152:155], v[76:79]
    s_add_u32 s21, s63, s42
    buffer_load_dwordx4 v[220:223], v4, s[4:7], s21 offen offset:1024 sc1
    v_mfma_f32_16x16x32_bf16 v[80:83], a[48:51], v[152:155], v[80:83]
    v_mfma_f32_16x16x32_bf16 v[84:87], a[52:55], v[152:155], v[84:87]
    v_mfma_f32_16x16x32_bf16 v[88:91], a[56:59], v[152:155], v[88:91]
    s_add_u32 s21, s60, s42
    buffer_load_dwordx4 v[208:211], v4, s[4:7], s21 offen offset:1024 sc1
    v_mfma_f32_16x16x32_bf16 v[92:95], a[40:43], v[156:159], v[92:95]
    v_mfma_f32_16x16x32_bf16 v[96:99], a[44:47], v[156:159], v[96:99]
    v_mfma_f32_16x16x32_bf16 v[100:103], a[48:51], v[156:159], v[100:103]
    s_add_u32 s21, s61, s43
    buffer_load_dwordx4 v[228:231], v4, s[4:7], s21 offen offset:1024 sc1
    v_mfma_f32_16x16x32_bf16 v[104:107], a[52:55], v[156:159], v[104:107]
    v_mfma_f32_16x16x32_bf16 v[108:111], a[56:59], v[156:159], v[108:111]
    v_mfma_f32_16x16x32_bf16 v[32:35], a[40:43], v[144:147], v[32:35]
    s_add_u32 s21, s62, s43
    buffer_load_dwordx4 v[232:235], v4, s[4:7], s21 offen offset:1024 sc1
    v_mfma_f32_16x16x32_bf16 v[36:39], a[44:47], v[144:147], v[36:39]
    v_mfma_f32_16x16x32_bf16 v[40:43], a[48:51], v[144:147], v[40:43]
    v_mfma_f32_16x16x32_bf16 v[44:47], a[52:55], v[144:147], v[44:47]
    s_add_u32 s21, s63, s43
    buffer_load_dwordx4 v[236:239], v4, s[4:7], s21 offen offset:1024 sc1
    v_mfma_f32_16x16x32_bf16 v[48:51], a[56:59], v[144:147], v[48:51]
    v_mfma_f32_16x16x32_bf16 v[52:55], a[60:63], v[164:167], v[52:55]
    v_mfma_f32_16x16x32_bf16 v[56:59], a[64:67], v[164:167], v[56:59]
    s_add_u32 s21, s60, s43
    buffer_load_dwordx4 v[224:227], v4, s[4:7], s21 offen offset:1024 sc1
    v_mfma_f32_16x16x32_bf16 v[60:63], a[68:71], v[164:167], v[60:63]
    v_mfma_f32_16x16x32_bf16 v[64:67], a[72:75], v[164:167], v[64:67]
    v_mfma_f32_16x16x32_bf16 v[68:71], a[76:79], v[164:167], v[68:71]
    v_mfma_f32_16x16x32_bf16 v[72:75], a[60:63], v[168:171], v[72:75]
    v_mfma_f32_16x16x32_bf16 v[76:79], a[64:67], v[168:171], v[76:79]
    v_mfma_f32_16x16x32_bf16 v[80:83], a[68:71], v[168:171], v[80:83]
    v_mfma_f32_16x16x32_bf16 v[84:87], a[72:75], v[168:171], v[84:87]
    v_mfma_f32_16x16x32_bf16 v[88:91], a[76:79], v[168:171], v[88:91]
    v_mfma_f32_16x16x32_bf16 v[92:95], a[60:63], v[172:175], v[92:95]
    v_mfma_f32_16x16x32_bf16 v[96:99], a[64:67], v[172:175], v[96:99]
    v_mfma_f32_16x16x32_bf16 v[100:103], a[68:71], v[172:175], v[100:103]
    v_mfma_f32_16x16x32_bf16 v[104:107], a[72:75], v[172:175], v[104:107]
    v_mfma_f32_16x16x32_bf16 v[108:111], a[76:79], v[172:175], v[108:111]
    v_mfma_f32_16x16x32_bf16 v[32:35], a[60:63], v[160:163], v[32:35]
    v_mfma_f32_16x16x32_bf16 v[36:39], a[64:67], v[160:163], v[36:39]
    v_mfma_f32_16x16x32_bf16 v[40:43], a[68:71], v[160:163], v[40:43]
    v_mfma_f32_16x16x32_bf16 v[44:47], a[72:75], v[160:163], v[44:47]
    v_mfma_f32_16x16x32_bf16 v[48:51], a[76:79], v[160:163], v[48:51]
    s_waitcnt vmcnt(15)
    v_mfma_f32_16x16x32_bf16 v[52:55], a[80:83], v[180:183], v[52:55]
    v_mfma_f32_16x16x32_bf16 v[56:59], a[84:87], v[180:183], v[56:59]
    v_mfma_f32_16x16x32_bf16 v[60:63], a[88:91], v[180:183], v[60:63]
    v_mfma_f32_16x16x32_bf16 v[64:67], a[92:95], v[180:183], v[64:67]
    v_mfma_f32_16x16x32_bf16 v[68:71], a[96:99], v[180:183], v[68:71]
    s_waitcnt vmcnt(14)
    v_mfma_f32_16x16x32_bf16 v[72:75], a[80:83], v[184:187], v[72:75]
    v_mfma_f32_16x16x32_bf16 v[76:79], a[84:87], v[184:187], v[76:79]
    v_mfma_f32_16x16x32_bf16 v[80:83], a[88:91], v[184:187], v[80:83]
    s_cmp_lg_u32 s3, 3
    s_cbranch_scc1 Lw_prompt_126
    v_mov_b32 v0, 0
    s_add_u32 s21, s64, 35652480
    buffer_load_dword v0, v30, s[4:7], s21 offen sc1
Lw_prompt_126:
    v_mfma_f32_16x16x32_bf16 v[84:87], a[92:95], v[184:187], v[84:87]
    v_mfma_f32_16x16x32_bf16 v[88:91], a[96:99], v[184:187], v[88:91]
    s_waitcnt vmcnt(13)
    v_mfma_f32_16x16x32_bf16 v[92:95], a[80:83], v[188:191], v[92:95]
    v_mfma_f32_16x16x32_bf16 v[96:99], a[84:87], v[188:191], v[96:99]
    v_mfma_f32_16x16x32_bf16 v[100:103], a[88:91], v[188:191], v[100:103]
    v_mfma_f32_16x16x32_bf16 v[104:107], a[92:95], v[188:191], v[104:107]
    v_mfma_f32_16x16x32_bf16 v[108:111], a[96:99], v[188:191], v[108:111]
    s_waitcnt vmcnt(12)
    v_mfma_f32_16x16x32_bf16 v[32:35], a[80:83], v[176:179], v[32:35]
    v_mfma_f32_16x16x32_bf16 v[36:39], a[84:87], v[176:179], v[36:39]
    v_mfma_f32_16x16x32_bf16 v[40:43], a[88:91], v[176:179], v[40:43]
    v_mfma_f32_16x16x32_bf16 v[44:47], a[92:95], v[176:179], v[44:47]
    v_mfma_f32_16x16x32_bf16 v[48:51], a[96:99], v[176:179], v[48:51]
    s_cmp_lg_u32 s3, 3
    s_cbranch_scc1 Lw_prompt_128
    s_waitcnt vmcnt(0)
    v_cmp_gt_u32 vcc, 16, v0
    s_cbranch_vccz Lq_prompt_127
    s_add_u32 s21, s64, 35652480
    s_mov_b32 s66, 0
Lp_prompt_129:
    buffer_load_dword v0, v30, s[4:7], s21 offen sc1
    s_add_u32 s66, s66, 1
    s_waitcnt vmcnt(0)
    v_cmp_gt_u32 vcc, 16, v0
    s_cbranch_vccz Lq_prompt_127
    s_cmp_lt_u32 s66, 0x40000
    s_cbranch_scc0 Lq_prompt_127
    s_sleep 4
    s_branch Lp_prompt_129
Lq_prompt_127:
Lw_prompt_128:
    s_barrier
    s_waitcnt vmcnt(11)
    v_mfma_f32_16x16x32_bf16 v[52:55], a[100:103], v[196:199], v[52:55]
    s_add_u32 s21, s61, s40
    buffer_load_dwordx4 v[244:247], v4, s[4:7], s21 offen offset:2048 sc1
    v_mfma_f32_16x16x32_bf16 v[56:59], a[104:107], v[196:199], v[56:59]
    v_mfma_f32_16x16x32_bf16 v[60:63], a[108:111], v[196:199], v[60:63]
    v_mfma_f32_16x16x32_bf16 v[64:67], a[112:115], v[196:199], v[64:67]
    s_add_u32 s21, s61, s41
    buffer_load_dwordx4 v[116:119], v4, s[4:7], s21 offen offset:2048 sc1
    v_mfma_f32_16x16x32_bf16 v[68:71], a[116:119], v[196:199], v[68:71]
    s_waitcnt vmcnt(12)
    v_mfma_f32_16x16x32_bf16 v[72:75], a[100:103], v[200:203], v[72:75]
    v_mfma_f32_16x16x32_bf16 v[76:79], a[104:107], v[200:203], v[76:79]
    s_add_u32 s21, s61, s42
    buffer_load_dwordx4 v[132:135], v4, s[4:7], s21 offen offset:2048 sc1
    v_mfma_f32_16x16x32_bf16 v[80:83], a[108:111], v[200:203], v[80:83]
    v_mfma_f32_16x16x32_bf16 v[84:87], a[112:115], v[200:203], v[84:87]
    v_mfma_f32_16x16x32_bf16 v[88:91], a[116:119], v[200:203], v[88:91]
    s_add_u32 s21, s61, s43
    buffer_load_dwordx4 v[148:151], v4, s[4:7], s21 offen offset:2048 sc1
    s_waitcnt vmcnt(13)
    v_mfma_f32_16x16x32_bf16 v[92:95], a[100:103], v[204:207], v[92:95]
    v_mfma_f32_16x16x32_bf16 v[96:99], a[104:107], v[204:207], v[96:99]
    v_mfma_f32_16x16x32_bf16 v[100:103], a[108:111], v[204:207], v[100:103]
    s_add_u32 s21, s62, s40
    buffer_load_dwordx4 v[248:251], v4, s[4:7], s21 offen offset:2048 sc1
    v_mfma_f32_16x16x32_bf16 v[104:107], a[112:115], v[204:207], v[104:107]
    v_mfma_f32_16x16x32_bf16 v[108:111], a[116:119], v[204:207], v[108:111]
    s_waitcnt vmcnt(13)
    v_mfma_f32_16x16x32_bf16 v[32:35], a[100:103], v[192:195], v[32:35]
    s_add_u32 s21, s62, s41
    buffer_load_dwordx4 v[120:123], v4, s[4:7], s21 offen offset:2048 sc1
    v_mfma_f32_16x16x32_bf16 v[36:39], a[104:107], v[192:195], v[36:39]
    v_mfma_f32_16x16x32_bf16 v[40:43], a[108:111], v[192:195], v[40:43]
    v_mfma_f32_16x16x32_bf16 v[44:47], a[112:115], v[192:195], v[44:47]
    s_add_u32 s21, s62, s42
    buffer_load_dwordx4 v[136:139], v4, s[4:7], s21 offen offset:2048 sc1
    v_mfma_f32_16x16x32_bf16 v[48:51], a[116:119], v[192:195], v[48:51]
    s_waitcnt vmcnt(14)
    v_mfma_f32_16x16x32_bf16 v[52:55], a[120:123], v[212:215], v[52:55]
    v_mfma_f32_16x16x32_bf16 v[56:59], a[124:127], v[212:215], v[56:59]
    s_add_u32 s21, s62, s43
    buffer_load_dwordx4 v[152:155], v4, s[4:7], s21 offen offset:2048 sc1
    v_mfma_f32_16x16x32_bf16 v[60:63], a[128:131], v[212:215], v[60:63]
    v_mfma_f32_16x16x32_bf16 v[64:67], a[132:135], v[212:215], v[64:67]
    v_mfma_f32_16x16x32_bf16 v[68:71], a[136:139], v[212:215], v[68:71]
    s_add_u32 s21, s63, s40
    buffer_load_dwordx4 v[252:255], v4, s[4:7], s21 offen offset:2048 sc1
    s_waitcnt vmcnt(15)
    v_mfma_f32_16x16x32_bf16 v[72:75], a[120:123], v[216:219], v[72:75]
    v_mfma_f32_16x16x32_bf16 v[76:79], a[124:127], v[216:219], v[76:79]
    v_mfma_f32_16x16x32_bf16 v[80:83], a[128:131], v[216:219], v[80:83]
    s_add_u32 s21, s63, s41
    buffer_load_dwordx4 v[124:127], v4, s[4:7], s21 offen offset:2048 sc1
    v_mfma_f32_16x16x32_bf16 v[84:87], a[132:135], v[216:219], v[84:87]
    v_mfma_f32_16x16x32_bf16 v[88:91], a[136:139], v[216:219], v[88:91]
    s_waitcnt vmcnt(15)
    v_mfma_f32_16x16x32_bf16 v[92:95], a[120:123], v[220:223], v[92:95]
    s_add_u32 s21, s63, s42
    buffer_load_dwordx4 v[140:143], v4, s[4:7], s21 offen offset:2048 sc1
    v_mfma_f32_16x16x32_bf16 v[96:99], a[124:127], v[220:223], v[96:99]
    v_mfma_f32_16x16x32_bf16 v[100:103], a[128:131], v[220:223], v[100:103]
    v_mfma_f32_16x16x32_bf16 v[104:107], a[132:135], v[220:223], v[104:107]
    s_add_u32 s21, s63, s43
    buffer_load_dwordx4 v[156:159], v4, s[4:7], s21 offen offset:2048 sc1
    v_mfma_f32_16x16x32_bf16 v[108:111], a[136:139], v[220:223], v[108:111]
    s_waitcnt vmcnt(16)
    v_mfma_f32_16x16x32_bf16 v[32:35], a[120:123], v[208:211], v[32:35]
    v_mfma_f32_16x16x32_bf16 v[36:39], a[124:127], v[208:211], v[36:39]
    s_add_u32 s21, s60, s40
    buffer_load_dwordx4 v[240:243], v4, s[4:7], s21 offen offset:2048 sc1
    v_mfma_f32_16x16x32_bf16 v[40:43], a[128:131], v[208:211], v[40:43]
    v_mfma_f32_16x16x32_bf16 v[44:47], a[132:135], v[208:211], v[44:47]
    v_mfma_f32_16x16x32_bf16 v[48:51], a[136:139], v[208:211], v[48:51]
    s_add_u32 s21, s60, s41
    buffer_load_dwordx4 v[112:115], v4, s[4:7], s21 offen offset:2048 sc1
    s_waitcnt vmcnt(17)
    v_mfma_f32_16x16x32_bf16 v[52:55], a[140:143], v[228:231], v[52:55]
    v_mfma_f32_16x16x32_bf16 v[56:59], a[144:147], v[228:231], v[56:59]
    v_mfma_f32_16x16x32_bf16 v[60:63], a[148:151], v[228:231], v[60:63]
    s_add_u32 s21, s60, s42
    buffer_load_dwordx4 v[128:131], v4, s[4:7], s21 offen offset:2048 sc1
    v_mfma_f32_16x16x32_bf16 v[64:67], a[152:155], v[228:231], v[64:67]
    v_mfma_f32_16x16x32_bf16 v[68:71], a[156:159], v[228:231], v[68:71]
    s_waitcnt vmcnt(17)
    v_mfma_f32_16x16x32_bf16 v[72:75], a[140:143], v[232:235], v[72:75]
    s_add_u32 s21, s60, s43
    buffer_load_dwordx4 v[144:147], v4, s[4:7], s21 offen offset:2048 sc1
    v_mfma_f32_16x16x32_bf16 v[76:79], a[144:147], v[232:235], v[76:79]
    v_mfma_f32_16x16x32_bf16 v[80:83], a[148:151], v[232:235], v[80:83]
    v_mfma_f32_16x16x32_bf16 v[84:87], a[152:155], v[232:235], v[84:87]
    v_mfma_f32_16x16x32_bf16 v[88:91], a[156:159], v[232:235], v[88:91]
    s_waitcnt vmcnt(17)
    v_mfma_f32_16x16x32_bf16 v[92:95], a[140:143], v[236:239], v[92:95]
    v_mfma_f32_16x16x32_bf16 v[96:99], a[144:147], v[236:239], v[96:99]
    v_mfma_f32_16x16x32_bf16 v[100:103], a[148:151], v[236:239], v[100:103]
    v_mfma_f32_16x16x32_bf16 v[104:107], a[152:155], v[236:239], v[104:107]
    v_mfma_f32_16x16x32_bf16 v[108:111], a[156:159], v[236:239], v[108:111]
    s_waitcnt vmcnt(16)
    v_mfma_f32_16x16x32_bf16 v[32:35], a[140:143], v[224:227], v[32:35]
    v_mfma_f32_16x16x32_bf16 v[36:39], a[144:147], v[224:227], v[36:39]
    v_mfma_f32_16x16x32_bf16 v[40:43], a[148:151], v[224:227], v[40:43]
    v_mfma_f32_16x16x32_bf16 v[44:47], a[152:155], v[224:227], v[44:47]
    v_mfma_f32_16x16x32_bf16 v[48:51], a[156:159], v[224:227], v[48:51]
    s_waitcnt vmcnt(15)
    v_mfma_f32_16x16x32_bf16 v[52:55], a[160:163], v[244:247], v[52:55]
    v_mfma_f32_16x16x32_bf16 v[56:59], a[164:167], v[244:247], v[56:59]
    v_mfma_f32_16x16x32_bf16 v[60:63], a[168:171], v[244:247], v[60:63]
    v_mfma_f32_16x16x32_bf16 v[64:67], a[172:175], v[244:247], v[64:67]
    v_mfma_f32_16x16x32_bf16 v[68:71], a[176:179], v[244:247], v[68:71]
    s_waitcnt vmcnt(14)
    v_mfma_f32_16x16x32_bf16 v[52:55], a[180:183], v[116:119], v[52:55]
    v_mfma_f32_16x16x32_bf16 v[56:59], a[184:187], v[116:119], v[56:59]
    v_mfma_f32_16x16x32_bf16 v[60:63], a[188:191], v[116:119], v[60:63]
    v_mfma_f32_16x16x32_bf16 v[64:67], a[192:195], v[116:119], v[64:67]
    v_mfma_f32_16x16x32_bf16 v[68:71], a[196:199], v[116:119], v[68:71]
    s_waitcnt vmcnt(13)
    v_mfma_f32_16x16x32_bf16 v[52:55], a[200:203], v[132:135], v[52:55]
    v_mfma_f32_16x16x32_bf16 v[56:59], a[204:207], v[132:135], v[56:59]
    v_mfma_f32_16x16x32_bf16 v[60:63], a[208:211], v[132:135], v[60:63]
    v_mfma_f32_16x16x32_bf16 v[64:67], a[212:215], v[132:135], v[64:67]
    v_mfma_f32_16x16x32_bf16 v[68:71], a[216:219], v[132:135], v[68:71]
    s_waitcnt vmcnt(12)
    v_mfma_f32_16x16x32_bf16 v[52:55], a[220:223], v[148:151], v[52:55]
    v_mfma_f32_16x16x32_bf16 v[56:59], a[224:227], v[148:151], v[56:59]
    v_mfma_f32_16x16x32_bf16 v[60:63], a[228:231], v[148:151], v[60:63]
    v_mfma_f32_16x16x32_bf16 v[64:67], a[232:235], v[148:151], v[64:67]
    v_mfma_f32_16x16x32_bf16 v[68:71], a[236:239], v[148:151], v[68:71]
    s_waitcnt vmcnt(11)
    v_mfma_f32_16x16x32_bf16 v[72:75], a[160:163], v[248:251], v[72:75]
    v_mfma_f32_16x16x32_bf16 v[76:79], a[164:167], v[248:251], v[76:79]
    v_mfma_f32_16x16x32_bf16 v[80:83], a[168:171], v[248:251], v[80:83]
    v_mfma_f32_16x16x32_bf16 v[84:87], a[172:175], v[248:251], v[84:87]
    v_mfma_f32_16x16x32_bf16 v[88:91], a[176:179], v[248:251], v[88:91]
    s_waitcnt vmcnt(10)
    v_mfma_f32_16x16x32_bf16 v[72:75], a[180:183], v[120:123], v[72:75]
    v_mfma_f32_16x16x32_bf16 v[76:79], a[184:187], v[120:123], v[76:79]
    ds_write_b128 v11, v[52:55] offset:0
    v_mfma_f32_16x16x32_bf16 v[80:83], a[188:191], v[120:123], v[80:83]
    v_mfma_f32_16x16x32_bf16 v[84:87], a[192:195], v[120:123], v[84:87]
    v_mfma_f32_16x16x32_bf16 v[88:91], a[196:199], v[120:123], v[88:91]
    ds_write_b128 v11, v[56:59] offset:1024
    s_waitcnt vmcnt(9)
    v_mfma_f32_16x16x32_bf16 v[72:75], a[200:203], v[136:139], v[72:75]
    v_mfma_f32_16x16x32_bf16 v[76:79], a[204:207], v[136:139], v[76:79]
    v_mfma_f32_16x16x32_bf16 v[80:83], a[208:211], v[136:139], v[80:83]
    ds_write_b128 v11, v[60:63] offset:2048
    v_mfma_f32_16x16x32_bf16 v[84:87], a[212:215], v[136:139], v[84:87]
    v_mfma_f32_16x16x32_bf16 v[88:91], a[216:219], v[136:139], v[88:91]
    s_waitcnt vmcnt(8)
    v_mfma_f32_16x16x32_bf16 v[72:75], a[220:223], v[152:155], v[72:75]
    ds_write_b128 v11, v[64:67] offset:3072
    v_mfma_f32_16x16x32_bf16 v[76:79], a[224:227], v[152:155], v[76:79]
    v_mfma_f32_16x16x32_bf16 v[80:83], a[228:231], v[152:155], v[80:83]
    v_mfma_f32_16x16x32_bf16 v[84:87], a[232:235], v[152:155], v[84:87]
    ds_write_b128 v11, v[68:71] offset:4096
    v_mfma_f32_16x16x32_bf16 v[88:91], a[236:239], v[152:155], v[88:91]
    s_waitcnt vmcnt(7)
    v_mfma_f32_16x16x32_bf16 v[92:95], a[160:163], v[252:255], v[92:95]
    v_lshlrev_b32 v176, 16, v14
    v_and_b32 v177, 0xffff0000, v14
    v_mfma_f32_16x16x32_bf16 v[96:99], a[164:167], v[252:255], v[96:99]
    v_lshlrev_b32 v178, 16, v15
    v_and_b32 v179, 0xffff0000, v15
    v_mfma_f32_16x16x32_bf16 v[100:103], a[168:171], v[252:255], v[100:103]
    v_lshlrev_b32 v180, 16, v16
    v_and_b32 v181, 0xffff0000, v16
    v_mfma_f32_16x16x32_bf16 v[104:107], a[172:175], v[252:255], v[104:107]
    v_lshlrev_b32 v182, 16, v17
    v_and_b32 v183, 0xffff0000, v17
    v_mfma_f32_16x16x32_bf16 v[108:111], a[176:179], v[252:255], v[108:111]
    ds_write_b128 v12, v[72:75] offset:5120
    v_lshlrev_b32 v184, 16, v18
    s_waitcnt vmcnt(6)
    v_mfma_f32_16x16x32_bf16 v[92:95], a[180:183], v[124:127], v[92:95]
    v_and_b32 v185, 0xffff0000, v18
    v_lshlrev_b32 v186, 16, v19
    v_mfma_f32_16x16x32_bf16 v[96:99], a[184:187], v[124:127], v[96:99]
    v_and_b32 v187, 0xffff0000, v19
    v_lshlrev_b32 v188, 16, v20
    v_mfma_f32_16x16x32_bf16 v[100:103], a[188:191], v[124:127], v[100:103]
    ds_write_b128 v12, v[76:79] offset:6144
    v_and_b32 v189, 0xffff0000, v20
    v_mfma_f32_16x16x32_bf16 v[104:107], a[192:195], v[124:127], v[104:107]
    v_lshlrev_b32 v190, 16, v21
    v_and_b32 v191, 0xffff0000, v21
    v_mfma_f32_16x16x32_bf16 v[108:111], a[196:199], v[124:127], v[108:111]
    v_lshlrev_b32 v192, 16, v22
    v_and_b32 v193, 0xffff0000, v22
    s_waitcnt vmcnt(5)
    v_mfma_f32_16x16x32_bf16 v[92:95], a[200:203], v[140:143], v[92:95]
    ds_write_b128 v12, v[80:83] offset:7168
    v_lshlrev_b32 v194, 16, v23
    v_mfma_f32_16x16x32_bf16 v[96:99], a[204:207], v[140:143], v[96:99]
    v_and_b32 v195, 0xffff0000, v23
    v_mfma_f32_16x16x32_bf16 v[100:103], a[208:211], v[140:143], v[100:103]
    v_mfma_f32_16x16x32_bf16 v[104:107], a[212:215], v[140:143], v[104:107]
    ds_write_b128 v12, v[84:87] offset:8192
    v_mfma_f32_16x16x32_bf16 v[108:111], a[216:219], v[140:143], v[108:111]
    s_waitcnt vmcnt(4)
    v_mfma_f32_16x16x32_bf16 v[92:95], a[220:223], v[156:159], v[92:95]
    v_mfma_f32_16x16x32_bf16 v[96:99], a[224:227], v[156:159], v[96:99]
    ds_write_b128 v12, v[88:91] offset:9216
    v_mfma_f32_16x16x32_bf16 v[100:103], a[228:231], v[156:159], v[100:103]
    v_mfma_f32_16x16x32_bf16 v[104:107], a[232:235], v[156:159], v[104:107]
    v_mfma_f32_16x16x32_bf16 v[108:111], a[236:239], v[156:159], v[108:111]
    s_waitcnt vmcnt(3)
    v_mfma_f32_16x16x32_bf16 v[32:35], a[160:163], v[240:243], v[32:35]
    v_mfma_f32_16x16x32_bf16 v[36:39], a[164:167], v[240:243], v[36:39]
    v_mfma_f32_16x16x32_bf16 v[40:43], a[168:171], v[240:243], v[40:43]
    v_mfma_f32_16x16x32_bf16 v[44:47], a[172:175], v[240:243], v[44:47]
    v_mfma_f32_16x16x32_bf16 v[48:51], a[176:179], v[240:243], v[48:51]
    s_waitcnt vmcnt(2)
    v_mfma_f32_16x16x32_bf16 v[32:35], a[180:183], v[112:115], v[32:35]
    ds_write_b128 v13, v[92:95] offset:10240
    v_mfma_f32_16x16x32_bf16 v[36:39], a[184:187], v[112:115], v[36:39]
    v_mfma_f32_16x16x32_bf16 v[40:43], a[188:191], v[112:115], v[40:43]
    v_mfma_f32_16x16x32_bf16 v[44:47], a[192:195], v[112:115], v[44:47]
    ds_write_b128 v13, v[96:99] offset:11264
    v_mfma_f32_16x16x32_bf16 v[48:51], a[196:199], v[112:115], v[48:51]
    s_waitcnt vmcnt(1)
    v_mfma_f32_16x16x32_bf16 v[32:35], a[200:203], v[128:131], v[32:35]
    v_mfma_f32_16x16x32_bf16 v[36:39], a[204:207], v[128:131], v[36:39]
    ds_write_b128 v13, v[100:103] offset:12288
    v_mfma_f32_16x16x32_bf16 v[40:43], a[208:211], v[128:131], v[40:43]
    v_mfma_f32_16x16x32_bf16 v[44:47], a[212:215], v[128:131], v[44:47]
    v_mfma_f32_16x16x32_bf16 v[48:51], a[216:219], v[128:131], v[48:51]
    ds_write_b128 v13, v[104:107] offset:13312
    s_waitcnt vmcnt(0)
    v_mfma_f32_16x16x32_bf16 v[32:35], a[220:223], v[144:147], v[32:35]
    v_mfma_f32_16x16x32_bf16 v[36:39], a[224:227], v[144:147], v[36:39]
    v_mfma_f32_16x16x32_bf16 v[40:43], a[228:231], v[144:147], v[40:43]
    ds_write_b128 v13, v[108:111] offset:14336
    v_mfma_f32_16x16x32_bf16 v[44:47], a[232:235], v[144:147], v[44:47]
    v_mfma_f32_16x16x32_bf16 v[48:51], a[236:239], v[144:147], v[48:51]
    s_waitcnt lgkmcnt(0)
    s_barrier
    ds_read_b128 v[196:199], v10 offset:0
    ds_read_b128 v[200:203], v10 offset:5120
    ds_read_b128 v[204:207], v10 offset:10240
    ds_read_b128 v[208:211], v10 offset:1024
    ds_read_b128 v[212:215], v10 offset:6144
    ds_read_b128 v[216:219], v10 offset:11264
    ds_read_b128 v[220:223], v10 offset:2048
    ds_read_b128 v[224:227], v10 offset:7168
    ds_read_b128 v[228:231], v10 offset:12288
    ds_read_b128 v[232:235], v10 offset:3072
    ds_read_b128 v[236:239], v10 offset:8192
    ds_read_b128 v[240:243], v10 offset:13312
    ds_read_b128 v[244:247], v10 offset:4096
    ds_read_b128 v[248:251], v10 offset:9216
    ds_read_b128 v[252:255], v10 offset:14336
    v_pk_add_f32 v[32:33], v[32:33], v[176:177]
    v_pk_add_f32 v[34:35], v[34:35], v[178:179]
    v_pk_add_f32 v[36:37], v[36:37], v[180:181]
    v_pk_add_f32 v[38:39], v[38:39], v[182:183]
    v_pk_add_f32 v[40:41], v[40:41], v[184:185]
    v_pk_add_f32 v[42:43], v[42:43], v[186:187]
    v_pk_add_f32 v[44:45], v[44:45], v[188:189]
    v_pk_add_f32 v[46:47], v[46:47], v[190:191]
    v_pk_add_f32 v[48:49], v[48:49], v[192:193]
    v_pk_add_f32 v[50:51], v[50:51], v[194:195]
    s_waitcnt lgkmcnt(12)
    v_pk_add_f32 v[32:33], v[32:33], v[196:197]
    v_pk_add_f32 v[200:201], v[200:201], v[204:205]
    v_pk_add_f32 v[34:35], v[34:35], v[198:199]
    v_pk_add_f32 v[202:203], v[202:203], v[206:207]
    v_pk_add_f32 v[32:33], v[32:33], v[200:201]
    v_pk_add_f32 v[34:35], v[34:35], v[202:203]
    v_cvt_pk_bf16_f32 v112, v32, v33
    v_cvt_pk_bf16_f32 v113, v34, v35
    s_waitcnt lgkmcnt(9)
    v_pk_add_f32 v[36:37], v[36:37], v[208:209]
    v_pk_add_f32 v[212:213], v[212:213], v[216:217]
    v_pk_add_f32 v[38:39], v[38:39], v[210:211]
    v_pk_add_f32 v[214:215], v[214:215], v[218:219]
    v_pk_add_f32 v[36:37], v[36:37], v[212:213]
    v_pk_add_f32 v[38:39], v[38:39], v[214:215]
    v_cvt_pk_bf16_f32 v114, v36, v37
    v_cvt_pk_bf16_f32 v115, v38, v39
    s_nop 0
    v_permlane16_swap_b32 v112, v114
    v_permlane16_swap_b32 v113, v115
    buffer_store_dwordx4 v[112:115], v9, s[8:11], s30 offen offset:0
    s_waitcnt lgkmcnt(6)
    v_pk_add_f32 v[40:41], v[40:41], v[220:221]
    v_pk_add_f32 v[224:225], v[224:225], v[228:229]
    v_pk_add_f32 v[42:43], v[42:43], v[222:223]
    v_pk_add_f32 v[226:227], v[226:227], v[230:231]
    v_pk_add_f32 v[40:41], v[40:41], v[224:225]
    v_pk_add_f32 v[42:43], v[42:43], v[226:227]
    v_cvt_pk_bf16_f32 v116, v40, v41
    v_cvt_pk_bf16_f32 v117, v42, v43
    s_waitcnt lgkmcnt(3)
    v_pk_add_f32 v[44:45], v[44:45], v[232:233]
    v_pk_add_f32 v[236:237], v[236:237], v[240:241]
    v_pk_add_f32 v[46:47], v[46:47], v[234:235]
    v_pk_add_f32 v[238:239], v[238:239], v[242:243]
    v_pk_add_f32 v[44:45], v[44:45], v[236:237]
    v_pk_add_f32 v[46:47], v[46:47], v[238:239]
    v_cvt_pk_bf16_f32 v118, v44, v45
    v_cvt_pk_bf16_f32 v119, v46, v47
    s_nop 0
    v_permlane16_swap_b32 v116, v118
    v_permlane16_swap_b32 v117, v119
    buffer_store_dwordx4 v[116:119], v9, s[8:11], s30 offen offset:64
    s_waitcnt lgkmcnt(0)
    v_pk_add_f32 v[48:49], v[48:49], v[244:245]
    v_pk_add_f32 v[248:249], v[248:249], v[252:253]
    v_pk_add_f32 v[50:51], v[50:51], v[246:247]
    v_pk_add_f32 v[250:251], v[250:251], v[254:255]
    v_pk_add_f32 v[48:49], v[48:49], v[248:249]
    v_pk_add_f32 v[50:51], v[50:51], v[250:251]
    v_cvt_pk_bf16_f32 v120, v48, v49
    v_cvt_pk_bf16_f32 v121, v50, v51
    v_mov_b32 v122, v120
    v_mov_b32 v123, v121
    s_nop 0
    v_permlane16_swap_b32 v120, v122
    v_permlane16_swap_b32 v121, v123
    s_mov_b32 exec_lo, 0xffff
    s_mov_b32 exec_hi, 0xffff
    buffer_store_dwordx4 v[120:123], v9, s[8:11], s30 offen offset:128
    s_mov_b64 exec, -1
L_end:
    s_endpgm
L_codeend:

.section .rodata,"a"
.p2align 6
.amdhsa_kernel interleave_layers__spectral_fnet__glu_gated_glu__prompt_kernel
  .amdhsa_next_free_vgpr 512
  .amdhsa_next_free_sgpr 102
  .amdhsa_accum_offset 256
  .amdhsa_group_segment_fixed_size 0
  .amdhsa_kernarg_size 96
  .amdhsa_user_sgpr_count 2
  .amdhsa_user_sgpr_kernarg_segment_ptr 1
  .amdhsa_system_sgpr_workgroup_id_x 1
  .amdhsa_float_denorm_mode_32 3
.end_amdhsa_kernel
```
